```python
import torch

def _softmax(x, axis=-1):
    return torch.softmax(x, dim=axis)
def _gelu(x):
    return torch.nn.functional.gelu(x, approximate="tanh")
def _silu(x):
    return torch.nn.functional.silu(x)
def _sigmoid(x):
    return torch.sigmoid(x)
def _layernorm(x, axis=-1, eps=1e-5):
    m = x.mean(dim=axis, keepdim=True)
    v = x.var(dim=axis, keepdim=True, unbiased=False)
    return (x - m) / torch.sqrt(v + eps)
def _scatter_add(tgt, idx, src, axis=0):
    return tgt.clone().index_add_(axis, idx, src)
def _segment_sum(src, seg, n):
    out = torch.zeros((n,) + src.shape[1:], dtype=src.dtype)
    return out.index_add_(0, seg, src)
def _pad(x, pw):
    flat = tuple(v for pair in reversed(pw) for v in pair)
    return torch.nn.functional.pad(x, flat)

kernel_name = 'parallel_sum__sliding_local_dilated__glu_gated_reglu__prompt'

def setup_inputs():

    _w = (lambda a: (lambda t: t.to(torch.bfloat16) if t.is_floating_point() else t)(torch.as_tensor(a)))
    def _A_setup():
        B, S, D = 1, 2048, 576
        return {
            "x": _w((lambda *s: torch.randn(*s, dtype=torch.bfloat16) * 0.05)(B, S, D)),
            "wqkv": _w((lambda *s: torch.randn(*s, dtype=torch.bfloat16) * 0.05)(D, 3 * D)),
            "wo": _w((lambda *s: torch.randn(*s, dtype=torch.bfloat16) * 0.05)(D, D)),
        }
    _A_in = _A_setup()

    def _B_setup():
        B, S, D, F = 1, 2048, 576, 4608
        return {
            "x": _w((lambda *s: torch.randn(*s, dtype=torch.bfloat16) * 0.05)(B, S, D)),
            "W_gate": _w((lambda *s: torch.randn(*s, dtype=torch.bfloat16) * 0.8)(D, F) * (2.0 / D) ** 0.5),
            "W_up": _w((lambda *s: torch.randn(*s, dtype=torch.bfloat16) * 0.8)(D, F) * (2.0 / D) ** 0.5),
            "W_down": _w((lambda *s: torch.randn(*s, dtype=torch.bfloat16) * 0.8)(F, D) * (1.0 / F) ** 0.5),
        }
    _B_in = _B_setup()

    return {
        "A_x": _A_in["x"],
        "A_wqkv": _A_in["wqkv"],
        "A_wo": _A_in["wo"],
        "B_x": _B_in["x"],
        "B_W_gate": _B_in["W_gate"],
        "B_W_up": _B_in["W_up"],
        "B_W_down": _B_in["W_down"],
    }

def reference(A_x, A_wqkv, A_wo, B_x, B_W_gate, B_W_up, B_W_down):
    def _A_ref(x, wqkv, wo):
        B, S, D = x.shape
        H = 32; Dh = D // H
        W, dil = 8, 2
        qkv = (lambda x, *d: x.permute(*d))((x @ wqkv).reshape(B, S, 3, H, Dh), 2, 0, 3, 1, 4)
        q, k, v = qkv[0], qkv[1], qkv[2]
        scale = Dh ** -0.5
        pos = torch.arange(S)
        off = torch.arange(W) * dil
        idx = pos[:, None] - off[None, :]
        mask = idx >= 0
        idx_c = torch.where(mask, idx, 0).reshape(-1)
        kg = k[:, :, idx_c, :].reshape(B, H, S, W, Dh)
        vg = v[:, :, idx_c, :].reshape(B, H, S, W, Dh)
        logits = torch.einsum("bhsd,bhswd->bhsw", q, kg) * scale
        logits = torch.where(mask[None, None, :, :], logits, -1e9)
        attn = _softmax(logits, axis=-1)
        o = torch.einsum("bhsw,bhswd->bhsd", attn, vg)
        return (lambda x, *d: x.permute(*d))(o, 0, 2, 1, 3).reshape(B, S, D) @ wo

    def _B_ref(x, W_gate, W_up, W_down):
        gate = torch.einsum("bsd,df->bsf", x, W_gate)
        up = torch.einsum("bsd,df->bsf", x, W_up)
        gate = gate * (lambda x, dt: x.to(dt))(gate > 0, gate.dtype)
        h = gate * up
        return torch.einsum("bsf,fd->bsd", h, W_down)

    x = A_x
    xn = _layernorm(x, axis=-1)
    return x + _A_ref(xn, A_wqkv, A_wo) + _B_ref(xn, B_W_gate, B_W_up, B_W_down)
```

```asm
; @launch kernel=ln_kernel grid=(192,1,1) block=(256,1,1) lds=2048
; @launch kernel=ka_kernel grid=(256,1,1) block=(512,1,1) lds=159744
; @launch kernel=gemm2_kernel grid=(256,1,1) block=(512,1,1) lds=147456
; @launch kernel=reduce_kernel grid=(288,1,1) block=(256,1,1) lds=0
.amdgcn_target "amdgcn-amd-amdhsa--gfx950"
.text
.globl ln_kernel
.p2align 8
.type ln_kernel,@function
ln_kernel:
    s_cmp_ge_u32 s2, 192
    s_cbranch_scc1 L_ln_end
    v_lshrrev_b32 v8, 6, v0
    v_and_b32 v0, 63, v0
    v_readfirstlane_b32 s30, v8
    s_cmp_ge_u32 s2, 128
    s_cbranch_scc1 L_ln_pf
    s_load_dwordx2 s[4:5], s[0:1], 0
    s_load_dwordx2 s[6:7], s[0:1], 72
    v_and_b32 v1, 15, v0
    v_lshrrev_b32 v2, 4, v0
    v_mul_u32_u24 v3, 1152, v1
    v_lshl_add_u32 v3, v2, 4, v3
    s_mul_i32 s3, s2, 18432
    s_lshl_b32 s16, s30, 6
    s_add_u32 s17, s3, s16
    s_lshl_b32 s16, s30, 10
    s_add_u32 s18, s3, s16
    v_mov_b32 v4, 0x3f803f80
    v_lshlrev_b32 v14, 4, v0
    v_xor_b32 v15, 16, v0
    v_lshlrev_b32 v15, 2, v15
    v_xor_b32 v13, 32, v0
    v_lshlrev_b32 v13, 2, v13
    s_cmp_lt_u32 s30, 2
    s_cselect_b32 s19, 0, 0x40000000
    s_waitcnt lgkmcnt(0)
    s_mov_b32 s8, s4
    s_and_b32 s9, s5, 0xffff
    s_mov_b32 s10, 2359296
    s_mov_b32 s11, 0x00020000
    s_mov_b32 s12, s6
    s_and_b32 s13, s7, 0xffff
    s_mov_b32 s14, 2359296
    s_mov_b32 s15, 0x00020000
    buffer_load_dwordx4 v[16:19], v3, s[8:11], s17 offen offset:0
    buffer_load_dwordx4 v[20:23], v3, s[8:11], s17 offen offset:256
    buffer_load_dwordx4 v[24:27], v3, s[8:11], s17 offen offset:512
    buffer_load_dwordx4 v[28:31], v3, s[8:11], s17 offen offset:768
    s_add_u32 s17, s17, s19
    buffer_load_dwordx4 v[32:35], v3, s[8:11], s17 offen offset:1024
    v_mov_b32 v5, 0
    v_mov_b32 v6, 0
    v_mov_b32 v7, 0
    v_mov_b32 v8, 0
    v_mov_b32 v9, 0
    v_mov_b32 v10, 0
    v_mov_b32 v11, 0
    v_mov_b32 v12, 0
    s_waitcnt vmcnt(4)
    v_dot2_f32_bf16 v5, v16, v4, v5
    v_dot2_f32_bf16 v9, v16, v16, v9
    v_dot2_f32_bf16 v6, v17, v4, v6
    v_dot2_f32_bf16 v10, v17, v17, v10
    v_dot2_f32_bf16 v7, v18, v4, v7
    v_dot2_f32_bf16 v11, v18, v18, v11
    v_dot2_f32_bf16 v8, v19, v4, v8
    v_dot2_f32_bf16 v12, v19, v19, v12
    s_waitcnt vmcnt(3)
    v_dot2_f32_bf16 v5, v20, v4, v5
    v_dot2_f32_bf16 v9, v20, v20, v9
    v_dot2_f32_bf16 v6, v21, v4, v6
    v_dot2_f32_bf16 v10, v21, v21, v10
    v_dot2_f32_bf16 v7, v22, v4, v7
    v_dot2_f32_bf16 v11, v22, v22, v11
    v_dot2_f32_bf16 v8, v23, v4, v8
    v_dot2_f32_bf16 v12, v23, v23, v12
    s_waitcnt vmcnt(2)
    v_dot2_f32_bf16 v5, v24, v4, v5
    v_dot2_f32_bf16 v9, v24, v24, v9
    v_dot2_f32_bf16 v6, v25, v4, v6
    v_dot2_f32_bf16 v10, v25, v25, v10
    v_dot2_f32_bf16 v7, v26, v4, v7
    v_dot2_f32_bf16 v11, v26, v26, v11
    v_dot2_f32_bf16 v8, v27, v4, v8
    v_dot2_f32_bf16 v12, v27, v27, v12
    s_waitcnt vmcnt(1)
    v_dot2_f32_bf16 v5, v28, v4, v5
    v_dot2_f32_bf16 v9, v28, v28, v9
    v_dot2_f32_bf16 v6, v29, v4, v6
    v_dot2_f32_bf16 v10, v29, v29, v10
    v_dot2_f32_bf16 v7, v30, v4, v7
    v_dot2_f32_bf16 v11, v30, v30, v11
    v_dot2_f32_bf16 v8, v31, v4, v8
    v_dot2_f32_bf16 v12, v31, v31, v12
    s_waitcnt vmcnt(0)
    v_dot2_f32_bf16 v5, v32, v4, v5
    v_dot2_f32_bf16 v9, v32, v32, v9
    v_dot2_f32_bf16 v6, v33, v4, v6
    v_dot2_f32_bf16 v10, v33, v33, v10
    v_dot2_f32_bf16 v7, v34, v4, v7
    v_dot2_f32_bf16 v11, v34, v34, v11
    v_dot2_f32_bf16 v8, v35, v4, v8
    v_dot2_f32_bf16 v12, v35, v35, v12
    s_nop 3
    v_add_f32 v5, v5, v6
    v_add_f32 v7, v7, v8
    v_add_f32 v9, v9, v10
    v_add_f32 v11, v11, v12
    v_add_f32 v10, v5, v7
    v_add_f32 v11, v9, v11
    v_lshlrev_b32 v7, 3, v0
    s_lshl_b32 s16, s30, 9
    v_add_u32 v7, s16, v7
    ds_write_b64 v7, v[10:11]
    v_lshlrev_b32 v7, 3, v1
    s_waitcnt lgkmcnt(0)
    s_barrier
    ds_read_b64 v[40:41], v7 offset:0
    ds_read_b64 v[42:43], v7 offset:128
    ds_read_b64 v[44:45], v7 offset:256
    ds_read_b64 v[46:47], v7 offset:384
    ds_read_b64 v[48:49], v7 offset:512
    ds_read_b64 v[50:51], v7 offset:640
    ds_read_b64 v[52:53], v7 offset:768
    ds_read_b64 v[54:55], v7 offset:896
    s_waitcnt lgkmcnt(0)
    ds_read_b64 v[56:57], v7 offset:1024
    ds_read_b64 v[58:59], v7 offset:1152
    ds_read_b64 v[60:61], v7 offset:1280
    ds_read_b64 v[62:63], v7 offset:1408
    ds_read_b64 v[64:65], v7 offset:1536
    ds_read_b64 v[66:67], v7 offset:1664
    ds_read_b64 v[68:69], v7 offset:1792
    ds_read_b64 v[70:71], v7 offset:1920
    s_waitcnt lgkmcnt(0)
    v_add_f32 v40, v40, v56
    v_add_f32 v41, v41, v57
    v_add_f32 v42, v42, v58
    v_add_f32 v43, v43, v59
    v_add_f32 v44, v44, v60
    v_add_f32 v45, v45, v61
    v_add_f32 v46, v46, v62
    v_add_f32 v47, v47, v63
    v_add_f32 v48, v48, v64
    v_add_f32 v49, v49, v65
    v_add_f32 v50, v50, v66
    v_add_f32 v51, v51, v67
    v_add_f32 v52, v52, v68
    v_add_f32 v53, v53, v69
    v_add_f32 v54, v54, v70
    v_add_f32 v55, v55, v71
    v_add_f32 v40, v40, v48
    v_add_f32 v41, v41, v49
    v_add_f32 v42, v42, v50
    v_add_f32 v43, v43, v51
    v_add_f32 v44, v44, v52
    v_add_f32 v45, v45, v53
    v_add_f32 v46, v46, v54
    v_add_f32 v47, v47, v55
    v_add_f32 v40, v40, v44
    v_add_f32 v41, v41, v45
    v_add_f32 v42, v42, v46
    v_add_f32 v43, v43, v47
    v_add_f32 v40, v40, v42
    v_add_f32 v41, v41, v43
    v_mul_f32 v5, 0x3ae38e39, v40
    v_mul_f32 v9, 0x3ae38e39, v41
    v_fma_f32 v9, -v5, v5, v9
    v_max_f32 v9, 0, v9
    v_cvt_pk_bf16_f32 v6, v5, v5
    v_lshlrev_b32 v5, 16, v6
    v_cvt_pk_bf16_f32 v6, v9, v9
    v_lshlrev_b32 v9, 16, v6
    v_add_f32 v9, 0x3727c5ac, v9
    v_cvt_pk_bf16_f32 v6, v9, v9
    v_lshlrev_b32 v9, 16, v6
    v_sqrt_f32 v9, v9
    s_nop 0
    v_cvt_pk_bf16_f32 v6, v9, v9
    v_lshlrev_b32 v9, 16, v6
    v_rcp_f32 v9, v9
    s_nop 0
    v_lshlrev_b32 v6, 16, v16
    v_and_b32 v7, 0xffff0000, v16
    v_sub_f32 v6, v6, v5
    v_sub_f32 v7, v7, v5
    v_cvt_pk_bf16_f32 v8, v6, v7
    v_lshlrev_b32 v6, 16, v8
    v_and_b32 v7, 0xffff0000, v8
    v_mul_f32 v6, v6, v9
    v_mul_f32 v7, v7, v9
    v_cvt_pk_bf16_f32 v16, v6, v7
    v_lshlrev_b32 v6, 16, v17
    v_and_b32 v7, 0xffff0000, v17
    v_sub_f32 v6, v6, v5
    v_sub_f32 v7, v7, v5
    v_cvt_pk_bf16_f32 v8, v6, v7
    v_lshlrev_b32 v6, 16, v8
    v_and_b32 v7, 0xffff0000, v8
    v_mul_f32 v6, v6, v9
    v_mul_f32 v7, v7, v9
    v_cvt_pk_bf16_f32 v17, v6, v7
    v_lshlrev_b32 v6, 16, v18
    v_and_b32 v7, 0xffff0000, v18
    v_sub_f32 v6, v6, v5
    v_sub_f32 v7, v7, v5
    v_cvt_pk_bf16_f32 v8, v6, v7
    v_lshlrev_b32 v6, 16, v8
    v_and_b32 v7, 0xffff0000, v8
    v_mul_f32 v6, v6, v9
    v_mul_f32 v7, v7, v9
    v_cvt_pk_bf16_f32 v18, v6, v7
    v_lshlrev_b32 v6, 16, v19
    v_and_b32 v7, 0xffff0000, v19
    v_sub_f32 v6, v6, v5
    v_sub_f32 v7, v7, v5
    v_cvt_pk_bf16_f32 v8, v6, v7
    v_lshlrev_b32 v6, 16, v8
    v_and_b32 v7, 0xffff0000, v8
    v_mul_f32 v6, v6, v9
    v_mul_f32 v7, v7, v9
    v_cvt_pk_bf16_f32 v19, v6, v7
    buffer_store_dwordx4 v[16:19], v14, s[12:15], s18 offen
    s_add_u32 s18, s18, 4096
    v_lshlrev_b32 v6, 16, v20
    v_and_b32 v7, 0xffff0000, v20
    v_sub_f32 v6, v6, v5
    v_sub_f32 v7, v7, v5
    v_cvt_pk_bf16_f32 v8, v6, v7
    v_lshlrev_b32 v6, 16, v8
    v_and_b32 v7, 0xffff0000, v8
    v_mul_f32 v6, v6, v9
    v_mul_f32 v7, v7, v9
    v_cvt_pk_bf16_f32 v20, v6, v7
    v_lshlrev_b32 v6, 16, v21
    v_and_b32 v7, 0xffff0000, v21
    v_sub_f32 v6, v6, v5
    v_sub_f32 v7, v7, v5
    v_cvt_pk_bf16_f32 v8, v6, v7
    v_lshlrev_b32 v6, 16, v8
    v_and_b32 v7, 0xffff0000, v8
    v_mul_f32 v6, v6, v9
    v_mul_f32 v7, v7, v9
    v_cvt_pk_bf16_f32 v21, v6, v7
    v_lshlrev_b32 v6, 16, v22
    v_and_b32 v7, 0xffff0000, v22
    v_sub_f32 v6, v6, v5
    v_sub_f32 v7, v7, v5
    v_cvt_pk_bf16_f32 v8, v6, v7
    v_lshlrev_b32 v6, 16, v8
    v_and_b32 v7, 0xffff0000, v8
    v_mul_f32 v6, v6, v9
    v_mul_f32 v7, v7, v9
    v_cvt_pk_bf16_f32 v22, v6, v7
    v_lshlrev_b32 v6, 16, v23
    v_and_b32 v7, 0xffff0000, v23
    v_sub_f32 v6, v6, v5
    v_sub_f32 v7, v7, v5
    v_cvt_pk_bf16_f32 v8, v6, v7
    v_lshlrev_b32 v6, 16, v8
    v_and_b32 v7, 0xffff0000, v8
    v_mul_f32 v6, v6, v9
    v_mul_f32 v7, v7, v9
    v_cvt_pk_bf16_f32 v23, v6, v7
    buffer_store_dwordx4 v[20:23], v14, s[12:15], s18 offen
    s_add_u32 s18, s18, 4096
    v_lshlrev_b32 v6, 16, v24
    v_and_b32 v7, 0xffff0000, v24
    v_sub_f32 v6, v6, v5
    v_sub_f32 v7, v7, v5
    v_cvt_pk_bf16_f32 v8, v6, v7
    v_lshlrev_b32 v6, 16, v8
    v_and_b32 v7, 0xffff0000, v8
    v_mul_f32 v6, v6, v9
    v_mul_f32 v7, v7, v9
    v_cvt_pk_bf16_f32 v24, v6, v7
    v_lshlrev_b32 v6, 16, v25
    v_and_b32 v7, 0xffff0000, v25
    v_sub_f32 v6, v6, v5
    v_sub_f32 v7, v7, v5
    v_cvt_pk_bf16_f32 v8, v6, v7
    v_lshlrev_b32 v6, 16, v8
    v_and_b32 v7, 0xffff0000, v8
    v_mul_f32 v6, v6, v9
    v_mul_f32 v7, v7, v9
    v_cvt_pk_bf16_f32 v25, v6, v7
    v_lshlrev_b32 v6, 16, v26
    v_and_b32 v7, 0xffff0000, v26
    v_sub_f32 v6, v6, v5
    v_sub_f32 v7, v7, v5
    v_cvt_pk_bf16_f32 v8, v6, v7
    v_lshlrev_b32 v6, 16, v8
    v_and_b32 v7, 0xffff0000, v8
    v_mul_f32 v6, v6, v9
    v_mul_f32 v7, v7, v9
    v_cvt_pk_bf16_f32 v26, v6, v7
    v_lshlrev_b32 v6, 16, v27
    v_and_b32 v7, 0xffff0000, v27
    v_sub_f32 v6, v6, v5
    v_sub_f32 v7, v7, v5
    v_cvt_pk_bf16_f32 v8, v6, v7
    v_lshlrev_b32 v6, 16, v8
    v_and_b32 v7, 0xffff0000, v8
    v_mul_f32 v6, v6, v9
    v_mul_f32 v7, v7, v9
    v_cvt_pk_bf16_f32 v27, v6, v7
    buffer_store_dwordx4 v[24:27], v14, s[12:15], s18 offen
    s_add_u32 s18, s18, 4096
    v_lshlrev_b32 v6, 16, v28
    v_and_b32 v7, 0xffff0000, v28
    v_sub_f32 v6, v6, v5
    v_sub_f32 v7, v7, v5
    v_cvt_pk_bf16_f32 v8, v6, v7
    v_lshlrev_b32 v6, 16, v8
    v_and_b32 v7, 0xffff0000, v8
    v_mul_f32 v6, v6, v9
    v_mul_f32 v7, v7, v9
    v_cvt_pk_bf16_f32 v28, v6, v7
    v_lshlrev_b32 v6, 16, v29
    v_and_b32 v7, 0xffff0000, v29
    v_sub_f32 v6, v6, v5
    v_sub_f32 v7, v7, v5
    v_cvt_pk_bf16_f32 v8, v6, v7
    v_lshlrev_b32 v6, 16, v8
    v_and_b32 v7, 0xffff0000, v8
    v_mul_f32 v6, v6, v9
    v_mul_f32 v7, v7, v9
    v_cvt_pk_bf16_f32 v29, v6, v7
    v_lshlrev_b32 v6, 16, v30
    v_and_b32 v7, 0xffff0000, v30
    v_sub_f32 v6, v6, v5
    v_sub_f32 v7, v7, v5
    v_cvt_pk_bf16_f32 v8, v6, v7
    v_lshlrev_b32 v6, 16, v8
    v_and_b32 v7, 0xffff0000, v8
    v_mul_f32 v6, v6, v9
    v_mul_f32 v7, v7, v9
    v_cvt_pk_bf16_f32 v30, v6, v7
    v_lshlrev_b32 v6, 16, v31
    v_and_b32 v7, 0xffff0000, v31
    v_sub_f32 v6, v6, v5
    v_sub_f32 v7, v7, v5
    v_cvt_pk_bf16_f32 v8, v6, v7
    v_lshlrev_b32 v6, 16, v8
    v_and_b32 v7, 0xffff0000, v8
    v_mul_f32 v6, v6, v9
    v_mul_f32 v7, v7, v9
    v_cvt_pk_bf16_f32 v31, v6, v7
    buffer_store_dwordx4 v[28:31], v14, s[12:15], s18 offen
    s_add_u32 s18, s18, 4096
    v_lshlrev_b32 v6, 16, v32
    v_and_b32 v7, 0xffff0000, v32
    v_sub_f32 v6, v6, v5
    v_sub_f32 v7, v7, v5
    v_cvt_pk_bf16_f32 v8, v6, v7
    v_lshlrev_b32 v6, 16, v8
    v_and_b32 v7, 0xffff0000, v8
    v_mul_f32 v6, v6, v9
    v_mul_f32 v7, v7, v9
    v_cvt_pk_bf16_f32 v32, v6, v7
    v_lshlrev_b32 v6, 16, v33
    v_and_b32 v7, 0xffff0000, v33
    v_sub_f32 v6, v6, v5
    v_sub_f32 v7, v7, v5
    v_cvt_pk_bf16_f32 v8, v6, v7
    v_lshlrev_b32 v6, 16, v8
    v_and_b32 v7, 0xffff0000, v8
    v_mul_f32 v6, v6, v9
    v_mul_f32 v7, v7, v9
    v_cvt_pk_bf16_f32 v33, v6, v7
    v_lshlrev_b32 v6, 16, v34
    v_and_b32 v7, 0xffff0000, v34
    v_sub_f32 v6, v6, v5
    v_sub_f32 v7, v7, v5
    v_cvt_pk_bf16_f32 v8, v6, v7
    v_lshlrev_b32 v6, 16, v8
    v_and_b32 v7, 0xffff0000, v8
    v_mul_f32 v6, v6, v9
    v_mul_f32 v7, v7, v9
    v_cvt_pk_bf16_f32 v34, v6, v7
    v_lshlrev_b32 v6, 16, v35
    v_and_b32 v7, 0xffff0000, v35
    v_sub_f32 v6, v6, v5
    v_sub_f32 v7, v7, v5
    v_cvt_pk_bf16_f32 v8, v6, v7
    v_lshlrev_b32 v6, 16, v8
    v_and_b32 v7, 0xffff0000, v8
    v_mul_f32 v6, v6, v9
    v_mul_f32 v7, v7, v9
    v_cvt_pk_bf16_f32 v35, v6, v7
    s_add_u32 s18, s18, s19
    buffer_store_dwordx4 v[32:35], v14, s[12:15], s18 offen
    s_add_u32 s18, s18, 4096
    s_branch L_ln_end
L_ln_pf:
    s_load_dwordx4 s[4:7], s[0:1], 8
    s_load_dwordx4 s[24:27], s[0:1], 32
    s_load_dwordx2 s[28:29], s[0:1], 48
    s_sub_u32 s3, s2, 128
    s_and_b32 s20, s3, 7
    s_lshr_b32 s21, s3, 3
    s_lshl_b32 s21, s21, 2
    s_add_u32 s21, s21, s30
    s_mov_b32 s22, 57
    v_mul_u32_u24 v2, s22, v0
    v_lshrrev_b32 v2, 10, v2
    v_mul_u32_u24 v3, 18, v2
    v_sub_u32 v3, v0, v3
    v_cmp_gt_u32 vcc, 54, v0
    s_nop 1
    v_cndmask_b32 v2, 0, v2, vcc
    v_cndmask_b32 v3, 0, v3, vcc
    v_mul_u32_u24 v4, 9216, v2
    v_lshl_add_u32 v4, v3, 6, v4
    s_mul_i32 s22, s20, 1152
    v_add_u32 v4, s22, v4
    s_mov_b32 s22, 43
    v_mul_u32_u24 v6, s22, v3
    v_lshrrev_b32 v6, 8, v6
    v_mul_u32_u24 v7, 6, v6
    v_sub_u32 v7, v3, v7
    v_mul_u32_u24 v5, 3456, v2
    v_mul_u32_u24 v6, 1152, v6
    v_add_u32 v5, v5, v6
    v_lshl_add_u32 v5, v7, 6, v5
    s_lshr_b32 s22, s20, 1
    s_mul_i32 s22, s22, 288
    v_add_u32 v5, s22, v5
    v_lshlrev_b32 v6, 6, v0
    s_waitcnt lgkmcnt(0)
    s_mov_b32 s8, s24
    s_and_b32 s9, s25, 0xffff
    s_mov_b32 s10, 5308416
    s_mov_b32 s11, 0x00020000
    s_mov_b32 s12, s26
    s_and_b32 s13, s27, 0xffff
    s_mov_b32 s14, 5308416
    s_mov_b32 s15, 0x00020000
    s_mov_b32 s16, s4
    s_and_b32 s17, s5, 0xffff
    s_mov_b32 s18, 1990656
    s_mov_b32 s19, 0x00020000
    s_mov_b32 s32, s28
    s_and_b32 s33, s29, 0xffff
    s_mov_b32 s34, 5308416
    s_mov_b32 s35, 0x00020000
    s_mov_b32 s36, s6
    s_and_b32 s37, s7, 0xffff
    s_mov_b32 s38, 663552
    s_mov_b32 s39, 0x00020000
    s_getpc_b64 s[40:41]
L_pc_here:
    s_add_u32 s40, s40, ka_kernel - L_pc_here
    s_addc_u32 s41, s41, 0
    s_lshl_b32 s22, s21, 12
    v_lshlrev_b32 v15, 6, v0
    v_add_u32 v15, s22, v15
    s_mov_b32 s22, L_code_end - ka_kernel - 4
    v_add_u32 v16, 0, v15
    v_min_u32 v16, s22, v16
    global_load_dword v17, v16, s[40:41]
    v_add_u32 v16, 131072, v15
    v_min_u32 v16, s22, v16
    global_load_dword v17, v16, s[40:41]
    s_mul_i32 s22, s21, 55296
    s_add_u32 s23, s22, 0
    buffer_load_dword v10, v4, s[8:11], s23 offen
    buffer_load_dword v11, v4, s[12:15], s23 offen
    s_add_u32 s23, s22, 27648
    buffer_load_dword v10, v4, s[8:11], s23 offen
    buffer_load_dword v11, v4, s[12:15], s23 offen
    s_mul_i32 s22, s21, 20736
    s_add_u32 s23, s22, 0
    buffer_load_dword v12, v5, s[16:19], s23 offen
    s_add_u32 s23, s22, 10368
    buffer_load_dword v12, v5, s[16:19], s23 offen
L_ln_end:
    s_endpgm
.section .rodata,"a"
.p2align 6
.amdhsa_kernel ln_kernel
  .amdhsa_next_free_vgpr 88
  .amdhsa_next_free_sgpr 44
  .amdhsa_accum_offset 88
  .amdhsa_group_segment_fixed_size 0
  .amdhsa_kernarg_size 80
  .amdhsa_user_sgpr_count 2
  .amdhsa_user_sgpr_kernarg_segment_ptr 1
  .amdhsa_system_sgpr_workgroup_id_x 1
.end_amdhsa_kernel
.text

.globl ka_kernel
.p2align 8
.type ka_kernel,@function
ka_kernel:
    s_cmp_ge_u32 s2, 256
    s_cbranch_scc1 L_ka_end
    s_load_dwordx4 s[4:7], s[0:1], 32
    s_load_dwordx2 s[26:27], s[0:1], 72
    s_load_dwordx2 s[36:37], s[0:1], 8
    s_load_dwordx2 s[40:41], s[0:1], 48
    s_load_dwordx2 s[42:43], s[0:1], 16
    v_and_b32 v1, 63, v0
    v_lshrrev_b32 v2, 6, v0
    s_nop 0
    v_readfirstlane_b32 s20, v2
    s_and_b32 s38, s2, 7
    s_lshr_b32 s39, s2, 3
    s_cmp_ge_u32 s39, 24
    s_cbranch_scc1 L_ka_qkv
    s_mul_i32 s22, s39, 43
    s_lshr_b32 s22, s22, 7
    s_mul_i32 s23, s22, 3
    s_sub_u32 s23, s39, s23
    s_mul_i32 s21, s38, 3
    s_add_u32 s21, s21, s23
    v_lshlrev_b32 v19, 4, v1
    s_lshl_b32 s23, s22, 4
    s_lshl_b32 s24, s20, 1
    s_add_u32 s28, s23, s24
    s_mul_i32 s23, s28, 18432
    s_add_u32 s24, s23, 0
    v_add_u32 v14, s24, v19
    s_add_u32 s24, s23, 18432
    v_add_u32 v15, s24, v19
    s_and_b32 s24, s20, 3
    s_mul_i32 s25, s24, 208
    s_mul_i32 s23, s21, 384
    s_add_u32 s29, s25, 0
    v_add_u32 v2, s29, v1
    s_mov_b32 s30, 1261
    v_mul_u32_u24 v3, s30, v2
    v_lshrrev_b32 v3, 15, v3
    v_mul_u32_u24 v4, 26, v3
    v_sub_u32 v4, v2, v4
    v_min_u32 v4, 23, v4
    v_min_u32 v3, 31, v3
    v_and_b32 v5, 0x13, v3
    v_and_b32 v6, 4, v3
    v_lshl_or_b32 v5, v6, 1, v5
    v_and_b32 v6, 8, v3
    v_lshrrev_b32 v6, 1, v6
    v_or_b32 v5, v5, v6
    v_mul_u32_u24 v5, 9216, v5
    v_lshl_add_u32 v5, v4, 4, v5
    v_add_u32 v10, s23, v5
    s_add_u32 s29, s25, 64
    v_add_u32 v2, s29, v1
    s_mov_b32 s30, 1261
    v_mul_u32_u24 v3, s30, v2
    v_lshrrev_b32 v3, 15, v3
    v_mul_u32_u24 v4, 26, v3
    v_sub_u32 v4, v2, v4
    v_min_u32 v4, 23, v4
    v_min_u32 v3, 31, v3
    v_and_b32 v5, 0x13, v3
    v_and_b32 v6, 4, v3
    v_lshl_or_b32 v5, v6, 1, v5
    v_and_b32 v6, 8, v3
    v_lshrrev_b32 v6, 1, v6
    v_or_b32 v5, v5, v6
    v_mul_u32_u24 v5, 9216, v5
    v_lshl_add_u32 v5, v4, 4, v5
    v_add_u32 v11, s23, v5
    s_add_u32 s29, s25, 128
    v_add_u32 v2, s29, v1
    s_mov_b32 s30, 1261
    v_mul_u32_u24 v3, s30, v2
    v_lshrrev_b32 v3, 15, v3
    v_mul_u32_u24 v4, 26, v3
    v_sub_u32 v4, v2, v4
    v_min_u32 v4, 23, v4
    v_min_u32 v3, 31, v3
    v_and_b32 v5, 0x13, v3
    v_and_b32 v6, 4, v3
    v_lshl_or_b32 v5, v6, 1, v5
    v_and_b32 v6, 8, v3
    v_lshrrev_b32 v6, 1, v6
    v_or_b32 v5, v5, v6
    v_mul_u32_u24 v5, 9216, v5
    v_lshl_add_u32 v5, v4, 4, v5
    v_add_u32 v12, s23, v5
    s_add_u32 s29, s25, 192
    v_add_u32 v2, s29, v1
    s_mov_b32 s30, 1261
    v_mul_u32_u24 v3, s30, v2
    v_lshrrev_b32 v3, 15, v3
    v_mul_u32_u24 v4, 26, v3
    v_sub_u32 v4, v2, v4
    v_min_u32 v4, 23, v4
    v_min_u32 v3, 31, v3
    v_and_b32 v5, 0x13, v3
    v_and_b32 v6, 4, v3
    v_lshl_or_b32 v5, v6, 1, v5
    v_and_b32 v6, 8, v3
    v_lshrrev_b32 v6, 1, v6
    v_or_b32 v5, v5, v6
    v_mul_u32_u24 v5, 9216, v5
    v_lshl_add_u32 v5, v4, 4, v5
    v_add_u32 v13, s23, v5
    v_lshrrev_b32 v16, 5, v1
    v_lshlrev_b32 v16, 4, v16
    v_bfe_u32 v3, v1, 4, 1
    v_lshl_add_u32 v16, v3, 2, v16
    v_bfe_u32 v3, v1, 2, 2
    v_add_u32 v16, v16, v3
    v_mul_u32_u24 v16, 416, v16
    v_and_b32 v3, 3, v1
    v_lshl_add_u32 v16, v3, 3, v16
    s_lshr_b32 s23, s20, 2
    s_mul_i32 s29, s23, 13312
    s_mul_i32 s30, s24, 3328
    s_add_u32 s29, s29, s30
    s_waitcnt lgkmcnt(0)
    s_mov_b64 s[60:61], s[4:5]
    s_mov_b64 s[62:63], s[6:7]
    s_cmp_eq_u32 s23, 0
    s_cselect_b32 s4, s4, s6
    s_cselect_b32 s5, s5, s7
    s_mov_b32 s12, s4
    s_and_b32 s13, s5, 0xffff
    s_mov_b32 s14, 5308416
    s_mov_b32 s15, 0x00020000
    s_mov_b32 s8, s26
    s_and_b32 s9, s27, 0xffff
    s_mov_b32 s10, 2359296
    s_mov_b32 s11, 0x00020000
    s_add_u32 s16, s26, 4194304
    s_addc_u32 s17, s27, 0
    s_and_b32 s17, s17, 0xffff
    s_mov_b32 s18, 21233664
    s_mov_b32 s19, 0x00020000
    s_mov_b32 s31, 0
    s_add_u32 m0, s29, 0
    s_nop 0
    buffer_load_dwordx4 v10, s[12:15], s31 offen lds
    s_add_u32 m0, s29, 1024
    s_nop 0
    buffer_load_dwordx4 v11, s[12:15], s31 offen lds
    s_add_u32 m0, s29, 2048
    s_nop 0
    buffer_load_dwordx4 v12, s[12:15], s31 offen lds
    s_add_u32 m0, s29, 3072
    s_mov_b64 exec, 0xffff
    buffer_load_dwordx4 v13, s[12:15], s31 offen lds
    s_mov_b64 exec, -1
    s_mov_b32 s32, 0
    buffer_load_dwordx4 v[20:23], v14, s[8:11], s32 offen
    buffer_load_dwordx4 v[24:27], v15, s[8:11], s32 offen
    s_mov_b32 s31, 294912
    s_add_u32 m0, s29, 26624
    s_nop 0
    buffer_load_dwordx4 v10, s[12:15], s31 offen lds
    s_add_u32 m0, s29, 27648
    s_nop 0
    buffer_load_dwordx4 v11, s[12:15], s31 offen lds
    s_add_u32 m0, s29, 28672
    s_nop 0
    buffer_load_dwordx4 v12, s[12:15], s31 offen lds
    s_add_u32 m0, s29, 29696
    s_mov_b64 exec, 0xffff
    buffer_load_dwordx4 v13, s[12:15], s31 offen lds
    s_mov_b64 exec, -1
    s_mov_b32 s32, 1024
    buffer_load_dwordx4 v[28:31], v14, s[8:11], s32 offen
    buffer_load_dwordx4 v[32:35], v15, s[8:11], s32 offen
    s_mov_b32 s30, 43
    v_mul_u32_u24 v2, s30, v1
    v_lshrrev_b32 v2, 8, v2
    v_mul_u32_u24 v3, 6, v2
    v_sub_u32 v3, v1, v3
    v_min_u32 v2, 8, v2
    v_mul_u32_u24 v2, 9216, v2
    v_lshl_add_u32 v2, v3, 6, v2
    s_lshl_b32 s23, s22, 3
    s_add_u32 s23, s23, s20
    s_mul_i32 s23, s23, 9*9216
    s_mul_i32 s24, s21, 384
    s_add_u32 s23, s23, s24
    s_mov_b32 s52, s60
    s_and_b32 s53, s61, 0xffff
    s_mov_b32 s54, 5308416
    s_mov_b32 s55, 0x00020000
    s_mov_b32 s44, s62
    s_and_b32 s45, s63, 0xffff
    s_mov_b32 s46, 5308416
    s_mov_b32 s47, 0x00020000
    buffer_load_dword v3, v2, s[52:55], s23 offen
    buffer_load_dword v3, v2, s[44:47], s23 offen
    s_mov_b32 s44, s40
    s_and_b32 s45, s41, 0xffff
    s_mov_b32 s46, 5308416
    s_mov_b32 s47, 0x00020000
    s_mov_b32 s48, s42
    s_and_b32 s49, s43, 0xffff
    s_mov_b32 s50, 663552
    s_mov_b32 s51, 0x00020000
    v_lshlrev_b32 v9, 6, v1
    s_lshl_b32 s23, s39, 3
    s_add_u32 s23, s23, s20
    s_mul_i32 s23, s23, 2*4096
    s_lshr_b32 s24, s38, 1
    s_mul_i32 s25, s24, 1344*1152
    s_add_u32 s25, s25, s23
    s_sub_u32 s34, s23, 663552
    s_cmp_ge_u32 s23, 663552
    s_cselect_b32 s34, s34, 0x40000000
    s_cmp_eq_u32 s24, 3
    s_cselect_b32 s34, s34, 0x40000000
    s_waitcnt vmcnt(10)
    s_barrier
    v_add_u32 v17, 0, v16
    ds_read_b64_tr_b16 v[44:45], v17 offset:0
    ds_read_b64_tr_b16 v[46:47], v17 offset:3328
    ds_read_b64_tr_b16 v[48:49], v17 offset:32
    ds_read_b64_tr_b16 v[50:51], v17 offset:3360
    ds_read_b64_tr_b16 v[52:53], v17 offset:64
    ds_read_b64_tr_b16 v[54:55], v17 offset:3392
    ds_read_b64_tr_b16 v[56:57], v17 offset:96
    ds_read_b64_tr_b16 v[58:59], v17 offset:3424
    ds_read_b64_tr_b16 v[60:61], v17 offset:128
    ds_read_b64_tr_b16 v[62:63], v17 offset:3456
    s_waitcnt vmcnt(8)
    s_waitcnt lgkmcnt(8)
    v_mfma_f32_16x16x32_bf16 a[0:3], v[44:47], v[20:23], 0
    v_mfma_f32_16x16x32_bf16 a[48:51], v[44:47], v[24:27], 0
    ds_read_b64_tr_b16 v[44:45], v17 offset:160
    ds_read_b64_tr_b16 v[46:47], v17 offset:3488
    s_waitcnt lgkmcnt(8)
    v_mfma_f32_16x16x32_bf16 a[4:7], v[48:51], v[20:23], 0
    v_mfma_f32_16x16x32_bf16 a[52:55], v[48:51], v[24:27], 0
    s_mov_b32 s32, 2048
    buffer_load_dwordx4 v[36:39], v14, s[8:11], s32 offen
    ds_read_b64_tr_b16 v[48:49], v17 offset:192
    ds_read_b64_tr_b16 v[50:51], v17 offset:3520
    s_waitcnt lgkmcnt(8)
    v_mfma_f32_16x16x32_bf16 a[8:11], v[52:55], v[20:23], 0
    v_mfma_f32_16x16x32_bf16 a[56:59], v[52:55], v[24:27], 0
    ds_read_b64_tr_b16 v[52:53], v17 offset:224
    ds_read_b64_tr_b16 v[54:55], v17 offset:3552
    s_waitcnt lgkmcnt(8)
    v_mfma_f32_16x16x32_bf16 a[12:15], v[56:59], v[20:23], 0
    v_mfma_f32_16x16x32_bf16 a[60:63], v[56:59], v[24:27], 0
    buffer_load_dwordx4 v[40:43], v15, s[8:11], s32 offen
    ds_read_b64_tr_b16 v[56:57], v17 offset:256
    ds_read_b64_tr_b16 v[58:59], v17 offset:3584
    s_waitcnt lgkmcnt(8)
    v_mfma_f32_16x16x32_bf16 a[16:19], v[60:63], v[20:23], 0
    v_mfma_f32_16x16x32_bf16 a[64:67], v[60:63], v[24:27], 0
    ds_read_b64_tr_b16 v[60:61], v17 offset:288
    ds_read_b64_tr_b16 v[62:63], v17 offset:3616
    s_waitcnt lgkmcnt(8)
    v_mfma_f32_16x16x32_bf16 a[20:23], v[44:47], v[20:23], 0
    v_mfma_f32_16x16x32_bf16 a[68:71], v[44:47], v[24:27], 0
    s_mov_b32 s31, 589824
    s_add_u32 m0, s29, 53248
    s_nop 0
    buffer_load_dwordx4 v10, s[12:15], s31 offen lds
    ds_read_b64_tr_b16 v[44:45], v17 offset:320
    ds_read_b64_tr_b16 v[46:47], v17 offset:3648
    s_waitcnt lgkmcnt(8)
    v_mfma_f32_16x16x32_bf16 a[24:27], v[48:51], v[20:23], 0
    v_mfma_f32_16x16x32_bf16 a[72:75], v[48:51], v[24:27], 0
    ds_read_b64_tr_b16 v[48:49], v17 offset:352
    ds_read_b64_tr_b16 v[50:51], v17 offset:3680
    s_waitcnt lgkmcnt(8)
    v_mfma_f32_16x16x32_bf16 a[28:31], v[52:55], v[20:23], 0
    v_mfma_f32_16x16x32_bf16 a[76:79], v[52:55], v[24:27], 0
    s_add_u32 m0, s29, 54272
    s_nop 0
    buffer_load_dwordx4 v11, s[12:15], s31 offen lds
    ds_read_b64_tr_b16 v[52:53], v17 offset:13312
    ds_read_b64_tr_b16 v[54:55], v17 offset:16640
    s_waitcnt lgkmcnt(8)
    v_mfma_f32_16x16x32_bf16 a[32:35], v[56:59], v[20:23], 0
    v_mfma_f32_16x16x32_bf16 a[80:83], v[56:59], v[24:27], 0
    ds_read_b64_tr_b16 v[56:57], v17 offset:13344
    ds_read_b64_tr_b16 v[58:59], v17 offset:16672
    s_waitcnt lgkmcnt(8)
    v_mfma_f32_16x16x32_bf16 a[36:39], v[60:63], v[20:23], 0
    v_mfma_f32_16x16x32_bf16 a[84:87], v[60:63], v[24:27], 0
    s_add_u32 m0, s29, 55296
    s_nop 0
    buffer_load_dwordx4 v12, s[12:15], s31 offen lds
    ds_read_b64_tr_b16 v[60:61], v17 offset:13376
    ds_read_b64_tr_b16 v[62:63], v17 offset:16704
    s_waitcnt lgkmcnt(8)
    v_mfma_f32_16x16x32_bf16 a[40:43], v[44:47], v[20:23], 0
    v_mfma_f32_16x16x32_bf16 a[88:91], v[44:47], v[24:27], 0
    ds_read_b64_tr_b16 v[44:45], v17 offset:13408
    ds_read_b64_tr_b16 v[46:47], v17 offset:16736
    s_waitcnt lgkmcnt(8)
    v_mfma_f32_16x16x32_bf16 a[44:47], v[48:51], v[20:23], 0
    v_mfma_f32_16x16x32_bf16 a[92:95], v[48:51], v[24:27], 0
    s_add_u32 m0, s29, 56320
    s_mov_b64 exec, 0xffff
    buffer_load_dwordx4 v13, s[12:15], s31 offen lds
    s_mov_b64 exec, -1
    ds_read_b64_tr_b16 v[48:49], v17 offset:13440
    ds_read_b64_tr_b16 v[50:51], v17 offset:16768
    s_waitcnt lgkmcnt(8)
    v_mfma_f32_16x16x32_bf16 a[96:99], v[52:55], v[20:23], 0
    v_mfma_f32_16x16x32_bf16 v[80:83], v[52:55], v[24:27], 0
    ds_read_b64_tr_b16 v[52:53], v17 offset:13472
    ds_read_b64_tr_b16 v[54:55], v17 offset:16800
    s_waitcnt lgkmcnt(8)
    v_mfma_f32_16x16x32_bf16 a[100:103], v[56:59], v[20:23], 0
    v_mfma_f32_16x16x32_bf16 v[84:87], v[56:59], v[24:27], 0
    s_mov_b32 s31, 884736
    s_add_u32 m0, s29, 79872
    s_nop 0
    buffer_load_dwordx4 v10, s[12:15], s31 offen lds
    ds_read_b64_tr_b16 v[56:57], v17 offset:13504
    ds_read_b64_tr_b16 v[58:59], v17 offset:16832
    s_waitcnt lgkmcnt(8)
    v_mfma_f32_16x16x32_bf16 a[104:107], v[60:63], v[20:23], 0
    v_mfma_f32_16x16x32_bf16 v[88:91], v[60:63], v[24:27], 0
    ds_read_b64_tr_b16 v[60:61], v17 offset:13536
    ds_read_b64_tr_b16 v[62:63], v17 offset:16864
    s_waitcnt lgkmcnt(8)
    v_mfma_f32_16x16x32_bf16 a[108:111], v[44:47], v[20:23], 0
    v_mfma_f32_16x16x32_bf16 v[92:95], v[44:47], v[24:27], 0
    s_add_u32 m0, s29, 80896
    s_nop 0
    buffer_load_dwordx4 v11, s[12:15], s31 offen lds
    ds_read_b64_tr_b16 v[44:45], v17 offset:13568
    ds_read_b64_tr_b16 v[46:47], v17 offset:16896
    s_waitcnt lgkmcnt(8)
    v_mfma_f32_16x16x32_bf16 a[112:115], v[48:51], v[20:23], 0
    v_mfma_f32_16x16x32_bf16 v[96:99], v[48:51], v[24:27], 0
    ds_read_b64_tr_b16 v[48:49], v17 offset:13600
    ds_read_b64_tr_b16 v[50:51], v17 offset:16928
    s_waitcnt lgkmcnt(8)
    v_mfma_f32_16x16x32_bf16 a[116:119], v[52:55], v[20:23], 0
    v_mfma_f32_16x16x32_bf16 v[100:103], v[52:55], v[24:27], 0
    s_add_u32 m0, s29, 81920
    s_nop 0
    buffer_load_dwordx4 v12, s[12:15], s31 offen lds
    ds_read_b64_tr_b16 v[52:53], v17 offset:13632
    ds_read_b64_tr_b16 v[54:55], v17 offset:16960
    s_waitcnt lgkmcnt(8)
    v_mfma_f32_16x16x32_bf16 a[120:123], v[56:59], v[20:23], 0
    v_mfma_f32_16x16x32_bf16 v[104:107], v[56:59], v[24:27], 0
    ds_read_b64_tr_b16 v[56:57], v17 offset:13664
    ds_read_b64_tr_b16 v[58:59], v17 offset:16992
    s_waitcnt lgkmcnt(8)
    v_mfma_f32_16x16x32_bf16 a[124:127], v[60:63], v[20:23], 0
    v_mfma_f32_16x16x32_bf16 v[108:111], v[60:63], v[24:27], 0
    s_add_u32 m0, s29, 82944
    s_mov_b64 exec, 0xffff
    buffer_load_dwordx4 v13, s[12:15], s31 offen lds
    s_mov_b64 exec, -1
    s_waitcnt vmcnt(14)
    s_barrier
    v_add_u32 v18, 26624, v16
    ds_read_b64_tr_b16 v[60:61], v18 offset:0
    ds_read_b64_tr_b16 v[62:63], v18 offset:3328
    s_waitcnt lgkmcnt(8)
    v_mfma_f32_16x16x32_bf16 v[64:67], v[44:47], v[20:23], 0
    v_mfma_f32_16x16x32_bf16 v[112:115], v[44:47], v[24:27], 0
    ds_read_b64_tr_b16 v[44:45], v18 offset:32
    ds_read_b64_tr_b16 v[46:47], v18 offset:3360
    s_waitcnt lgkmcnt(8)
    v_mfma_f32_16x16x32_bf16 v[68:71], v[48:51], v[20:23], 0
    v_mfma_f32_16x16x32_bf16 v[116:119], v[48:51], v[24:27], 0
    s_mov_b32 s31, 1179648
    s_add_u32 m0, s29, 106496
    s_nop 0
    buffer_load_dwordx4 v10, s[12:15], s31 offen lds
    ds_read_b64_tr_b16 v[48:49], v18 offset:64
    ds_read_b64_tr_b16 v[50:51], v18 offset:3392
    s_waitcnt lgkmcnt(8)
    v_mfma_f32_16x16x32_bf16 v[72:75], v[52:55], v[20:23], 0
    v_mfma_f32_16x16x32_bf16 v[120:123], v[52:55], v[24:27], 0
    ds_read_b64_tr_b16 v[52:53], v18 offset:96
    ds_read_b64_tr_b16 v[54:55], v18 offset:3424
    s_waitcnt lgkmcnt(8)
    v_mfma_f32_16x16x32_bf16 v[76:79], v[56:59], v[20:23], 0
    v_mfma_f32_16x16x32_bf16 v[124:127], v[56:59], v[24:27], 0
    s_add_u32 m0, s29, 107520
    s_nop 0
    buffer_load_dwordx4 v11, s[12:15], s31 offen lds
    ds_read_b64_tr_b16 v[56:57], v18 offset:128
    ds_read_b64_tr_b16 v[58:59], v18 offset:3456
    s_waitcnt vmcnt(14)
    s_waitcnt lgkmcnt(8)
    v_mfma_f32_16x16x32_bf16 a[0:3], v[60:63], v[28:31], a[0:3]
    v_mfma_f32_16x16x32_bf16 a[48:51], v[60:63], v[32:35], a[48:51]
    ds_read_b64_tr_b16 v[60:61], v18 offset:160
    ds_read_b64_tr_b16 v[62:63], v18 offset:3488
    s_waitcnt lgkmcnt(8)
    v_mfma_f32_16x16x32_bf16 a[4:7], v[44:47], v[28:31], a[4:7]
    v_mfma_f32_16x16x32_bf16 a[52:55], v[44:47], v[32:35], a[52:55]
    s_mov_b32 s32, 3072
    buffer_load_dwordx4 v[20:23], v14, s[8:11], s32 offen
    ds_read_b64_tr_b16 v[44:45], v18 offset:192
    ds_read_b64_tr_b16 v[46:47], v18 offset:3520
    s_waitcnt lgkmcnt(8)
    v_mfma_f32_16x16x32_bf16 a[8:11], v[48:51], v[28:31], a[8:11]
    v_mfma_f32_16x16x32_bf16 a[56:59], v[48:51], v[32:35], a[56:59]
    ds_read_b64_tr_b16 v[48:49], v18 offset:224
    ds_read_b64_tr_b16 v[50:51], v18 offset:3552
    s_waitcnt lgkmcnt(8)
    v_mfma_f32_16x16x32_bf16 a[12:15], v[52:55], v[28:31], a[12:15]
    v_mfma_f32_16x16x32_bf16 a[60:63], v[52:55], v[32:35], a[60:63]
    buffer_load_dwordx4 v[24:27], v15, s[8:11], s32 offen
    ds_read_b64_tr_b16 v[52:53], v18 offset:256
    ds_read_b64_tr_b16 v[54:55], v18 offset:3584
    s_waitcnt lgkmcnt(8)
    v_mfma_f32_16x16x32_bf16 a[16:19], v[56:59], v[28:31], a[16:19]
    v_mfma_f32_16x16x32_bf16 a[64:67], v[56:59], v[32:35], a[64:67]
    ds_read_b64_tr_b16 v[56:57], v18 offset:288
    ds_read_b64_tr_b16 v[58:59], v18 offset:3616
    s_waitcnt lgkmcnt(8)
    v_mfma_f32_16x16x32_bf16 a[20:23], v[60:63], v[28:31], a[20:23]
    v_mfma_f32_16x16x32_bf16 a[68:71], v[60:63], v[32:35], a[68:71]
    s_add_u32 m0, s29, 108544
    s_nop 0
    buffer_load_dwordx4 v12, s[12:15], s31 offen lds
    ds_read_b64_tr_b16 v[60:61], v18 offset:320
    ds_read_b64_tr_b16 v[62:63], v18 offset:3648
    s_waitcnt lgkmcnt(8)
    v_mfma_f32_16x16x32_bf16 a[24:27], v[44:47], v[28:31], a[24:27]
    v_mfma_f32_16x16x32_bf16 a[72:75], v[44:47], v[32:35], a[72:75]
    ds_read_b64_tr_b16 v[44:45], v18 offset:352
    ds_read_b64_tr_b16 v[46:47], v18 offset:3680
    s_waitcnt lgkmcnt(8)
    v_mfma_f32_16x16x32_bf16 a[28:31], v[48:51], v[28:31], a[28:31]
    v_mfma_f32_16x16x32_bf16 a[76:79], v[48:51], v[32:35], a[76:79]
    s_add_u32 m0, s29, 109568
    s_mov_b64 exec, 0xffff
    buffer_load_dwordx4 v13, s[12:15], s31 offen lds
    s_mov_b64 exec, -1
    ds_read_b64_tr_b16 v[48:49], v18 offset:13312
    ds_read_b64_tr_b16 v[50:51], v18 offset:16640
    s_waitcnt lgkmcnt(8)
    v_mfma_f32_16x16x32_bf16 a[32:35], v[52:55], v[28:31], a[32:35]
    v_mfma_f32_16x16x32_bf16 a[80:83], v[52:55], v[32:35], a[80:83]
    ds_read_b64_tr_b16 v[52:53], v18 offset:13344
    ds_read_b64_tr_b16 v[54:55], v18 offset:16672
    s_waitcnt lgkmcnt(8)
    v_mfma_f32_16x16x32_bf16 a[36:39], v[56:59], v[28:31], a[36:39]
    v_mfma_f32_16x16x32_bf16 a[84:87], v[56:59], v[32:35], a[84:87]
    s_mov_b32 s31, 1474560
    s_add_u32 m0, s29, 133120
    s_nop 0
    buffer_load_dwordx4 v10, s[12:15], s31 offen lds
    ds_read_b64_tr_b16 v[56:57], v18 offset:13376
    ds_read_b64_tr_b16 v[58:59], v18 offset:16704
    s_waitcnt lgkmcnt(8)
    v_mfma_f32_16x16x32_bf16 a[40:43], v[60:63], v[28:31], a[40:43]
    v_mfma_f32_16x16x32_bf16 a[88:91], v[60:63], v[32:35], a[88:91]
    ds_read_b64_tr_b16 v[60:61], v18 offset:13408
    ds_read_b64_tr_b16 v[62:63], v18 offset:16736
    s_waitcnt lgkmcnt(8)
    v_mfma_f32_16x16x32_bf16 a[44:47], v[44:47], v[28:31], a[44:47]
    v_mfma_f32_16x16x32_bf16 a[92:95], v[44:47], v[32:35], a[92:95]
    s_add_u32 m0, s29, 134144
    s_nop 0
    buffer_load_dwordx4 v11, s[12:15], s31 offen lds
    ds_read_b64_tr_b16 v[44:45], v18 offset:13440
    ds_read_b64_tr_b16 v[46:47], v18 offset:16768
    s_waitcnt lgkmcnt(8)
    v_mfma_f32_16x16x32_bf16 a[96:99], v[48:51], v[28:31], a[96:99]
    v_mfma_f32_16x16x32_bf16 v[80:83], v[48:51], v[32:35], v[80:83]
    ds_read_b64_tr_b16 v[48:49], v18 offset:13472
    ds_read_b64_tr_b16 v[50:51], v18 offset:16800
    s_waitcnt lgkmcnt(8)
    v_mfma_f32_16x16x32_bf16 a[100:103], v[52:55], v[28:31], a[100:103]
    v_mfma_f32_16x16x32_bf16 v[84:87], v[52:55], v[32:35], v[84:87]
    s_add_u32 m0, s29, 135168
    s_nop 0
    buffer_load_dwordx4 v12, s[12:15], s31 offen lds
    ds_read_b64_tr_b16 v[52:53], v18 offset:13504
    ds_read_b64_tr_b16 v[54:55], v18 offset:16832
    s_waitcnt lgkmcnt(8)
    v_mfma_f32_16x16x32_bf16 a[104:107], v[56:59], v[28:31], a[104:107]
    v_mfma_f32_16x16x32_bf16 v[88:91], v[56:59], v[32:35], v[88:91]
    ds_read_b64_tr_b16 v[56:57], v18 offset:13536
    ds_read_b64_tr_b16 v[58:59], v18 offset:16864
    s_waitcnt lgkmcnt(8)
    v_mfma_f32_16x16x32_bf16 a[108:111], v[60:63], v[28:31], a[108:111]
    v_mfma_f32_16x16x32_bf16 v[92:95], v[60:63], v[32:35], v[92:95]
    s_add_u32 m0, s29, 136192
    s_mov_b64 exec, 0xffff
    buffer_load_dwordx4 v13, s[12:15], s31 offen lds
    s_mov_b64 exec, -1
    ds_read_b64_tr_b16 v[60:61], v18 offset:13568
    ds_read_b64_tr_b16 v[62:63], v18 offset:16896
    s_waitcnt lgkmcnt(8)
    v_mfma_f32_16x16x32_bf16 a[112:115], v[44:47], v[28:31], a[112:115]
    v_mfma_f32_16x16x32_bf16 v[96:99], v[44:47], v[32:35], v[96:99]
    ds_read_b64_tr_b16 v[44:45], v18 offset:13600
    ds_read_b64_tr_b16 v[46:47], v18 offset:16928
    s_waitcnt lgkmcnt(8)
    v_mfma_f32_16x16x32_bf16 a[116:119], v[48:51], v[28:31], a[116:119]
    v_mfma_f32_16x16x32_bf16 v[100:103], v[48:51], v[32:35], v[100:103]
    ds_read_b64_tr_b16 v[48:49], v18 offset:13632
    ds_read_b64_tr_b16 v[50:51], v18 offset:16960
    s_waitcnt lgkmcnt(8)
    v_mfma_f32_16x16x32_bf16 a[120:123], v[52:55], v[28:31], a[120:123]
    v_mfma_f32_16x16x32_bf16 v[104:107], v[52:55], v[32:35], v[104:107]
    ds_read_b64_tr_b16 v[52:53], v18 offset:13664
    ds_read_b64_tr_b16 v[54:55], v18 offset:16992
    s_waitcnt lgkmcnt(8)
    v_mfma_f32_16x16x32_bf16 a[124:127], v[56:59], v[28:31], a[124:127]
    v_mfma_f32_16x16x32_bf16 v[108:111], v[56:59], v[32:35], v[108:111]
    s_waitcnt vmcnt(14)
    s_barrier
    v_add_u32 v17, 53248, v16
    ds_read_b64_tr_b16 v[56:57], v17 offset:0
    ds_read_b64_tr_b16 v[58:59], v17 offset:3328
    s_waitcnt lgkmcnt(8)
    v_mfma_f32_16x16x32_bf16 v[64:67], v[60:63], v[28:31], v[64:67]
    v_mfma_f32_16x16x32_bf16 v[112:115], v[60:63], v[32:35], v[112:115]
    ds_read_b64_tr_b16 v[60:61], v17 offset:32
    ds_read_b64_tr_b16 v[62:63], v17 offset:3360
    s_waitcnt lgkmcnt(8)
    v_mfma_f32_16x16x32_bf16 v[68:71], v[44:47], v[28:31], v[68:71]
    v_mfma_f32_16x16x32_bf16 v[116:119], v[44:47], v[32:35], v[116:119]
    s_mov_b32 s31, 1769472
    s_add_u32 m0, s29, 0
    s_nop 0
    buffer_load_dwordx4 v10, s[12:15], s31 offen lds
    ds_read_b64_tr_b16 v[44:45], v17 offset:64
    ds_read_b64_tr_b16 v[46:47], v17 offset:3392
    s_waitcnt lgkmcnt(8)
    v_mfma_f32_16x16x32_bf16 v[72:75], v[48:51], v[28:31], v[72:75]
    v_mfma_f32_16x16x32_bf16 v[120:123], v[48:51], v[32:35], v[120:123]
    ds_read_b64_tr_b16 v[48:49], v17 offset:96
    ds_read_b64_tr_b16 v[50:51], v17 offset:3424
    s_waitcnt lgkmcnt(8)
    v_mfma_f32_16x16x32_bf16 v[76:79], v[52:55], v[28:31], v[76:79]
    v_mfma_f32_16x16x32_bf16 v[124:127], v[52:55], v[32:35], v[124:127]
    s_add_u32 m0, s29, 1024
    s_nop 0
    buffer_load_dwordx4 v11, s[12:15], s31 offen lds
    ds_read_b64_tr_b16 v[52:53], v17 offset:128
    ds_read_b64_tr_b16 v[54:55], v17 offset:3456
    s_waitcnt lgkmcnt(8)
    v_mfma_f32_16x16x32_bf16 a[0:3], v[56:59], v[36:39], a[0:3]
    v_mfma_f32_16x16x32_bf16 a[48:51], v[56:59], v[40:43], a[48:51]
    ds_read_b64_tr_b16 v[56:57], v17 offset:160
    ds_read_b64_tr_b16 v[58:59], v17 offset:3488
    s_waitcnt lgkmcnt(8)
    v_mfma_f32_16x16x32_bf16 a[4:7], v[60:63], v[36:39], a[4:7]
    v_mfma_f32_16x16x32_bf16 a[52:55], v[60:63], v[40:43], a[52:55]
    s_mov_b32 s32, 4096
    buffer_load_dwordx4 v[28:31], v14, s[8:11], s32 offen
    ds_read_b64_tr_b16 v[60:61], v17 offset:192
    ds_read_b64_tr_b16 v[62:63], v17 offset:3520
    s_waitcnt lgkmcnt(8)
    v_mfma_f32_16x16x32_bf16 a[8:11], v[44:47], v[36:39], a[8:11]
    v_mfma_f32_16x16x32_bf16 a[56:59], v[44:47], v[40:43], a[56:59]
    ds_read_b64_tr_b16 v[44:45], v17 offset:224
    ds_read_b64_tr_b16 v[46:47], v17 offset:3552
    s_waitcnt lgkmcnt(8)
    v_mfma_f32_16x16x32_bf16 a[12:15], v[48:51], v[36:39], a[12:15]
    v_mfma_f32_16x16x32_bf16 a[60:63], v[48:51], v[40:43], a[60:63]
    buffer_load_dwordx4 v[32:35], v15, s[8:11], s32 offen
    ds_read_b64_tr_b16 v[48:49], v17 offset:256
    ds_read_b64_tr_b16 v[50:51], v17 offset:3584
    s_waitcnt lgkmcnt(8)
    v_mfma_f32_16x16x32_bf16 a[16:19], v[52:55], v[36:39], a[16:19]
    v_mfma_f32_16x16x32_bf16 a[64:67], v[52:55], v[40:43], a[64:67]
    ds_read_b64_tr_b16 v[52:53], v17 offset:288
    ds_read_b64_tr_b16 v[54:55], v17 offset:3616
    s_waitcnt lgkmcnt(8)
    v_mfma_f32_16x16x32_bf16 a[20:23], v[56:59], v[36:39], a[20:23]
    v_mfma_f32_16x16x32_bf16 a[68:71], v[56:59], v[40:43], a[68:71]
    s_add_u32 m0, s29, 2048
    s_nop 0
    buffer_load_dwordx4 v12, s[12:15], s31 offen lds
    ds_read_b64_tr_b16 v[56:57], v17 offset:320
    ds_read_b64_tr_b16 v[58:59], v17 offset:3648
    s_waitcnt lgkmcnt(8)
    v_mfma_f32_16x16x32_bf16 a[24:27], v[60:63], v[36:39], a[24:27]
    v_mfma_f32_16x16x32_bf16 a[72:75], v[60:63], v[40:43], a[72:75]
    ds_read_b64_tr_b16 v[60:61], v17 offset:352
    ds_read_b64_tr_b16 v[62:63], v17 offset:3680
    s_waitcnt lgkmcnt(8)
    v_mfma_f32_16x16x32_bf16 a[28:31], v[44:47], v[36:39], a[28:31]
    v_mfma_f32_16x16x32_bf16 a[76:79], v[44:47], v[40:43], a[76:79]
    s_add_u32 m0, s29, 3072
    s_mov_b64 exec, 0xffff
    buffer_load_dwordx4 v13, s[12:15], s31 offen lds
    s_mov_b64 exec, -1
    ds_read_b64_tr_b16 v[44:45], v17 offset:13312
    ds_read_b64_tr_b16 v[46:47], v17 offset:16640
    s_waitcnt lgkmcnt(8)
    v_mfma_f32_16x16x32_bf16 a[32:35], v[48:51], v[36:39], a[32:35]
    v_mfma_f32_16x16x32_bf16 a[80:83], v[48:51], v[40:43], a[80:83]
    ds_read_b64_tr_b16 v[48:49], v17 offset:13344
    ds_read_b64_tr_b16 v[50:51], v17 offset:16672
    s_waitcnt lgkmcnt(8)
    v_mfma_f32_16x16x32_bf16 a[36:39], v[52:55], v[36:39], a[36:39]
    v_mfma_f32_16x16x32_bf16 a[84:87], v[52:55], v[40:43], a[84:87]
    ds_read_b64_tr_b16 v[52:53], v17 offset:13376
    ds_read_b64_tr_b16 v[54:55], v17 offset:16704
    s_waitcnt lgkmcnt(8)
    v_mfma_f32_16x16x32_bf16 a[40:43], v[56:59], v[36:39], a[40:43]
    v_mfma_f32_16x16x32_bf16 a[88:91], v[56:59], v[40:43], a[88:91]
    ds_read_b64_tr_b16 v[56:57], v17 offset:13408
    ds_read_b64_tr_b16 v[58:59], v17 offset:16736
    s_waitcnt lgkmcnt(8)
    v_mfma_f32_16x16x32_bf16 a[44:47], v[60:63], v[36:39], a[44:47]
    v_mfma_f32_16x16x32_bf16 a[92:95], v[60:63], v[40:43], a[92:95]
    ds_read_b64_tr_b16 v[60:61], v17 offset:13440
    ds_read_b64_tr_b16 v[62:63], v17 offset:16768
    s_waitcnt lgkmcnt(8)
    v_mfma_f32_16x16x32_bf16 a[96:99], v[44:47], v[36:39], a[96:99]
    v_mfma_f32_16x16x32_bf16 v[80:83], v[44:47], v[40:43], v[80:83]
    ds_read_b64_tr_b16 v[44:45], v17 offset:13472
    ds_read_b64_tr_b16 v[46:47], v17 offset:16800
    s_waitcnt lgkmcnt(8)
    v_mfma_f32_16x16x32_bf16 a[100:103], v[48:51], v[36:39], a[100:103]
    v_mfma_f32_16x16x32_bf16 v[84:87], v[48:51], v[40:43], v[84:87]
    ds_read_b64_tr_b16 v[48:49], v17 offset:13504
    ds_read_b64_tr_b16 v[50:51], v17 offset:16832
    s_waitcnt lgkmcnt(8)
    v_mfma_f32_16x16x32_bf16 a[104:107], v[52:55], v[36:39], a[104:107]
    v_mfma_f32_16x16x32_bf16 v[88:91], v[52:55], v[40:43], v[88:91]
    ds_read_b64_tr_b16 v[52:53], v17 offset:13536
    ds_read_b64_tr_b16 v[54:55], v17 offset:16864
    s_waitcnt lgkmcnt(8)
    v_mfma_f32_16x16x32_bf16 a[108:111], v[56:59], v[36:39], a[108:111]
    v_mfma_f32_16x16x32_bf16 v[92:95], v[56:59], v[40:43], v[92:95]
    ds_read_b64_tr_b16 v[56:57], v17 offset:13568
    ds_read_b64_tr_b16 v[58:59], v17 offset:16896
    s_waitcnt lgkmcnt(8)
    v_mfma_f32_16x16x32_bf16 a[112:115], v[60:63], v[36:39], a[112:115]
    v_mfma_f32_16x16x32_bf16 v[96:99], v[60:63], v[40:43], v[96:99]
    ds_read_b64_tr_b16 v[60:61], v17 offset:13600
    ds_read_b64_tr_b16 v[62:63], v17 offset:16928
    s_waitcnt lgkmcnt(8)
    v_mfma_f32_16x16x32_bf16 a[116:119], v[44:47], v[36:39], a[116:119]
    v_mfma_f32_16x16x32_bf16 v[100:103], v[44:47], v[40:43], v[100:103]
    ds_read_b64_tr_b16 v[44:45], v17 offset:13632
    ds_read_b64_tr_b16 v[46:47], v17 offset:16960
    s_waitcnt lgkmcnt(8)
    v_mfma_f32_16x16x32_bf16 a[120:123], v[48:51], v[36:39], a[120:123]
    v_mfma_f32_16x16x32_bf16 v[104:107], v[48:51], v[40:43], v[104:107]
    ds_read_b64_tr_b16 v[48:49], v17 offset:13664
    ds_read_b64_tr_b16 v[50:51], v17 offset:16992
    s_waitcnt lgkmcnt(8)
    v_mfma_f32_16x16x32_bf16 a[124:127], v[52:55], v[36:39], a[124:127]
    v_mfma_f32_16x16x32_bf16 v[108:111], v[52:55], v[40:43], v[108:111]
    s_waitcnt vmcnt(16)
    s_barrier
    v_add_u32 v18, 79872, v16
    ds_read_b64_tr_b16 v[52:53], v18 offset:0
    ds_read_b64_tr_b16 v[54:55], v18 offset:3328
    s_waitcnt lgkmcnt(8)
    v_mfma_f32_16x16x32_bf16 v[64:67], v[56:59], v[36:39], v[64:67]
    v_mfma_f32_16x16x32_bf16 v[112:115], v[56:59], v[40:43], v[112:115]
    ds_read_b64_tr_b16 v[56:57], v18 offset:32
    ds_read_b64_tr_b16 v[58:59], v18 offset:3360
    s_waitcnt lgkmcnt(8)
    v_mfma_f32_16x16x32_bf16 v[68:71], v[60:63], v[36:39], v[68:71]
    v_mfma_f32_16x16x32_bf16 v[116:119], v[60:63], v[40:43], v[116:119]
    s_mov_b32 s31, 2064384
    s_add_u32 m0, s29, 26624
    s_nop 0
    buffer_load_dwordx4 v10, s[12:15], s31 offen lds
    ds_read_b64_tr_b16 v[60:61], v18 offset:64
    ds_read_b64_tr_b16 v[62:63], v18 offset:3392
    s_waitcnt lgkmcnt(8)
    v_mfma_f32_16x16x32_bf16 v[72:75], v[44:47], v[36:39], v[72:75]
    v_mfma_f32_16x16x32_bf16 v[120:123], v[44:47], v[40:43], v[120:123]
    ds_read_b64_tr_b16 v[44:45], v18 offset:96
    ds_read_b64_tr_b16 v[46:47], v18 offset:3424
    s_waitcnt lgkmcnt(8)
    v_mfma_f32_16x16x32_bf16 v[76:79], v[48:51], v[36:39], v[76:79]
    v_mfma_f32_16x16x32_bf16 v[124:127], v[48:51], v[40:43], v[124:127]
    s_add_u32 m0, s29, 27648
    s_nop 0
    buffer_load_dwordx4 v11, s[12:15], s31 offen lds
    ds_read_b64_tr_b16 v[48:49], v18 offset:128
    ds_read_b64_tr_b16 v[50:51], v18 offset:3456
    s_waitcnt vmcnt(14)
    s_waitcnt lgkmcnt(8)
    v_mfma_f32_16x16x32_bf16 a[0:3], v[52:55], v[20:23], a[0:3]
    v_mfma_f32_16x16x32_bf16 a[48:51], v[52:55], v[24:27], a[48:51]
    ds_read_b64_tr_b16 v[52:53], v18 offset:160
    ds_read_b64_tr_b16 v[54:55], v18 offset:3488
    s_waitcnt lgkmcnt(8)
    v_mfma_f32_16x16x32_bf16 a[4:7], v[56:59], v[20:23], a[4:7]
    v_mfma_f32_16x16x32_bf16 a[52:55], v[56:59], v[24:27], a[52:55]
    s_mov_b32 s32, 5120
    buffer_load_dwordx4 v[36:39], v14, s[8:11], s32 offen
    ds_read_b64_tr_b16 v[56:57], v18 offset:192
    ds_read_b64_tr_b16 v[58:59], v18 offset:3520
    s_waitcnt lgkmcnt(8)
    v_mfma_f32_16x16x32_bf16 a[8:11], v[60:63], v[20:23], a[8:11]
    v_mfma_f32_16x16x32_bf16 a[56:59], v[60:63], v[24:27], a[56:59]
    ds_read_b64_tr_b16 v[60:61], v18 offset:224
    ds_read_b64_tr_b16 v[62:63], v18 offset:3552
    s_waitcnt lgkmcnt(8)
    v_mfma_f32_16x16x32_bf16 a[12:15], v[44:47], v[20:23], a[12:15]
    v_mfma_f32_16x16x32_bf16 a[60:63], v[44:47], v[24:27], a[60:63]
    buffer_load_dwordx4 v[40:43], v15, s[8:11], s32 offen
    ds_read_b64_tr_b16 v[44:45], v18 offset:256
    ds_read_b64_tr_b16 v[46:47], v18 offset:3584
    s_waitcnt lgkmcnt(8)
    v_mfma_f32_16x16x32_bf16 a[16:19], v[48:51], v[20:23], a[16:19]
    v_mfma_f32_16x16x32_bf16 a[64:67], v[48:51], v[24:27], a[64:67]
    ds_read_b64_tr_b16 v[48:49], v18 offset:288
    ds_read_b64_tr_b16 v[50:51], v18 offset:3616
    s_waitcnt lgkmcnt(8)
    v_mfma_f32_16x16x32_bf16 a[20:23], v[52:55], v[20:23], a[20:23]
    v_mfma_f32_16x16x32_bf16 a[68:71], v[52:55], v[24:27], a[68:71]
    s_add_u32 m0, s29, 28672
    s_nop 0
    buffer_load_dwordx4 v12, s[12:15], s31 offen lds
    ds_read_b64_tr_b16 v[52:53], v18 offset:320
    ds_read_b64_tr_b16 v[54:55], v18 offset:3648
    s_waitcnt lgkmcnt(8)
    v_mfma_f32_16x16x32_bf16 a[24:27], v[56:59], v[20:23], a[24:27]
    v_mfma_f32_16x16x32_bf16 a[72:75], v[56:59], v[24:27], a[72:75]
    ds_read_b64_tr_b16 v[56:57], v18 offset:352
    ds_read_b64_tr_b16 v[58:59], v18 offset:3680
    s_waitcnt lgkmcnt(8)
    v_mfma_f32_16x16x32_bf16 a[28:31], v[60:63], v[20:23], a[28:31]
    v_mfma_f32_16x16x32_bf16 a[76:79], v[60:63], v[24:27], a[76:79]
    s_add_u32 m0, s29, 29696
    s_mov_b64 exec, 0xffff
    buffer_load_dwordx4 v13, s[12:15], s31 offen lds
    s_mov_b64 exec, -1
    ds_read_b64_tr_b16 v[60:61], v18 offset:13312
    ds_read_b64_tr_b16 v[62:63], v18 offset:16640
    s_waitcnt lgkmcnt(8)
    v_mfma_f32_16x16x32_bf16 a[32:35], v[44:47], v[20:23], a[32:35]
    v_mfma_f32_16x16x32_bf16 a[80:83], v[44:47], v[24:27], a[80:83]
    ds_read_b64_tr_b16 v[44:45], v18 offset:13344
    ds_read_b64_tr_b16 v[46:47], v18 offset:16672
    s_waitcnt lgkmcnt(8)
    v_mfma_f32_16x16x32_bf16 a[36:39], v[48:51], v[20:23], a[36:39]
    v_mfma_f32_16x16x32_bf16 a[84:87], v[48:51], v[24:27], a[84:87]
    ds_read_b64_tr_b16 v[48:49], v18 offset:13376
    ds_read_b64_tr_b16 v[50:51], v18 offset:16704
    s_waitcnt lgkmcnt(8)
    v_mfma_f32_16x16x32_bf16 a[40:43], v[52:55], v[20:23], a[40:43]
    v_mfma_f32_16x16x32_bf16 a[88:91], v[52:55], v[24:27], a[88:91]
    ds_read_b64_tr_b16 v[52:53], v18 offset:13408
    ds_read_b64_tr_b16 v[54:55], v18 offset:16736
    s_waitcnt lgkmcnt(8)
    v_mfma_f32_16x16x32_bf16 a[44:47], v[56:59], v[20:23], a[44:47]
    v_mfma_f32_16x16x32_bf16 a[92:95], v[56:59], v[24:27], a[92:95]
    ds_read_b64_tr_b16 v[56:57], v18 offset:13440
    ds_read_b64_tr_b16 v[58:59], v18 offset:16768
    s_waitcnt lgkmcnt(8)
    v_mfma_f32_16x16x32_bf16 a[96:99], v[60:63], v[20:23], a[96:99]
    v_mfma_f32_16x16x32_bf16 v[80:83], v[60:63], v[24:27], v[80:83]
    ds_read_b64_tr_b16 v[60:61], v18 offset:13472
    ds_read_b64_tr_b16 v[62:63], v18 offset:16800
    s_waitcnt lgkmcnt(8)
    v_mfma_f32_16x16x32_bf16 a[100:103], v[44:47], v[20:23], a[100:103]
    v_mfma_f32_16x16x32_bf16 v[84:87], v[44:47], v[24:27], v[84:87]
    ds_read_b64_tr_b16 v[44:45], v18 offset:13504
    ds_read_b64_tr_b16 v[46:47], v18 offset:16832
    s_waitcnt lgkmcnt(8)
    v_mfma_f32_16x16x32_bf16 a[104:107], v[48:51], v[20:23], a[104:107]
    v_mfma_f32_16x16x32_bf16 v[88:91], v[48:51], v[24:27], v[88:91]
    ds_read_b64_tr_b16 v[48:49], v18 offset:13536
    ds_read_b64_tr_b16 v[50:51], v18 offset:16864
    s_waitcnt lgkmcnt(8)
    v_mfma_f32_16x16x32_bf16 a[108:111], v[52:55], v[20:23], a[108:111]
    v_mfma_f32_16x16x32_bf16 v[92:95], v[52:55], v[24:27], v[92:95]
    ds_read_b64_tr_b16 v[52:53], v18 offset:13568
    ds_read_b64_tr_b16 v[54:55], v18 offset:16896
    s_waitcnt lgkmcnt(8)
    v_mfma_f32_16x16x32_bf16 a[112:115], v[56:59], v[20:23], a[112:115]
    v_mfma_f32_16x16x32_bf16 v[96:99], v[56:59], v[24:27], v[96:99]
    ds_read_b64_tr_b16 v[56:57], v18 offset:13600
    ds_read_b64_tr_b16 v[58:59], v18 offset:16928
    s_waitcnt lgkmcnt(8)
    v_mfma_f32_16x16x32_bf16 a[116:119], v[60:63], v[20:23], a[116:119]
    v_mfma_f32_16x16x32_bf16 v[100:103], v[60:63], v[24:27], v[100:103]
    ds_read_b64_tr_b16 v[60:61], v18 offset:13632
    ds_read_b64_tr_b16 v[62:63], v18 offset:16960
    s_waitcnt lgkmcnt(8)
    v_mfma_f32_16x16x32_bf16 a[120:123], v[44:47], v[20:23], a[120:123]
    v_mfma_f32_16x16x32_bf16 v[104:107], v[44:47], v[24:27], v[104:107]
    ds_read_b64_tr_b16 v[44:45], v18 offset:13664
    ds_read_b64_tr_b16 v[46:47], v18 offset:16992
    s_waitcnt lgkmcnt(8)
    v_mfma_f32_16x16x32_bf16 a[124:127], v[48:51], v[20:23], a[124:127]
    v_mfma_f32_16x16x32_bf16 v[108:111], v[48:51], v[24:27], v[108:111]
    s_waitcnt vmcnt(16)
    s_barrier
    v_add_u32 v17, 106496, v16
    ds_read_b64_tr_b16 v[48:49], v17 offset:0
    ds_read_b64_tr_b16 v[50:51], v17 offset:3328
    s_waitcnt lgkmcnt(8)
    v_mfma_f32_16x16x32_bf16 v[64:67], v[52:55], v[20:23], v[64:67]
    v_mfma_f32_16x16x32_bf16 v[112:115], v[52:55], v[24:27], v[112:115]
    ds_read_b64_tr_b16 v[52:53], v17 offset:32
    ds_read_b64_tr_b16 v[54:55], v17 offset:3360
    s_waitcnt lgkmcnt(8)
    v_mfma_f32_16x16x32_bf16 v[68:71], v[56:59], v[20:23], v[68:71]
    v_mfma_f32_16x16x32_bf16 v[116:119], v[56:59], v[24:27], v[116:119]
    s_mov_b32 s31, 2359296
    s_add_u32 m0, s29, 53248
    s_nop 0
    buffer_load_dwordx4 v10, s[12:15], s31 offen lds
    ds_read_b64_tr_b16 v[56:57], v17 offset:64
    ds_read_b64_tr_b16 v[58:59], v17 offset:3392
    s_waitcnt lgkmcnt(8)
    v_mfma_f32_16x16x32_bf16 v[72:75], v[60:63], v[20:23], v[72:75]
    v_mfma_f32_16x16x32_bf16 v[120:123], v[60:63], v[24:27], v[120:123]
    ds_read_b64_tr_b16 v[60:61], v17 offset:96
    ds_read_b64_tr_b16 v[62:63], v17 offset:3424
    s_waitcnt lgkmcnt(8)
    v_mfma_f32_16x16x32_bf16 v[76:79], v[44:47], v[20:23], v[76:79]
    v_mfma_f32_16x16x32_bf16 v[124:127], v[44:47], v[24:27], v[124:127]
    s_add_u32 m0, s29, 54272
    s_nop 0
    buffer_load_dwordx4 v11, s[12:15], s31 offen lds
    ds_read_b64_tr_b16 v[44:45], v17 offset:128
    ds_read_b64_tr_b16 v[46:47], v17 offset:3456
    s_waitcnt vmcnt(10)
    s_waitcnt lgkmcnt(8)
    v_mfma_f32_16x16x32_bf16 a[0:3], v[48:51], v[28:31], a[0:3]
    v_mfma_f32_16x16x32_bf16 a[48:51], v[48:51], v[32:35], a[48:51]
    ds_read_b64_tr_b16 v[48:49], v17 offset:160
    ds_read_b64_tr_b16 v[50:51], v17 offset:3488
    s_waitcnt lgkmcnt(8)
    v_mfma_f32_16x16x32_bf16 a[4:7], v[52:55], v[28:31], a[4:7]
    v_mfma_f32_16x16x32_bf16 a[52:55], v[52:55], v[32:35], a[52:55]
    s_mov_b32 s32, 6144
    buffer_load_dwordx4 v[20:23], v14, s[8:11], s32 offen
    ds_read_b64_tr_b16 v[52:53], v17 offset:192
    ds_read_b64_tr_b16 v[54:55], v17 offset:3520
    s_waitcnt lgkmcnt(8)
    v_mfma_f32_16x16x32_bf16 a[8:11], v[56:59], v[28:31], a[8:11]
    v_mfma_f32_16x16x32_bf16 a[56:59], v[56:59], v[32:35], a[56:59]
    ds_read_b64_tr_b16 v[56:57], v17 offset:224
    ds_read_b64_tr_b16 v[58:59], v17 offset:3552
    s_waitcnt lgkmcnt(8)
    v_mfma_f32_16x16x32_bf16 a[12:15], v[60:63], v[28:31], a[12:15]
    v_mfma_f32_16x16x32_bf16 a[60:63], v[60:63], v[32:35], a[60:63]
    buffer_load_dwordx4 v[24:27], v15, s[8:11], s32 offen
    ds_read_b64_tr_b16 v[60:61], v17 offset:256
    ds_read_b64_tr_b16 v[62:63], v17 offset:3584
    s_waitcnt lgkmcnt(8)
    v_mfma_f32_16x16x32_bf16 a[16:19], v[44:47], v[28:31], a[16:19]
    v_mfma_f32_16x16x32_bf16 a[64:67], v[44:47], v[32:35], a[64:67]
    ds_read_b64_tr_b16 v[44:45], v17 offset:288
    ds_read_b64_tr_b16 v[46:47], v17 offset:3616
    s_waitcnt lgkmcnt(8)
    v_mfma_f32_16x16x32_bf16 a[20:23], v[48:51], v[28:31], a[20:23]
    v_mfma_f32_16x16x32_bf16 a[68:71], v[48:51], v[32:35], a[68:71]
    s_add_u32 m0, s29, 55296
    s_nop 0
    buffer_load_dwordx4 v12, s[12:15], s31 offen lds
    ds_read_b64_tr_b16 v[48:49], v17 offset:320
    ds_read_b64_tr_b16 v[50:51], v17 offset:3648
    s_waitcnt lgkmcnt(8)
    v_mfma_f32_16x16x32_bf16 a[24:27], v[52:55], v[28:31], a[24:27]
    v_mfma_f32_16x16x32_bf16 a[72:75], v[52:55], v[32:35], a[72:75]
    ds_read_b64_tr_b16 v[52:53], v17 offset:352
    ds_read_b64_tr_b16 v[54:55], v17 offset:3680
    s_waitcnt lgkmcnt(8)
    v_mfma_f32_16x16x32_bf16 a[28:31], v[56:59], v[28:31], a[28:31]
    v_mfma_f32_16x16x32_bf16 a[76:79], v[56:59], v[32:35], a[76:79]
    s_add_u32 m0, s29, 56320
    s_mov_b64 exec, 0xffff
    buffer_load_dwordx4 v13, s[12:15], s31 offen lds
    s_mov_b64 exec, -1
    ds_read_b64_tr_b16 v[56:57], v17 offset:13312
    ds_read_b64_tr_b16 v[58:59], v17 offset:16640
    s_waitcnt lgkmcnt(8)
    v_mfma_f32_16x16x32_bf16 a[32:35], v[60:63], v[28:31], a[32:35]
    v_mfma_f32_16x16x32_bf16 a[80:83], v[60:63], v[32:35], a[80:83]
    ds_read_b64_tr_b16 v[60:61], v17 offset:13344
    ds_read_b64_tr_b16 v[62:63], v17 offset:16672
    s_waitcnt lgkmcnt(8)
    v_mfma_f32_16x16x32_bf16 a[36:39], v[44:47], v[28:31], a[36:39]
    v_mfma_f32_16x16x32_bf16 a[84:87], v[44:47], v[32:35], a[84:87]
    buffer_load_dword v2, v9, s[44:47], s25 offen
    buffer_load_dword v3, v9, s[48:51], s34 offen
    s_add_u32 s25, s25, 4096
    s_add_u32 s34, s34, 4096
    ds_read_b64_tr_b16 v[44:45], v17 offset:13376
    ds_read_b64_tr_b16 v[46:47], v17 offset:16704
    s_waitcnt lgkmcnt(8)
    v_mfma_f32_16x16x32_bf16 a[40:43], v[48:51], v[28:31], a[40:43]
    v_mfma_f32_16x16x32_bf16 a[88:91], v[48:51], v[32:35], a[88:91]
    ds_read_b64_tr_b16 v[48:49], v17 offset:13408
    ds_read_b64_tr_b16 v[50:51], v17 offset:16736
    s_waitcnt lgkmcnt(8)
    v_mfma_f32_16x16x32_bf16 a[44:47], v[52:55], v[28:31], a[44:47]
    v_mfma_f32_16x16x32_bf16 a[92:95], v[52:55], v[32:35], a[92:95]
    buffer_load_dword v2, v9, s[44:47], s25 offen
    buffer_load_dword v3, v9, s[48:51], s34 offen
    s_add_u32 s25, s25, 4096
    s_add_u32 s34, s34, 4096
    ds_read_b64_tr_b16 v[52:53], v17 offset:13440
    ds_read_b64_tr_b16 v[54:55], v17 offset:16768
    s_waitcnt lgkmcnt(8)
    v_mfma_f32_16x16x32_bf16 a[96:99], v[56:59], v[28:31], a[96:99]
    v_mfma_f32_16x16x32_bf16 v[80:83], v[56:59], v[32:35], v[80:83]
    ds_read_b64_tr_b16 v[56:57], v17 offset:13472
    ds_read_b64_tr_b16 v[58:59], v17 offset:16800
    s_waitcnt lgkmcnt(8)
    v_mfma_f32_16x16x32_bf16 a[100:103], v[60:63], v[28:31], a[100:103]
    v_mfma_f32_16x16x32_bf16 v[84:87], v[60:63], v[32:35], v[84:87]
    ds_read_b64_tr_b16 v[60:61], v17 offset:13504
    ds_read_b64_tr_b16 v[62:63], v17 offset:16832
    s_waitcnt lgkmcnt(8)
    v_mfma_f32_16x16x32_bf16 a[104:107], v[44:47], v[28:31], a[104:107]
    v_mfma_f32_16x16x32_bf16 v[88:91], v[44:47], v[32:35], v[88:91]
    ds_read_b64_tr_b16 v[44:45], v17 offset:13536
    ds_read_b64_tr_b16 v[46:47], v17 offset:16864
    s_waitcnt lgkmcnt(8)
    v_mfma_f32_16x16x32_bf16 a[108:111], v[48:51], v[28:31], a[108:111]
    v_mfma_f32_16x16x32_bf16 v[92:95], v[48:51], v[32:35], v[92:95]
    ds_read_b64_tr_b16 v[48:49], v17 offset:13568
    ds_read_b64_tr_b16 v[50:51], v17 offset:16896
    s_waitcnt lgkmcnt(8)
    v_mfma_f32_16x16x32_bf16 a[112:115], v[52:55], v[28:31], a[112:115]
    v_mfma_f32_16x16x32_bf16 v[96:99], v[52:55], v[32:35], v[96:99]
    ds_read_b64_tr_b16 v[52:53], v17 offset:13600
    ds_read_b64_tr_b16 v[54:55], v17 offset:16928
    s_waitcnt lgkmcnt(8)
    v_mfma_f32_16x16x32_bf16 a[116:119], v[56:59], v[28:31], a[116:119]
    v_mfma_f32_16x16x32_bf16 v[100:103], v[56:59], v[32:35], v[100:103]
    ds_read_b64_tr_b16 v[56:57], v17 offset:13632
    ds_read_b64_tr_b16 v[58:59], v17 offset:16960
    s_waitcnt lgkmcnt(8)
    v_mfma_f32_16x16x32_bf16 a[120:123], v[60:63], v[28:31], a[120:123]
    v_mfma_f32_16x16x32_bf16 v[104:107], v[60:63], v[32:35], v[104:107]
    ds_read_b64_tr_b16 v[60:61], v17 offset:13664
    ds_read_b64_tr_b16 v[62:63], v17 offset:16992
    s_waitcnt lgkmcnt(8)
    v_mfma_f32_16x16x32_bf16 a[124:127], v[44:47], v[28:31], a[124:127]
    v_mfma_f32_16x16x32_bf16 v[108:111], v[44:47], v[32:35], v[108:111]
    s_barrier
    v_add_u32 v18, 133120, v16
    ds_read_b64_tr_b16 v[44:45], v18 offset:0
    ds_read_b64_tr_b16 v[46:47], v18 offset:3328
    s_waitcnt lgkmcnt(8)
    v_mfma_f32_16x16x32_bf16 v[64:67], v[48:51], v[28:31], v[64:67]
    v_mfma_f32_16x16x32_bf16 v[112:115], v[48:51], v[32:35], v[112:115]
    ds_read_b64_tr_b16 v[48:49], v18 offset:32
    ds_read_b64_tr_b16 v[50:51], v18 offset:3360
    s_waitcnt lgkmcnt(8)
    v_mfma_f32_16x16x32_bf16 v[68:71], v[52:55], v[28:31], v[68:71]
    v_mfma_f32_16x16x32_bf16 v[116:119], v[52:55], v[32:35], v[116:119]
    s_mov_b32 s31, 2654208
    s_add_u32 m0, s29, 79872
    s_nop 0
    buffer_load_dwordx4 v10, s[12:15], s31 offen lds
    ds_read_b64_tr_b16 v[52:53], v18 offset:64
    ds_read_b64_tr_b16 v[54:55], v18 offset:3392
    s_waitcnt lgkmcnt(8)
    v_mfma_f32_16x16x32_bf16 v[72:75], v[56:59], v[28:31], v[72:75]
    v_mfma_f32_16x16x32_bf16 v[120:123], v[56:59], v[32:35], v[120:123]
    ds_read_b64_tr_b16 v[56:57], v18 offset:96
    ds_read_b64_tr_b16 v[58:59], v18 offset:3424
    s_waitcnt lgkmcnt(8)
    v_mfma_f32_16x16x32_bf16 v[76:79], v[60:63], v[28:31], v[76:79]
    v_mfma_f32_16x16x32_bf16 v[124:127], v[60:63], v[32:35], v[124:127]
    s_add_u32 m0, s29, 80896
    s_nop 0
    buffer_load_dwordx4 v11, s[12:15], s31 offen lds
    ds_read_b64_tr_b16 v[60:61], v18 offset:128
    ds_read_b64_tr_b16 v[62:63], v18 offset:3456
    s_waitcnt vmcnt(14)
    s_waitcnt lgkmcnt(8)
    v_mfma_f32_16x16x32_bf16 a[0:3], v[44:47], v[36:39], a[0:3]
    v_mfma_f32_16x16x32_bf16 a[48:51], v[44:47], v[40:43], a[48:51]
    ds_read_b64_tr_b16 v[44:45], v18 offset:160
    ds_read_b64_tr_b16 v[46:47], v18 offset:3488
    s_waitcnt lgkmcnt(8)
    v_mfma_f32_16x16x32_bf16 a[4:7], v[48:51], v[36:39], a[4:7]
    v_mfma_f32_16x16x32_bf16 a[52:55], v[48:51], v[40:43], a[52:55]
    s_mov_b32 s32, 7168
    buffer_load_dwordx4 v[28:31], v14, s[8:11], s32 offen
    ds_read_b64_tr_b16 v[48:49], v18 offset:192
    ds_read_b64_tr_b16 v[50:51], v18 offset:3520
    s_waitcnt lgkmcnt(8)
    v_mfma_f32_16x16x32_bf16 a[8:11], v[52:55], v[36:39], a[8:11]
    v_mfma_f32_16x16x32_bf16 a[56:59], v[52:55], v[40:43], a[56:59]
    ds_read_b64_tr_b16 v[52:53], v18 offset:224
    ds_read_b64_tr_b16 v[54:55], v18 offset:3552
    s_waitcnt lgkmcnt(8)
    v_mfma_f32_16x16x32_bf16 a[12:15], v[56:59], v[36:39], a[12:15]
    v_mfma_f32_16x16x32_bf16 a[60:63], v[56:59], v[40:43], a[60:63]
    buffer_load_dwordx4 v[32:35], v15, s[8:11], s32 offen
    ds_read_b64_tr_b16 v[56:57], v18 offset:256
    ds_read_b64_tr_b16 v[58:59], v18 offset:3584
    s_waitcnt lgkmcnt(8)
    v_mfma_f32_16x16x32_bf16 a[16:19], v[60:63], v[36:39], a[16:19]
    v_mfma_f32_16x16x32_bf16 a[64:67], v[60:63], v[40:43], a[64:67]
    ds_read_b64_tr_b16 v[60:61], v18 offset:288
    ds_read_b64_tr_b16 v[62:63], v18 offset:3616
    s_waitcnt lgkmcnt(8)
    v_mfma_f32_16x16x32_bf16 a[20:23], v[44:47], v[36:39], a[20:23]
    v_mfma_f32_16x16x32_bf16 a[68:71], v[44:47], v[40:43], a[68:71]
    s_add_u32 m0, s29, 81920
    s_nop 0
    buffer_load_dwordx4 v12, s[12:15], s31 offen lds
    ds_read_b64_tr_b16 v[44:45], v18 offset:320
    ds_read_b64_tr_b16 v[46:47], v18 offset:3648
    s_waitcnt lgkmcnt(8)
    v_mfma_f32_16x16x32_bf16 a[24:27], v[48:51], v[36:39], a[24:27]
    v_mfma_f32_16x16x32_bf16 a[72:75], v[48:51], v[40:43], a[72:75]
    ds_read_b64_tr_b16 v[48:49], v18 offset:352
    ds_read_b64_tr_b16 v[50:51], v18 offset:3680
    s_waitcnt lgkmcnt(8)
    v_mfma_f32_16x16x32_bf16 a[28:31], v[52:55], v[36:39], a[28:31]
    v_mfma_f32_16x16x32_bf16 a[76:79], v[52:55], v[40:43], a[76:79]
    s_add_u32 m0, s29, 82944
    s_mov_b64 exec, 0xffff
    buffer_load_dwordx4 v13, s[12:15], s31 offen lds
    s_mov_b64 exec, -1
    ds_read_b64_tr_b16 v[52:53], v18 offset:13312
    ds_read_b64_tr_b16 v[54:55], v18 offset:16640
    s_waitcnt lgkmcnt(8)
    v_mfma_f32_16x16x32_bf16 a[32:35], v[56:59], v[36:39], a[32:35]
    v_mfma_f32_16x16x32_bf16 a[80:83], v[56:59], v[40:43], a[80:83]
    ds_read_b64_tr_b16 v[56:57], v18 offset:13344
    ds_read_b64_tr_b16 v[58:59], v18 offset:16672
    s_waitcnt lgkmcnt(8)
    v_mfma_f32_16x16x32_bf16 a[36:39], v[60:63], v[36:39], a[36:39]
    v_mfma_f32_16x16x32_bf16 a[84:87], v[60:63], v[40:43], a[84:87]
    ds_read_b64_tr_b16 v[60:61], v18 offset:13376
    ds_read_b64_tr_b16 v[62:63], v18 offset:16704
    s_waitcnt lgkmcnt(8)
    v_mfma_f32_16x16x32_bf16 a[40:43], v[44:47], v[36:39], a[40:43]
    v_mfma_f32_16x16x32_bf16 a[88:91], v[44:47], v[40:43], a[88:91]
    ds_read_b64_tr_b16 v[44:45], v18 offset:13408
    ds_read_b64_tr_b16 v[46:47], v18 offset:16736
    s_waitcnt lgkmcnt(8)
    v_mfma_f32_16x16x32_bf16 a[44:47], v[48:51], v[36:39], a[44:47]
    v_mfma_f32_16x16x32_bf16 a[92:95], v[48:51], v[40:43], a[92:95]
    ds_read_b64_tr_b16 v[48:49], v18 offset:13440
    ds_read_b64_tr_b16 v[50:51], v18 offset:16768
    s_waitcnt lgkmcnt(8)
    v_mfma_f32_16x16x32_bf16 a[96:99], v[52:55], v[36:39], a[96:99]
    v_mfma_f32_16x16x32_bf16 v[80:83], v[52:55], v[40:43], v[80:83]
    ds_read_b64_tr_b16 v[52:53], v18 offset:13472
    ds_read_b64_tr_b16 v[54:55], v18 offset:16800
    s_waitcnt lgkmcnt(8)
    v_mfma_f32_16x16x32_bf16 a[100:103], v[56:59], v[36:39], a[100:103]
    v_mfma_f32_16x16x32_bf16 v[84:87], v[56:59], v[40:43], v[84:87]
    ds_read_b64_tr_b16 v[56:57], v18 offset:13504
    ds_read_b64_tr_b16 v[58:59], v18 offset:16832
    s_waitcnt lgkmcnt(8)
    v_mfma_f32_16x16x32_bf16 a[104:107], v[60:63], v[36:39], a[104:107]
    v_mfma_f32_16x16x32_bf16 v[88:91], v[60:63], v[40:43], v[88:91]
    ds_read_b64_tr_b16 v[60:61], v18 offset:13536
    ds_read_b64_tr_b16 v[62:63], v18 offset:16864
    s_waitcnt lgkmcnt(8)
    v_mfma_f32_16x16x32_bf16 a[108:111], v[44:47], v[36:39], a[108:111]
    v_mfma_f32_16x16x32_bf16 v[92:95], v[44:47], v[40:43], v[92:95]
    ds_read_b64_tr_b16 v[44:45], v18 offset:13568
    ds_read_b64_tr_b16 v[46:47], v18 offset:16896
    s_waitcnt lgkmcnt(8)
    v_mfma_f32_16x16x32_bf16 a[112:115], v[48:51], v[36:39], a[112:115]
    v_mfma_f32_16x16x32_bf16 v[96:99], v[48:51], v[40:43], v[96:99]
    ds_read_b64_tr_b16 v[48:49], v18 offset:13600
    ds_read_b64_tr_b16 v[50:51], v18 offset:16928
    s_waitcnt lgkmcnt(8)
    v_mfma_f32_16x16x32_bf16 a[116:119], v[52:55], v[36:39], a[116:119]
    v_mfma_f32_16x16x32_bf16 v[100:103], v[52:55], v[40:43], v[100:103]
    ds_read_b64_tr_b16 v[52:53], v18 offset:13632
    ds_read_b64_tr_b16 v[54:55], v18 offset:16960
    s_waitcnt lgkmcnt(8)
    v_mfma_f32_16x16x32_bf16 a[120:123], v[56:59], v[36:39], a[120:123]
    v_mfma_f32_16x16x32_bf16 v[104:107], v[56:59], v[40:43], v[104:107]
    ds_read_b64_tr_b16 v[56:57], v18 offset:13664
    ds_read_b64_tr_b16 v[58:59], v18 offset:16992
    s_waitcnt lgkmcnt(8)
    v_mfma_f32_16x16x32_bf16 a[124:127], v[60:63], v[36:39], a[124:127]
    v_mfma_f32_16x16x32_bf16 v[108:111], v[60:63], v[40:43], v[108:111]
    s_barrier
    v_add_u32 v17, 0, v16
    ds_read_b64_tr_b16 v[60:61], v17 offset:0
    ds_read_b64_tr_b16 v[62:63], v17 offset:3328
    s_waitcnt lgkmcnt(8)
    v_mfma_f32_16x16x32_bf16 v[64:67], v[44:47], v[36:39], v[64:67]
    v_mfma_f32_16x16x32_bf16 v[112:115], v[44:47], v[40:43], v[112:115]
    ds_read_b64_tr_b16 v[44:45], v17 offset:32
    ds_read_b64_tr_b16 v[46:47], v17 offset:3360
    s_waitcnt lgkmcnt(8)
    v_mfma_f32_16x16x32_bf16 v[68:71], v[48:51], v[36:39], v[68:71]
    v_mfma_f32_16x16x32_bf16 v[116:119], v[48:51], v[40:43], v[116:119]
    s_mov_b32 s31, 2949120
    s_add_u32 m0, s29, 106496
    s_nop 0
    buffer_load_dwordx4 v10, s[12:15], s31 offen lds
    ds_read_b64_tr_b16 v[48:49], v17 offset:64
    ds_read_b64_tr_b16 v[50:51], v17 offset:3392
    s_waitcnt lgkmcnt(8)
    v_mfma_f32_16x16x32_bf16 v[72:75], v[52:55], v[36:39], v[72:75]
    v_mfma_f32_16x16x32_bf16 v[120:123], v[52:55], v[40:43], v[120:123]
    ds_read_b64_tr_b16 v[52:53], v17 offset:96
    ds_read_b64_tr_b16 v[54:55], v17 offset:3424
    s_waitcnt lgkmcnt(8)
    v_mfma_f32_16x16x32_bf16 v[76:79], v[56:59], v[36:39], v[76:79]
    v_mfma_f32_16x16x32_bf16 v[124:127], v[56:59], v[40:43], v[124:127]
    s_add_u32 m0, s29, 107520
    s_nop 0
    buffer_load_dwordx4 v11, s[12:15], s31 offen lds
    ds_read_b64_tr_b16 v[56:57], v17 offset:128
    ds_read_b64_tr_b16 v[58:59], v17 offset:3456
    s_waitcnt vmcnt(14)
    s_waitcnt lgkmcnt(8)
    v_mfma_f32_16x16x32_bf16 a[0:3], v[60:63], v[20:23], a[0:3]
    v_mfma_f32_16x16x32_bf16 a[48:51], v[60:63], v[24:27], a[48:51]
    ds_read_b64_tr_b16 v[60:61], v17 offset:160
    ds_read_b64_tr_b16 v[62:63], v17 offset:3488
    s_waitcnt lgkmcnt(8)
    v_mfma_f32_16x16x32_bf16 a[4:7], v[44:47], v[20:23], a[4:7]
    v_mfma_f32_16x16x32_bf16 a[52:55], v[44:47], v[24:27], a[52:55]
    s_mov_b32 s32, 8192
    buffer_load_dwordx4 v[36:39], v14, s[8:11], s32 offen
    ds_read_b64_tr_b16 v[44:45], v17 offset:192
    ds_read_b64_tr_b16 v[46:47], v17 offset:3520
    s_waitcnt lgkmcnt(8)
    v_mfma_f32_16x16x32_bf16 a[8:11], v[48:51], v[20:23], a[8:11]
    v_mfma_f32_16x16x32_bf16 a[56:59], v[48:51], v[24:27], a[56:59]
    ds_read_b64_tr_b16 v[48:49], v17 offset:224
    ds_read_b64_tr_b16 v[50:51], v17 offset:3552
    s_waitcnt lgkmcnt(8)
    v_mfma_f32_16x16x32_bf16 a[12:15], v[52:55], v[20:23], a[12:15]
    v_mfma_f32_16x16x32_bf16 a[60:63], v[52:55], v[24:27], a[60:63]
    buffer_load_dwordx4 v[40:43], v15, s[8:11], s32 offen
    ds_read_b64_tr_b16 v[52:53], v17 offset:256
    ds_read_b64_tr_b16 v[54:55], v17 offset:3584
    s_waitcnt lgkmcnt(8)
    v_mfma_f32_16x16x32_bf16 a[16:19], v[56:59], v[20:23], a[16:19]
    v_mfma_f32_16x16x32_bf16 a[64:67], v[56:59], v[24:27], a[64:67]
    ds_read_b64_tr_b16 v[56:57], v17 offset:288
    ds_read_b64_tr_b16 v[58:59], v17 offset:3616
    s_waitcnt lgkmcnt(8)
    v_mfma_f32_16x16x32_bf16 a[20:23], v[60:63], v[20:23], a[20:23]
    v_mfma_f32_16x16x32_bf16 a[68:71], v[60:63], v[24:27], a[68:71]
    s_add_u32 m0, s29, 108544
    s_nop 0
    buffer_load_dwordx4 v12, s[12:15], s31 offen lds
    ds_read_b64_tr_b16 v[60:61], v17 offset:320
    ds_read_b64_tr_b16 v[62:63], v17 offset:3648
    s_waitcnt lgkmcnt(8)
    v_mfma_f32_16x16x32_bf16 a[24:27], v[44:47], v[20:23], a[24:27]
    v_mfma_f32_16x16x32_bf16 a[72:75], v[44:47], v[24:27], a[72:75]
    ds_read_b64_tr_b16 v[44:45], v17 offset:352
    ds_read_b64_tr_b16 v[46:47], v17 offset:3680
    s_waitcnt lgkmcnt(8)
    v_mfma_f32_16x16x32_bf16 a[28:31], v[48:51], v[20:23], a[28:31]
    v_mfma_f32_16x16x32_bf16 a[76:79], v[48:51], v[24:27], a[76:79]
    s_add_u32 m0, s29, 109568
    s_mov_b64 exec, 0xffff
    buffer_load_dwordx4 v13, s[12:15], s31 offen lds
    s_mov_b64 exec, -1
    ds_read_b64_tr_b16 v[48:49], v17 offset:13312
    ds_read_b64_tr_b16 v[50:51], v17 offset:16640
    s_waitcnt lgkmcnt(8)
    v_mfma_f32_16x16x32_bf16 a[32:35], v[52:55], v[20:23], a[32:35]
    v_mfma_f32_16x16x32_bf16 a[80:83], v[52:55], v[24:27], a[80:83]
    ds_read_b64_tr_b16 v[52:53], v17 offset:13344
    ds_read_b64_tr_b16 v[54:55], v17 offset:16672
    s_waitcnt lgkmcnt(8)
    v_mfma_f32_16x16x32_bf16 a[36:39], v[56:59], v[20:23], a[36:39]
    v_mfma_f32_16x16x32_bf16 a[84:87], v[56:59], v[24:27], a[84:87]
    ds_read_b64_tr_b16 v[56:57], v17 offset:13376
    ds_read_b64_tr_b16 v[58:59], v17 offset:16704
    s_waitcnt lgkmcnt(8)
    v_mfma_f32_16x16x32_bf16 a[40:43], v[60:63], v[20:23], a[40:43]
    v_mfma_f32_16x16x32_bf16 a[88:91], v[60:63], v[24:27], a[88:91]
    ds_read_b64_tr_b16 v[60:61], v17 offset:13408
    ds_read_b64_tr_b16 v[62:63], v17 offset:16736
    s_waitcnt lgkmcnt(8)
    v_mfma_f32_16x16x32_bf16 a[44:47], v[44:47], v[20:23], a[44:47]
    v_mfma_f32_16x16x32_bf16 a[92:95], v[44:47], v[24:27], a[92:95]
    ds_read_b64_tr_b16 v[44:45], v17 offset:13440
    ds_read_b64_tr_b16 v[46:47], v17 offset:16768
    s_waitcnt lgkmcnt(8)
    v_mfma_f32_16x16x32_bf16 a[96:99], v[48:51], v[20:23], a[96:99]
    v_mfma_f32_16x16x32_bf16 v[80:83], v[48:51], v[24:27], v[80:83]
    ds_read_b64_tr_b16 v[48:49], v17 offset:13472
    ds_read_b64_tr_b16 v[50:51], v17 offset:16800
    s_waitcnt lgkmcnt(8)
    v_mfma_f32_16x16x32_bf16 a[100:103], v[52:55], v[20:23], a[100:103]
    v_mfma_f32_16x16x32_bf16 v[84:87], v[52:55], v[24:27], v[84:87]
    ds_read_b64_tr_b16 v[52:53], v17 offset:13504
    ds_read_b64_tr_b16 v[54:55], v17 offset:16832
    s_waitcnt lgkmcnt(8)
    v_mfma_f32_16x16x32_bf16 a[104:107], v[56:59], v[20:23], a[104:107]
    v_mfma_f32_16x16x32_bf16 v[88:91], v[56:59], v[24:27], v[88:91]
    ds_read_b64_tr_b16 v[56:57], v17 offset:13536
    ds_read_b64_tr_b16 v[58:59], v17 offset:16864
    s_waitcnt lgkmcnt(8)
    v_mfma_f32_16x16x32_bf16 a[108:111], v[60:63], v[20:23], a[108:111]
    v_mfma_f32_16x16x32_bf16 v[92:95], v[60:63], v[24:27], v[92:95]
    ds_read_b64_tr_b16 v[60:61], v17 offset:13568
    ds_read_b64_tr_b16 v[62:63], v17 offset:16896
    s_waitcnt lgkmcnt(8)
    v_mfma_f32_16x16x32_bf16 a[112:115], v[44:47], v[20:23], a[112:115]
    v_mfma_f32_16x16x32_bf16 v[96:99], v[44:47], v[24:27], v[96:99]
    ds_read_b64_tr_b16 v[44:45], v17 offset:13600
    ds_read_b64_tr_b16 v[46:47], v17 offset:16928
    s_waitcnt lgkmcnt(8)
    v_mfma_f32_16x16x32_bf16 a[116:119], v[48:51], v[20:23], a[116:119]
    v_mfma_f32_16x16x32_bf16 v[100:103], v[48:51], v[24:27], v[100:103]
    ds_read_b64_tr_b16 v[48:49], v17 offset:13632
    ds_read_b64_tr_b16 v[50:51], v17 offset:16960
    s_waitcnt lgkmcnt(8)
    v_mfma_f32_16x16x32_bf16 a[120:123], v[52:55], v[20:23], a[120:123]
    v_mfma_f32_16x16x32_bf16 v[104:107], v[52:55], v[24:27], v[104:107]
    ds_read_b64_tr_b16 v[52:53], v17 offset:13664
    ds_read_b64_tr_b16 v[54:55], v17 offset:16992
    s_waitcnt lgkmcnt(8)
    v_mfma_f32_16x16x32_bf16 a[124:127], v[56:59], v[20:23], a[124:127]
    v_mfma_f32_16x16x32_bf16 v[108:111], v[56:59], v[24:27], v[108:111]
    s_barrier
    v_add_u32 v18, 26624, v16
    ds_read_b64_tr_b16 v[56:57], v18 offset:0
    ds_read_b64_tr_b16 v[58:59], v18 offset:3328
    s_waitcnt lgkmcnt(8)
    v_mfma_f32_16x16x32_bf16 v[64:67], v[60:63], v[20:23], v[64:67]
    v_mfma_f32_16x16x32_bf16 v[112:115], v[60:63], v[24:27], v[112:115]
    ds_read_b64_tr_b16 v[60:61], v18 offset:32
    ds_read_b64_tr_b16 v[62:63], v18 offset:3360
    s_waitcnt lgkmcnt(8)
    v_mfma_f32_16x16x32_bf16 v[68:71], v[44:47], v[20:23], v[68:71]
    v_mfma_f32_16x16x32_bf16 v[116:119], v[44:47], v[24:27], v[116:119]
    s_mov_b32 s31, 3244032
    s_add_u32 m0, s29, 133120
    s_nop 0
    buffer_load_dwordx4 v10, s[12:15], s31 offen lds
    ds_read_b64_tr_b16 v[44:45], v18 offset:64
    ds_read_b64_tr_b16 v[46:47], v18 offset:3392
    s_waitcnt lgkmcnt(8)
    v_mfma_f32_16x16x32_bf16 v[72:75], v[48:51], v[20:23], v[72:75]
    v_mfma_f32_16x16x32_bf16 v[120:123], v[48:51], v[24:27], v[120:123]
    ds_read_b64_tr_b16 v[48:49], v18 offset:96
    ds_read_b64_tr_b16 v[50:51], v18 offset:3424
    s_waitcnt lgkmcnt(8)
    v_mfma_f32_16x16x32_bf16 v[76:79], v[52:55], v[20:23], v[76:79]
    v_mfma_f32_16x16x32_bf16 v[124:127], v[52:55], v[24:27], v[124:127]
    s_add_u32 m0, s29, 134144
    s_nop 0
    buffer_load_dwordx4 v11, s[12:15], s31 offen lds
    ds_read_b64_tr_b16 v[52:53], v18 offset:128
    ds_read_b64_tr_b16 v[54:55], v18 offset:3456
    s_waitcnt vmcnt(10)
    s_waitcnt lgkmcnt(8)
    v_mfma_f32_16x16x32_bf16 a[0:3], v[56:59], v[28:31], a[0:3]
    v_mfma_f32_16x16x32_bf16 a[48:51], v[56:59], v[32:35], a[48:51]
    ds_read_b64_tr_b16 v[56:57], v18 offset:160
    ds_read_b64_tr_b16 v[58:59], v18 offset:3488
    s_waitcnt lgkmcnt(8)
    v_mfma_f32_16x16x32_bf16 a[4:7], v[60:63], v[28:31], a[4:7]
    v_mfma_f32_16x16x32_bf16 a[52:55], v[60:63], v[32:35], a[52:55]
    s_mov_b32 s32, 9216
    buffer_load_dwordx4 v[20:23], v14, s[8:11], s32 offen
    ds_read_b64_tr_b16 v[60:61], v18 offset:192
    ds_read_b64_tr_b16 v[62:63], v18 offset:3520
    s_waitcnt lgkmcnt(8)
    v_mfma_f32_16x16x32_bf16 a[8:11], v[44:47], v[28:31], a[8:11]
    v_mfma_f32_16x16x32_bf16 a[56:59], v[44:47], v[32:35], a[56:59]
    ds_read_b64_tr_b16 v[44:45], v18 offset:224
    ds_read_b64_tr_b16 v[46:47], v18 offset:3552
    s_waitcnt lgkmcnt(8)
    v_mfma_f32_16x16x32_bf16 a[12:15], v[48:51], v[28:31], a[12:15]
    v_mfma_f32_16x16x32_bf16 a[60:63], v[48:51], v[32:35], a[60:63]
    buffer_load_dwordx4 v[24:27], v15, s[8:11], s32 offen
    ds_read_b64_tr_b16 v[48:49], v18 offset:256
    ds_read_b64_tr_b16 v[50:51], v18 offset:3584
    s_waitcnt lgkmcnt(8)
    v_mfma_f32_16x16x32_bf16 a[16:19], v[52:55], v[28:31], a[16:19]
    v_mfma_f32_16x16x32_bf16 a[64:67], v[52:55], v[32:35], a[64:67]
    ds_read_b64_tr_b16 v[52:53], v18 offset:288
    ds_read_b64_tr_b16 v[54:55], v18 offset:3616
    s_waitcnt lgkmcnt(8)
    v_mfma_f32_16x16x32_bf16 a[20:23], v[56:59], v[28:31], a[20:23]
    v_mfma_f32_16x16x32_bf16 a[68:71], v[56:59], v[32:35], a[68:71]
    s_add_u32 m0, s29, 135168
    s_nop 0
    buffer_load_dwordx4 v12, s[12:15], s31 offen lds
    ds_read_b64_tr_b16 v[56:57], v18 offset:320
    ds_read_b64_tr_b16 v[58:59], v18 offset:3648
    s_waitcnt lgkmcnt(8)
    v_mfma_f32_16x16x32_bf16 a[24:27], v[60:63], v[28:31], a[24:27]
    v_mfma_f32_16x16x32_bf16 a[72:75], v[60:63], v[32:35], a[72:75]
    ds_read_b64_tr_b16 v[60:61], v18 offset:352
    ds_read_b64_tr_b16 v[62:63], v18 offset:3680
    s_waitcnt lgkmcnt(8)
    v_mfma_f32_16x16x32_bf16 a[28:31], v[44:47], v[28:31], a[28:31]
    v_mfma_f32_16x16x32_bf16 a[76:79], v[44:47], v[32:35], a[76:79]
    s_add_u32 m0, s29, 136192
    s_mov_b64 exec, 0xffff
    buffer_load_dwordx4 v13, s[12:15], s31 offen lds
    s_mov_b64 exec, -1
    ds_read_b64_tr_b16 v[44:45], v18 offset:13312
    ds_read_b64_tr_b16 v[46:47], v18 offset:16640
    s_waitcnt lgkmcnt(8)
    v_mfma_f32_16x16x32_bf16 a[32:35], v[48:51], v[28:31], a[32:35]
    v_mfma_f32_16x16x32_bf16 a[80:83], v[48:51], v[32:35], a[80:83]
    ds_read_b64_tr_b16 v[48:49], v18 offset:13344
    ds_read_b64_tr_b16 v[50:51], v18 offset:16672
    s_waitcnt lgkmcnt(8)
    v_mfma_f32_16x16x32_bf16 a[36:39], v[52:55], v[28:31], a[36:39]
    v_mfma_f32_16x16x32_bf16 a[84:87], v[52:55], v[32:35], a[84:87]
    ds_read_b64_tr_b16 v[52:53], v18 offset:13376
    ds_read_b64_tr_b16 v[54:55], v18 offset:16704
    s_waitcnt lgkmcnt(8)
    v_mfma_f32_16x16x32_bf16 a[40:43], v[56:59], v[28:31], a[40:43]
    v_mfma_f32_16x16x32_bf16 a[88:91], v[56:59], v[32:35], a[88:91]
    ds_read_b64_tr_b16 v[56:57], v18 offset:13408
    ds_read_b64_tr_b16 v[58:59], v18 offset:16736
    s_waitcnt lgkmcnt(8)
    v_mfma_f32_16x16x32_bf16 a[44:47], v[60:63], v[28:31], a[44:47]
    v_mfma_f32_16x16x32_bf16 a[92:95], v[60:63], v[32:35], a[92:95]
    ds_read_b64_tr_b16 v[60:61], v18 offset:13440
    ds_read_b64_tr_b16 v[62:63], v18 offset:16768
    s_waitcnt lgkmcnt(8)
    v_mfma_f32_16x16x32_bf16 a[96:99], v[44:47], v[28:31], a[96:99]
    v_mfma_f32_16x16x32_bf16 v[80:83], v[44:47], v[32:35], v[80:83]
    ds_read_b64_tr_b16 v[44:45], v18 offset:13472
    ds_read_b64_tr_b16 v[46:47], v18 offset:16800
    s_waitcnt lgkmcnt(8)
    v_mfma_f32_16x16x32_bf16 a[100:103], v[48:51], v[28:31], a[100:103]
    v_mfma_f32_16x16x32_bf16 v[84:87], v[48:51], v[32:35], v[84:87]
    ds_read_b64_tr_b16 v[48:49], v18 offset:13504
    ds_read_b64_tr_b16 v[50:51], v18 offset:16832
    s_waitcnt lgkmcnt(8)
    v_mfma_f32_16x16x32_bf16 a[104:107], v[52:55], v[28:31], a[104:107]
    v_mfma_f32_16x16x32_bf16 v[88:91], v[52:55], v[32:35], v[88:91]
    ds_read_b64_tr_b16 v[52:53], v18 offset:13536
    ds_read_b64_tr_b16 v[54:55], v18 offset:16864
    s_waitcnt lgkmcnt(8)
    v_mfma_f32_16x16x32_bf16 a[108:111], v[56:59], v[28:31], a[108:111]
    v_mfma_f32_16x16x32_bf16 v[92:95], v[56:59], v[32:35], v[92:95]
    ds_read_b64_tr_b16 v[56:57], v18 offset:13568
    ds_read_b64_tr_b16 v[58:59], v18 offset:16896
    s_waitcnt lgkmcnt(8)
    v_mfma_f32_16x16x32_bf16 a[112:115], v[60:63], v[28:31], a[112:115]
    v_mfma_f32_16x16x32_bf16 v[96:99], v[60:63], v[32:35], v[96:99]
    ds_read_b64_tr_b16 v[60:61], v18 offset:13600
    ds_read_b64_tr_b16 v[62:63], v18 offset:16928
    s_waitcnt lgkmcnt(8)
    v_mfma_f32_16x16x32_bf16 a[116:119], v[44:47], v[28:31], a[116:119]
    v_mfma_f32_16x16x32_bf16 v[100:103], v[44:47], v[32:35], v[100:103]
    ds_read_b64_tr_b16 v[44:45], v18 offset:13632
    ds_read_b64_tr_b16 v[46:47], v18 offset:16960
    s_waitcnt lgkmcnt(8)
    v_mfma_f32_16x16x32_bf16 a[120:123], v[48:51], v[28:31], a[120:123]
    v_mfma_f32_16x16x32_bf16 v[104:107], v[48:51], v[32:35], v[104:107]
    ds_read_b64_tr_b16 v[48:49], v18 offset:13664
    ds_read_b64_tr_b16 v[50:51], v18 offset:16992
    s_waitcnt lgkmcnt(8)
    v_mfma_f32_16x16x32_bf16 a[124:127], v[52:55], v[28:31], a[124:127]
    v_mfma_f32_16x16x32_bf16 v[108:111], v[52:55], v[32:35], v[108:111]
    s_barrier
    v_add_u32 v17, 53248, v16
    ds_read_b64_tr_b16 v[52:53], v17 offset:0
    ds_read_b64_tr_b16 v[54:55], v17 offset:3328
    s_waitcnt lgkmcnt(8)
    v_mfma_f32_16x16x32_bf16 v[64:67], v[56:59], v[28:31], v[64:67]
    v_mfma_f32_16x16x32_bf16 v[112:115], v[56:59], v[32:35], v[112:115]
    ds_read_b64_tr_b16 v[56:57], v17 offset:32
    ds_read_b64_tr_b16 v[58:59], v17 offset:3360
    s_waitcnt lgkmcnt(8)
    v_mfma_f32_16x16x32_bf16 v[68:71], v[60:63], v[28:31], v[68:71]
    v_mfma_f32_16x16x32_bf16 v[116:119], v[60:63], v[32:35], v[116:119]
    s_mov_b32 s31, 3538944
    s_add_u32 m0, s29, 0
    s_nop 0
    buffer_load_dwordx4 v10, s[12:15], s31 offen lds
    ds_read_b64_tr_b16 v[60:61], v17 offset:64
    ds_read_b64_tr_b16 v[62:63], v17 offset:3392
    s_waitcnt lgkmcnt(8)
    v_mfma_f32_16x16x32_bf16 v[72:75], v[44:47], v[28:31], v[72:75]
    v_mfma_f32_16x16x32_bf16 v[120:123], v[44:47], v[32:35], v[120:123]
    ds_read_b64_tr_b16 v[44:45], v17 offset:96
    ds_read_b64_tr_b16 v[46:47], v17 offset:3424
    s_waitcnt lgkmcnt(8)
    v_mfma_f32_16x16x32_bf16 v[76:79], v[48:51], v[28:31], v[76:79]
    v_mfma_f32_16x16x32_bf16 v[124:127], v[48:51], v[32:35], v[124:127]
    s_add_u32 m0, s29, 1024
    s_nop 0
    buffer_load_dwordx4 v11, s[12:15], s31 offen lds
    ds_read_b64_tr_b16 v[48:49], v17 offset:128
    ds_read_b64_tr_b16 v[50:51], v17 offset:3456
    s_waitcnt vmcnt(10)
    s_waitcnt lgkmcnt(8)
    v_mfma_f32_16x16x32_bf16 a[0:3], v[52:55], v[36:39], a[0:3]
    v_mfma_f32_16x16x32_bf16 a[48:51], v[52:55], v[40:43], a[48:51]
    ds_read_b64_tr_b16 v[52:53], v17 offset:160
    ds_read_b64_tr_b16 v[54:55], v17 offset:3488
    s_waitcnt lgkmcnt(8)
    v_mfma_f32_16x16x32_bf16 a[4:7], v[56:59], v[36:39], a[4:7]
    v_mfma_f32_16x16x32_bf16 a[52:55], v[56:59], v[40:43], a[52:55]
    s_mov_b32 s32, 10240
    buffer_load_dwordx4 v[28:31], v14, s[8:11], s32 offen
    ds_read_b64_tr_b16 v[56:57], v17 offset:192
    ds_read_b64_tr_b16 v[58:59], v17 offset:3520
    s_waitcnt lgkmcnt(8)
    v_mfma_f32_16x16x32_bf16 a[8:11], v[60:63], v[36:39], a[8:11]
    v_mfma_f32_16x16x32_bf16 a[56:59], v[60:63], v[40:43], a[56:59]
    ds_read_b64_tr_b16 v[60:61], v17 offset:224
    ds_read_b64_tr_b16 v[62:63], v17 offset:3552
    s_waitcnt lgkmcnt(8)
    v_mfma_f32_16x16x32_bf16 a[12:15], v[44:47], v[36:39], a[12:15]
    v_mfma_f32_16x16x32_bf16 a[60:63], v[44:47], v[40:43], a[60:63]
    buffer_load_dwordx4 v[32:35], v15, s[8:11], s32 offen
    ds_read_b64_tr_b16 v[44:45], v17 offset:256
    ds_read_b64_tr_b16 v[46:47], v17 offset:3584
    s_waitcnt lgkmcnt(8)
    v_mfma_f32_16x16x32_bf16 a[16:19], v[48:51], v[36:39], a[16:19]
    v_mfma_f32_16x16x32_bf16 a[64:67], v[48:51], v[40:43], a[64:67]
    ds_read_b64_tr_b16 v[48:49], v17 offset:288
    ds_read_b64_tr_b16 v[50:51], v17 offset:3616
    s_waitcnt lgkmcnt(8)
    v_mfma_f32_16x16x32_bf16 a[20:23], v[52:55], v[36:39], a[20:23]
    v_mfma_f32_16x16x32_bf16 a[68:71], v[52:55], v[40:43], a[68:71]
    s_add_u32 m0, s29, 2048
    s_nop 0
    buffer_load_dwordx4 v12, s[12:15], s31 offen lds
    ds_read_b64_tr_b16 v[52:53], v17 offset:320
    ds_read_b64_tr_b16 v[54:55], v17 offset:3648
    s_waitcnt lgkmcnt(8)
    v_mfma_f32_16x16x32_bf16 a[24:27], v[56:59], v[36:39], a[24:27]
    v_mfma_f32_16x16x32_bf16 a[72:75], v[56:59], v[40:43], a[72:75]
    ds_read_b64_tr_b16 v[56:57], v17 offset:352
    ds_read_b64_tr_b16 v[58:59], v17 offset:3680
    s_waitcnt lgkmcnt(8)
    v_mfma_f32_16x16x32_bf16 a[28:31], v[60:63], v[36:39], a[28:31]
    v_mfma_f32_16x16x32_bf16 a[76:79], v[60:63], v[40:43], a[76:79]
    s_add_u32 m0, s29, 3072
    s_mov_b64 exec, 0xffff
    buffer_load_dwordx4 v13, s[12:15], s31 offen lds
    s_mov_b64 exec, -1
    ds_read_b64_tr_b16 v[60:61], v17 offset:13312
    ds_read_b64_tr_b16 v[62:63], v17 offset:16640
    s_waitcnt lgkmcnt(8)
    v_mfma_f32_16x16x32_bf16 a[32:35], v[44:47], v[36:39], a[32:35]
    v_mfma_f32_16x16x32_bf16 a[80:83], v[44:47], v[40:43], a[80:83]
    ds_read_b64_tr_b16 v[44:45], v17 offset:13344
    ds_read_b64_tr_b16 v[46:47], v17 offset:16672
    s_waitcnt lgkmcnt(8)
    v_mfma_f32_16x16x32_bf16 a[36:39], v[48:51], v[36:39], a[36:39]
    v_mfma_f32_16x16x32_bf16 a[84:87], v[48:51], v[40:43], a[84:87]
    ds_read_b64_tr_b16 v[48:49], v17 offset:13376
    ds_read_b64_tr_b16 v[50:51], v17 offset:16704
    s_waitcnt lgkmcnt(8)
    v_mfma_f32_16x16x32_bf16 a[40:43], v[52:55], v[36:39], a[40:43]
    v_mfma_f32_16x16x32_bf16 a[88:91], v[52:55], v[40:43], a[88:91]
    ds_read_b64_tr_b16 v[52:53], v17 offset:13408
    ds_read_b64_tr_b16 v[54:55], v17 offset:16736
    s_waitcnt lgkmcnt(8)
    v_mfma_f32_16x16x32_bf16 a[44:47], v[56:59], v[36:39], a[44:47]
    v_mfma_f32_16x16x32_bf16 a[92:95], v[56:59], v[40:43], a[92:95]
    ds_read_b64_tr_b16 v[56:57], v17 offset:13440
    ds_read_b64_tr_b16 v[58:59], v17 offset:16768
    s_waitcnt lgkmcnt(8)
    v_mfma_f32_16x16x32_bf16 a[96:99], v[60:63], v[36:39], a[96:99]
    v_mfma_f32_16x16x32_bf16 v[80:83], v[60:63], v[40:43], v[80:83]
    ds_read_b64_tr_b16 v[60:61], v17 offset:13472
    ds_read_b64_tr_b16 v[62:63], v17 offset:16800
    s_waitcnt lgkmcnt(8)
    v_mfma_f32_16x16x32_bf16 a[100:103], v[44:47], v[36:39], a[100:103]
    v_mfma_f32_16x16x32_bf16 v[84:87], v[44:47], v[40:43], v[84:87]
    ds_read_b64_tr_b16 v[44:45], v17 offset:13504
    ds_read_b64_tr_b16 v[46:47], v17 offset:16832
    s_waitcnt lgkmcnt(8)
    v_mfma_f32_16x16x32_bf16 a[104:107], v[48:51], v[36:39], a[104:107]
    v_mfma_f32_16x16x32_bf16 v[88:91], v[48:51], v[40:43], v[88:91]
    ds_read_b64_tr_b16 v[48:49], v17 offset:13536
    ds_read_b64_tr_b16 v[50:51], v17 offset:16864
    s_waitcnt lgkmcnt(8)
    v_mfma_f32_16x16x32_bf16 a[108:111], v[52:55], v[36:39], a[108:111]
    v_mfma_f32_16x16x32_bf16 v[92:95], v[52:55], v[40:43], v[92:95]
    ds_read_b64_tr_b16 v[52:53], v17 offset:13568
    ds_read_b64_tr_b16 v[54:55], v17 offset:16896
    s_waitcnt lgkmcnt(8)
    v_mfma_f32_16x16x32_bf16 a[112:115], v[56:59], v[36:39], a[112:115]
    v_mfma_f32_16x16x32_bf16 v[96:99], v[56:59], v[40:43], v[96:99]
    ds_read_b64_tr_b16 v[56:57], v17 offset:13600
    ds_read_b64_tr_b16 v[58:59], v17 offset:16928
    s_waitcnt lgkmcnt(8)
    v_mfma_f32_16x16x32_bf16 a[116:119], v[60:63], v[36:39], a[116:119]
    v_mfma_f32_16x16x32_bf16 v[100:103], v[60:63], v[40:43], v[100:103]
    ds_read_b64_tr_b16 v[60:61], v17 offset:13632
    ds_read_b64_tr_b16 v[62:63], v17 offset:16960
    s_waitcnt lgkmcnt(8)
    v_mfma_f32_16x16x32_bf16 a[120:123], v[44:47], v[36:39], a[120:123]
    v_mfma_f32_16x16x32_bf16 v[104:107], v[44:47], v[40:43], v[104:107]
    ds_read_b64_tr_b16 v[44:45], v17 offset:13664
    ds_read_b64_tr_b16 v[46:47], v17 offset:16992
    s_waitcnt lgkmcnt(8)
    v_mfma_f32_16x16x32_bf16 a[124:127], v[48:51], v[36:39], a[124:127]
    v_mfma_f32_16x16x32_bf16 v[108:111], v[48:51], v[40:43], v[108:111]
    s_barrier
    v_add_u32 v18, 79872, v16
    ds_read_b64_tr_b16 v[48:49], v18 offset:0
    ds_read_b64_tr_b16 v[50:51], v18 offset:3328
    s_waitcnt lgkmcnt(8)
    v_mfma_f32_16x16x32_bf16 v[64:67], v[52:55], v[36:39], v[64:67]
    v_mfma_f32_16x16x32_bf16 v[112:115], v[52:55], v[40:43], v[112:115]
    ds_read_b64_tr_b16 v[52:53], v18 offset:32
    ds_read_b64_tr_b16 v[54:55], v18 offset:3360
    s_waitcnt lgkmcnt(8)
    v_mfma_f32_16x16x32_bf16 v[68:71], v[56:59], v[36:39], v[68:71]
    v_mfma_f32_16x16x32_bf16 v[116:119], v[56:59], v[40:43], v[116:119]
    s_mov_b32 s31, 3833856
    s_add_u32 m0, s29, 26624
    s_nop 0
    buffer_load_dwordx4 v10, s[12:15], s31 offen lds
    ds_read_b64_tr_b16 v[56:57], v18 offset:64
    ds_read_b64_tr_b16 v[58:59], v18 offset:3392
    s_waitcnt lgkmcnt(8)
    v_mfma_f32_16x16x32_bf16 v[72:75], v[60:63], v[36:39], v[72:75]
    v_mfma_f32_16x16x32_bf16 v[120:123], v[60:63], v[40:43], v[120:123]
    ds_read_b64_tr_b16 v[60:61], v18 offset:96
    ds_read_b64_tr_b16 v[62:63], v18 offset:3424
    s_waitcnt lgkmcnt(8)
    v_mfma_f32_16x16x32_bf16 v[76:79], v[44:47], v[36:39], v[76:79]
    v_mfma_f32_16x16x32_bf16 v[124:127], v[44:47], v[40:43], v[124:127]
    s_add_u32 m0, s29, 27648
    s_nop 0
    buffer_load_dwordx4 v11, s[12:15], s31 offen lds
    ds_read_b64_tr_b16 v[44:45], v18 offset:128
    ds_read_b64_tr_b16 v[46:47], v18 offset:3456
    s_waitcnt vmcnt(10)
    s_waitcnt lgkmcnt(8)
    v_mfma_f32_16x16x32_bf16 a[0:3], v[48:51], v[20:23], a[0:3]
    v_mfma_f32_16x16x32_bf16 a[48:51], v[48:51], v[24:27], a[48:51]
    ds_read_b64_tr_b16 v[48:49], v18 offset:160
    ds_read_b64_tr_b16 v[50:51], v18 offset:3488
    s_waitcnt lgkmcnt(8)
    v_mfma_f32_16x16x32_bf16 a[4:7], v[52:55], v[20:23], a[4:7]
    v_mfma_f32_16x16x32_bf16 a[52:55], v[52:55], v[24:27], a[52:55]
    s_mov_b32 s32, 11264
    buffer_load_dwordx4 v[36:39], v14, s[8:11], s32 offen
    ds_read_b64_tr_b16 v[52:53], v18 offset:192
    ds_read_b64_tr_b16 v[54:55], v18 offset:3520
    s_waitcnt lgkmcnt(8)
    v_mfma_f32_16x16x32_bf16 a[8:11], v[56:59], v[20:23], a[8:11]
    v_mfma_f32_16x16x32_bf16 a[56:59], v[56:59], v[24:27], a[56:59]
    ds_read_b64_tr_b16 v[56:57], v18 offset:224
    ds_read_b64_tr_b16 v[58:59], v18 offset:3552
    s_waitcnt lgkmcnt(8)
    v_mfma_f32_16x16x32_bf16 a[12:15], v[60:63], v[20:23], a[12:15]
    v_mfma_f32_16x16x32_bf16 a[60:63], v[60:63], v[24:27], a[60:63]
    buffer_load_dwordx4 v[40:43], v15, s[8:11], s32 offen
    ds_read_b64_tr_b16 v[60:61], v18 offset:256
    ds_read_b64_tr_b16 v[62:63], v18 offset:3584
    s_waitcnt lgkmcnt(8)
    v_mfma_f32_16x16x32_bf16 a[16:19], v[44:47], v[20:23], a[16:19]
    v_mfma_f32_16x16x32_bf16 a[64:67], v[44:47], v[24:27], a[64:67]
    ds_read_b64_tr_b16 v[44:45], v18 offset:288
    ds_read_b64_tr_b16 v[46:47], v18 offset:3616
    s_waitcnt lgkmcnt(8)
    v_mfma_f32_16x16x32_bf16 a[20:23], v[48:51], v[20:23], a[20:23]
    v_mfma_f32_16x16x32_bf16 a[68:71], v[48:51], v[24:27], a[68:71]
    s_add_u32 m0, s29, 28672
    s_nop 0
    buffer_load_dwordx4 v12, s[12:15], s31 offen lds
    ds_read_b64_tr_b16 v[48:49], v18 offset:320
    ds_read_b64_tr_b16 v[50:51], v18 offset:3648
    s_waitcnt lgkmcnt(8)
    v_mfma_f32_16x16x32_bf16 a[24:27], v[52:55], v[20:23], a[24:27]
    v_mfma_f32_16x16x32_bf16 a[72:75], v[52:55], v[24:27], a[72:75]
    ds_read_b64_tr_b16 v[52:53], v18 offset:352
    ds_read_b64_tr_b16 v[54:55], v18 offset:3680
    s_waitcnt lgkmcnt(8)
    v_mfma_f32_16x16x32_bf16 a[28:31], v[56:59], v[20:23], a[28:31]
    v_mfma_f32_16x16x32_bf16 a[76:79], v[56:59], v[24:27], a[76:79]
    s_add_u32 m0, s29, 29696
    s_mov_b64 exec, 0xffff
    buffer_load_dwordx4 v13, s[12:15], s31 offen lds
    s_mov_b64 exec, -1
    ds_read_b64_tr_b16 v[56:57], v18 offset:13312
    ds_read_b64_tr_b16 v[58:59], v18 offset:16640
    s_waitcnt lgkmcnt(8)
    v_mfma_f32_16x16x32_bf16 a[32:35], v[60:63], v[20:23], a[32:35]
    v_mfma_f32_16x16x32_bf16 a[80:83], v[60:63], v[24:27], a[80:83]
    ds_read_b64_tr_b16 v[60:61], v18 offset:13344
    ds_read_b64_tr_b16 v[62:63], v18 offset:16672
    s_waitcnt lgkmcnt(8)
    v_mfma_f32_16x16x32_bf16 a[36:39], v[44:47], v[20:23], a[36:39]
    v_mfma_f32_16x16x32_bf16 a[84:87], v[44:47], v[24:27], a[84:87]
    ds_read_b64_tr_b16 v[44:45], v18 offset:13376
    ds_read_b64_tr_b16 v[46:47], v18 offset:16704
    s_waitcnt lgkmcnt(8)
    v_mfma_f32_16x16x32_bf16 a[40:43], v[48:51], v[20:23], a[40:43]
    v_mfma_f32_16x16x32_bf16 a[88:91], v[48:51], v[24:27], a[88:91]
    ds_read_b64_tr_b16 v[48:49], v18 offset:13408
    ds_read_b64_tr_b16 v[50:51], v18 offset:16736
    s_waitcnt lgkmcnt(8)
    v_mfma_f32_16x16x32_bf16 a[44:47], v[52:55], v[20:23], a[44:47]
    v_mfma_f32_16x16x32_bf16 a[92:95], v[52:55], v[24:27], a[92:95]
    ds_read_b64_tr_b16 v[52:53], v18 offset:13440
    ds_read_b64_tr_b16 v[54:55], v18 offset:16768
    s_waitcnt lgkmcnt(8)
    v_mfma_f32_16x16x32_bf16 a[96:99], v[56:59], v[20:23], a[96:99]
    v_mfma_f32_16x16x32_bf16 v[80:83], v[56:59], v[24:27], v[80:83]
    ds_read_b64_tr_b16 v[56:57], v18 offset:13472
    ds_read_b64_tr_b16 v[58:59], v18 offset:16800
    s_waitcnt lgkmcnt(8)
    v_mfma_f32_16x16x32_bf16 a[100:103], v[60:63], v[20:23], a[100:103]
    v_mfma_f32_16x16x32_bf16 v[84:87], v[60:63], v[24:27], v[84:87]
    ds_read_b64_tr_b16 v[60:61], v18 offset:13504
    ds_read_b64_tr_b16 v[62:63], v18 offset:16832
    s_waitcnt lgkmcnt(8)
    v_mfma_f32_16x16x32_bf16 a[104:107], v[44:47], v[20:23], a[104:107]
    v_mfma_f32_16x16x32_bf16 v[88:91], v[44:47], v[24:27], v[88:91]
    ds_read_b64_tr_b16 v[44:45], v18 offset:13536
    ds_read_b64_tr_b16 v[46:47], v18 offset:16864
    s_waitcnt lgkmcnt(8)
    v_mfma_f32_16x16x32_bf16 a[108:111], v[48:51], v[20:23], a[108:111]
    v_mfma_f32_16x16x32_bf16 v[92:95], v[48:51], v[24:27], v[92:95]
    ds_read_b64_tr_b16 v[48:49], v18 offset:13568
    ds_read_b64_tr_b16 v[50:51], v18 offset:16896
    s_waitcnt lgkmcnt(8)
    v_mfma_f32_16x16x32_bf16 a[112:115], v[52:55], v[20:23], a[112:115]
    v_mfma_f32_16x16x32_bf16 v[96:99], v[52:55], v[24:27], v[96:99]
    ds_read_b64_tr_b16 v[52:53], v18 offset:13600
    ds_read_b64_tr_b16 v[54:55], v18 offset:16928
    s_waitcnt lgkmcnt(8)
    v_mfma_f32_16x16x32_bf16 a[116:119], v[56:59], v[20:23], a[116:119]
    v_mfma_f32_16x16x32_bf16 v[100:103], v[56:59], v[24:27], v[100:103]
    ds_read_b64_tr_b16 v[56:57], v18 offset:13632
    ds_read_b64_tr_b16 v[58:59], v18 offset:16960
    s_waitcnt lgkmcnt(8)
    v_mfma_f32_16x16x32_bf16 a[120:123], v[60:63], v[20:23], a[120:123]
    v_mfma_f32_16x16x32_bf16 v[104:107], v[60:63], v[24:27], v[104:107]
    ds_read_b64_tr_b16 v[60:61], v18 offset:13664
    ds_read_b64_tr_b16 v[62:63], v18 offset:16992
    s_waitcnt lgkmcnt(8)
    v_mfma_f32_16x16x32_bf16 a[124:127], v[44:47], v[20:23], a[124:127]
    v_mfma_f32_16x16x32_bf16 v[108:111], v[44:47], v[24:27], v[108:111]
    s_barrier
    v_add_u32 v17, 106496, v16
    ds_read_b64_tr_b16 v[44:45], v17 offset:0
    ds_read_b64_tr_b16 v[46:47], v17 offset:3328
    s_waitcnt lgkmcnt(8)
    v_mfma_f32_16x16x32_bf16 v[64:67], v[48:51], v[20:23], v[64:67]
    v_mfma_f32_16x16x32_bf16 v[112:115], v[48:51], v[24:27], v[112:115]
    ds_read_b64_tr_b16 v[48:49], v17 offset:32
    ds_read_b64_tr_b16 v[50:51], v17 offset:3360
    s_waitcnt lgkmcnt(8)
    v_mfma_f32_16x16x32_bf16 v[68:71], v[52:55], v[20:23], v[68:71]
    v_mfma_f32_16x16x32_bf16 v[116:119], v[52:55], v[24:27], v[116:119]
    s_mov_b32 s31, 4128768
    s_add_u32 m0, s29, 53248
    s_nop 0
    buffer_load_dwordx4 v10, s[12:15], s31 offen lds
    ds_read_b64_tr_b16 v[52:53], v17 offset:64
    ds_read_b64_tr_b16 v[54:55], v17 offset:3392
    s_waitcnt lgkmcnt(8)
    v_mfma_f32_16x16x32_bf16 v[72:75], v[56:59], v[20:23], v[72:75]
    v_mfma_f32_16x16x32_bf16 v[120:123], v[56:59], v[24:27], v[120:123]
    ds_read_b64_tr_b16 v[56:57], v17 offset:96
    ds_read_b64_tr_b16 v[58:59], v17 offset:3424
    s_waitcnt lgkmcnt(8)
    v_mfma_f32_16x16x32_bf16 v[76:79], v[60:63], v[20:23], v[76:79]
    v_mfma_f32_16x16x32_bf16 v[124:127], v[60:63], v[24:27], v[124:127]
    s_add_u32 m0, s29, 54272
    s_nop 0
    buffer_load_dwordx4 v11, s[12:15], s31 offen lds
    ds_read_b64_tr_b16 v[60:61], v17 offset:128
    ds_read_b64_tr_b16 v[62:63], v17 offset:3456
    s_waitcnt vmcnt(10)
    s_waitcnt lgkmcnt(8)
    v_mfma_f32_16x16x32_bf16 a[0:3], v[44:47], v[28:31], a[0:3]
    v_mfma_f32_16x16x32_bf16 a[48:51], v[44:47], v[32:35], a[48:51]
    ds_read_b64_tr_b16 v[44:45], v17 offset:160
    ds_read_b64_tr_b16 v[46:47], v17 offset:3488
    s_waitcnt lgkmcnt(8)
    v_mfma_f32_16x16x32_bf16 a[4:7], v[48:51], v[28:31], a[4:7]
    v_mfma_f32_16x16x32_bf16 a[52:55], v[48:51], v[32:35], a[52:55]
    s_mov_b32 s32, 12288
    buffer_load_dwordx4 v[20:23], v14, s[8:11], s32 offen
    ds_read_b64_tr_b16 v[48:49], v17 offset:192
    ds_read_b64_tr_b16 v[50:51], v17 offset:3520
    s_waitcnt lgkmcnt(8)
    v_mfma_f32_16x16x32_bf16 a[8:11], v[52:55], v[28:31], a[8:11]
    v_mfma_f32_16x16x32_bf16 a[56:59], v[52:55], v[32:35], a[56:59]
    ds_read_b64_tr_b16 v[52:53], v17 offset:224
    ds_read_b64_tr_b16 v[54:55], v17 offset:3552
    s_waitcnt lgkmcnt(8)
    v_mfma_f32_16x16x32_bf16 a[12:15], v[56:59], v[28:31], a[12:15]
    v_mfma_f32_16x16x32_bf16 a[60:63], v[56:59], v[32:35], a[60:63]
    buffer_load_dwordx4 v[24:27], v15, s[8:11], s32 offen
    ds_read_b64_tr_b16 v[56:57], v17 offset:256
    ds_read_b64_tr_b16 v[58:59], v17 offset:3584
    s_waitcnt lgkmcnt(8)
    v_mfma_f32_16x16x32_bf16 a[16:19], v[60:63], v[28:31], a[16:19]
    v_mfma_f32_16x16x32_bf16 a[64:67], v[60:63], v[32:35], a[64:67]
    ds_read_b64_tr_b16 v[60:61], v17 offset:288
    ds_read_b64_tr_b16 v[62:63], v17 offset:3616
    s_waitcnt lgkmcnt(8)
    v_mfma_f32_16x16x32_bf16 a[20:23], v[44:47], v[28:31], a[20:23]
    v_mfma_f32_16x16x32_bf16 a[68:71], v[44:47], v[32:35], a[68:71]
    s_add_u32 m0, s29, 55296
    s_nop 0
    buffer_load_dwordx4 v12, s[12:15], s31 offen lds
    ds_read_b64_tr_b16 v[44:45], v17 offset:320
    ds_read_b64_tr_b16 v[46:47], v17 offset:3648
    s_waitcnt lgkmcnt(8)
    v_mfma_f32_16x16x32_bf16 a[24:27], v[48:51], v[28:31], a[24:27]
    v_mfma_f32_16x16x32_bf16 a[72:75], v[48:51], v[32:35], a[72:75]
    ds_read_b64_tr_b16 v[48:49], v17 offset:352
    ds_read_b64_tr_b16 v[50:51], v17 offset:3680
    s_waitcnt lgkmcnt(8)
    v_mfma_f32_16x16x32_bf16 a[28:31], v[52:55], v[28:31], a[28:31]
    v_mfma_f32_16x16x32_bf16 a[76:79], v[52:55], v[32:35], a[76:79]
    s_add_u32 m0, s29, 56320
    s_mov_b64 exec, 0xffff
    buffer_load_dwordx4 v13, s[12:15], s31 offen lds
    s_mov_b64 exec, -1
    ds_read_b64_tr_b16 v[52:53], v17 offset:13312
    ds_read_b64_tr_b16 v[54:55], v17 offset:16640
    s_waitcnt lgkmcnt(8)
    v_mfma_f32_16x16x32_bf16 a[32:35], v[56:59], v[28:31], a[32:35]
    v_mfma_f32_16x16x32_bf16 a[80:83], v[56:59], v[32:35], a[80:83]
    ds_read_b64_tr_b16 v[56:57], v17 offset:13344
    ds_read_b64_tr_b16 v[58:59], v17 offset:16672
    s_waitcnt lgkmcnt(8)
    v_mfma_f32_16x16x32_bf16 a[36:39], v[60:63], v[28:31], a[36:39]
    v_mfma_f32_16x16x32_bf16 a[84:87], v[60:63], v[32:35], a[84:87]
    ds_read_b64_tr_b16 v[60:61], v17 offset:13376
    ds_read_b64_tr_b16 v[62:63], v17 offset:16704
    s_waitcnt lgkmcnt(8)
    v_mfma_f32_16x16x32_bf16 a[40:43], v[44:47], v[28:31], a[40:43]
    v_mfma_f32_16x16x32_bf16 a[88:91], v[44:47], v[32:35], a[88:91]
    ds_read_b64_tr_b16 v[44:45], v17 offset:13408
    ds_read_b64_tr_b16 v[46:47], v17 offset:16736
    s_waitcnt lgkmcnt(8)
    v_mfma_f32_16x16x32_bf16 a[44:47], v[48:51], v[28:31], a[44:47]
    v_mfma_f32_16x16x32_bf16 a[92:95], v[48:51], v[32:35], a[92:95]
    ds_read_b64_tr_b16 v[48:49], v17 offset:13440
    ds_read_b64_tr_b16 v[50:51], v17 offset:16768
    s_waitcnt lgkmcnt(8)
    v_mfma_f32_16x16x32_bf16 a[96:99], v[52:55], v[28:31], a[96:99]
    v_mfma_f32_16x16x32_bf16 v[80:83], v[52:55], v[32:35], v[80:83]
    ds_read_b64_tr_b16 v[52:53], v17 offset:13472
    ds_read_b64_tr_b16 v[54:55], v17 offset:16800
    s_waitcnt lgkmcnt(8)
    v_mfma_f32_16x16x32_bf16 a[100:103], v[56:59], v[28:31], a[100:103]
    v_mfma_f32_16x16x32_bf16 v[84:87], v[56:59], v[32:35], v[84:87]
    ds_read_b64_tr_b16 v[56:57], v17 offset:13504
    ds_read_b64_tr_b16 v[58:59], v17 offset:16832
    s_waitcnt lgkmcnt(8)
    v_mfma_f32_16x16x32_bf16 a[104:107], v[60:63], v[28:31], a[104:107]
    v_mfma_f32_16x16x32_bf16 v[88:91], v[60:63], v[32:35], v[88:91]
    ds_read_b64_tr_b16 v[60:61], v17 offset:13536
    ds_read_b64_tr_b16 v[62:63], v17 offset:16864
    s_waitcnt lgkmcnt(8)
    v_mfma_f32_16x16x32_bf16 a[108:111], v[44:47], v[28:31], a[108:111]
    v_mfma_f32_16x16x32_bf16 v[92:95], v[44:47], v[32:35], v[92:95]
    ds_read_b64_tr_b16 v[44:45], v17 offset:13568
    ds_read_b64_tr_b16 v[46:47], v17 offset:16896
    s_waitcnt lgkmcnt(8)
    v_mfma_f32_16x16x32_bf16 a[112:115], v[48:51], v[28:31], a[112:115]
    v_mfma_f32_16x16x32_bf16 v[96:99], v[48:51], v[32:35], v[96:99]
    ds_read_b64_tr_b16 v[48:49], v17 offset:13600
    ds_read_b64_tr_b16 v[50:51], v17 offset:16928
    s_waitcnt lgkmcnt(8)
    v_mfma_f32_16x16x32_bf16 a[116:119], v[52:55], v[28:31], a[116:119]
    v_mfma_f32_16x16x32_bf16 v[100:103], v[52:55], v[32:35], v[100:103]
    ds_read_b64_tr_b16 v[52:53], v17 offset:13632
    ds_read_b64_tr_b16 v[54:55], v17 offset:16960
    s_waitcnt lgkmcnt(8)
    v_mfma_f32_16x16x32_bf16 a[120:123], v[56:59], v[28:31], a[120:123]
    v_mfma_f32_16x16x32_bf16 v[104:107], v[56:59], v[32:35], v[104:107]
    ds_read_b64_tr_b16 v[56:57], v17 offset:13664
    ds_read_b64_tr_b16 v[58:59], v17 offset:16992
    s_waitcnt lgkmcnt(8)
    v_mfma_f32_16x16x32_bf16 a[124:127], v[60:63], v[28:31], a[124:127]
    v_mfma_f32_16x16x32_bf16 v[108:111], v[60:63], v[32:35], v[108:111]
    s_barrier
    v_add_u32 v18, 133120, v16
    ds_read_b64_tr_b16 v[60:61], v18 offset:0
    ds_read_b64_tr_b16 v[62:63], v18 offset:3328
    s_waitcnt lgkmcnt(8)
    v_mfma_f32_16x16x32_bf16 v[64:67], v[44:47], v[28:31], v[64:67]
    v_mfma_f32_16x16x32_bf16 v[112:115], v[44:47], v[32:35], v[112:115]
    ds_read_b64_tr_b16 v[44:45], v18 offset:32
    ds_read_b64_tr_b16 v[46:47], v18 offset:3360
    s_waitcnt lgkmcnt(8)
    v_mfma_f32_16x16x32_bf16 v[68:71], v[48:51], v[28:31], v[68:71]
    v_mfma_f32_16x16x32_bf16 v[116:119], v[48:51], v[32:35], v[116:119]
    s_mov_b32 s31, 4423680
    s_add_u32 m0, s29, 79872
    s_nop 0
    buffer_load_dwordx4 v10, s[12:15], s31 offen lds
    ds_read_b64_tr_b16 v[48:49], v18 offset:64
    ds_read_b64_tr_b16 v[50:51], v18 offset:3392
    s_waitcnt lgkmcnt(8)
    v_mfma_f32_16x16x32_bf16 v[72:75], v[52:55], v[28:31], v[72:75]
    v_mfma_f32_16x16x32_bf16 v[120:123], v[52:55], v[32:35], v[120:123]
    ds_read_b64_tr_b16 v[52:53], v18 offset:96
    ds_read_b64_tr_b16 v[54:55], v18 offset:3424
    s_waitcnt lgkmcnt(8)
    v_mfma_f32_16x16x32_bf16 v[76:79], v[56:59], v[28:31], v[76:79]
    v_mfma_f32_16x16x32_bf16 v[124:127], v[56:59], v[32:35], v[124:127]
    s_add_u32 m0, s29, 80896
    s_nop 0
    buffer_load_dwordx4 v11, s[12:15], s31 offen lds
    ds_read_b64_tr_b16 v[56:57], v18 offset:128
    ds_read_b64_tr_b16 v[58:59], v18 offset:3456
    s_waitcnt vmcnt(10)
    s_waitcnt lgkmcnt(8)
    v_mfma_f32_16x16x32_bf16 a[0:3], v[60:63], v[36:39], a[0:3]
    v_mfma_f32_16x16x32_bf16 a[48:51], v[60:63], v[40:43], a[48:51]
    ds_read_b64_tr_b16 v[60:61], v18 offset:160
    ds_read_b64_tr_b16 v[62:63], v18 offset:3488
    s_waitcnt lgkmcnt(8)
    v_mfma_f32_16x16x32_bf16 a[4:7], v[44:47], v[36:39], a[4:7]
    v_mfma_f32_16x16x32_bf16 a[52:55], v[44:47], v[40:43], a[52:55]
    s_mov_b32 s32, 13312
    buffer_load_dwordx4 v[28:31], v14, s[8:11], s32 offen
    ds_read_b64_tr_b16 v[44:45], v18 offset:192
    ds_read_b64_tr_b16 v[46:47], v18 offset:3520
    s_waitcnt lgkmcnt(8)
    v_mfma_f32_16x16x32_bf16 a[8:11], v[48:51], v[36:39], a[8:11]
    v_mfma_f32_16x16x32_bf16 a[56:59], v[48:51], v[40:43], a[56:59]
    ds_read_b64_tr_b16 v[48:49], v18 offset:224
    ds_read_b64_tr_b16 v[50:51], v18 offset:3552
    s_waitcnt lgkmcnt(8)
    v_mfma_f32_16x16x32_bf16 a[12:15], v[52:55], v[36:39], a[12:15]
    v_mfma_f32_16x16x32_bf16 a[60:63], v[52:55], v[40:43], a[60:63]
    buffer_load_dwordx4 v[32:35], v15, s[8:11], s32 offen
    ds_read_b64_tr_b16 v[52:53], v18 offset:256
    ds_read_b64_tr_b16 v[54:55], v18 offset:3584
    s_waitcnt lgkmcnt(8)
    v_mfma_f32_16x16x32_bf16 a[16:19], v[56:59], v[36:39], a[16:19]
    v_mfma_f32_16x16x32_bf16 a[64:67], v[56:59], v[40:43], a[64:67]
    ds_read_b64_tr_b16 v[56:57], v18 offset:288
    ds_read_b64_tr_b16 v[58:59], v18 offset:3616
    s_waitcnt lgkmcnt(8)
    v_mfma_f32_16x16x32_bf16 a[20:23], v[60:63], v[36:39], a[20:23]
    v_mfma_f32_16x16x32_bf16 a[68:71], v[60:63], v[40:43], a[68:71]
    s_add_u32 m0, s29, 81920
    s_nop 0
    buffer_load_dwordx4 v12, s[12:15], s31 offen lds
    ds_read_b64_tr_b16 v[60:61], v18 offset:320
    ds_read_b64_tr_b16 v[62:63], v18 offset:3648
    s_waitcnt lgkmcnt(8)
    v_mfma_f32_16x16x32_bf16 a[24:27], v[44:47], v[36:39], a[24:27]
    v_mfma_f32_16x16x32_bf16 a[72:75], v[44:47], v[40:43], a[72:75]
    ds_read_b64_tr_b16 v[44:45], v18 offset:352
    ds_read_b64_tr_b16 v[46:47], v18 offset:3680
    s_waitcnt lgkmcnt(8)
    v_mfma_f32_16x16x32_bf16 a[28:31], v[48:51], v[36:39], a[28:31]
    v_mfma_f32_16x16x32_bf16 a[76:79], v[48:51], v[40:43], a[76:79]
    s_add_u32 m0, s29, 82944
    s_mov_b64 exec, 0xffff
    buffer_load_dwordx4 v13, s[12:15], s31 offen lds
    s_mov_b64 exec, -1
    ds_read_b64_tr_b16 v[48:49], v18 offset:13312
    ds_read_b64_tr_b16 v[50:51], v18 offset:16640
    s_waitcnt lgkmcnt(8)
    v_mfma_f32_16x16x32_bf16 a[32:35], v[52:55], v[36:39], a[32:35]
    v_mfma_f32_16x16x32_bf16 a[80:83], v[52:55], v[40:43], a[80:83]
    ds_read_b64_tr_b16 v[52:53], v18 offset:13344
    ds_read_b64_tr_b16 v[54:55], v18 offset:16672
    s_waitcnt lgkmcnt(8)
    v_mfma_f32_16x16x32_bf16 a[36:39], v[56:59], v[36:39], a[36:39]
    v_mfma_f32_16x16x32_bf16 a[84:87], v[56:59], v[40:43], a[84:87]
    ds_read_b64_tr_b16 v[56:57], v18 offset:13376
    ds_read_b64_tr_b16 v[58:59], v18 offset:16704
    s_waitcnt lgkmcnt(8)
    v_mfma_f32_16x16x32_bf16 a[40:43], v[60:63], v[36:39], a[40:43]
    v_mfma_f32_16x16x32_bf16 a[88:91], v[60:63], v[40:43], a[88:91]
    ds_read_b64_tr_b16 v[60:61], v18 offset:13408
    ds_read_b64_tr_b16 v[62:63], v18 offset:16736
    s_waitcnt lgkmcnt(8)
    v_mfma_f32_16x16x32_bf16 a[44:47], v[44:47], v[36:39], a[44:47]
    v_mfma_f32_16x16x32_bf16 a[92:95], v[44:47], v[40:43], a[92:95]
    ds_read_b64_tr_b16 v[44:45], v18 offset:13440
    ds_read_b64_tr_b16 v[46:47], v18 offset:16768
    s_waitcnt lgkmcnt(8)
    v_mfma_f32_16x16x32_bf16 a[96:99], v[48:51], v[36:39], a[96:99]
    v_mfma_f32_16x16x32_bf16 v[80:83], v[48:51], v[40:43], v[80:83]
    ds_read_b64_tr_b16 v[48:49], v18 offset:13472
    ds_read_b64_tr_b16 v[50:51], v18 offset:16800
    s_waitcnt lgkmcnt(8)
    v_mfma_f32_16x16x32_bf16 a[100:103], v[52:55], v[36:39], a[100:103]
    v_mfma_f32_16x16x32_bf16 v[84:87], v[52:55], v[40:43], v[84:87]
    ds_read_b64_tr_b16 v[52:53], v18 offset:13504
    ds_read_b64_tr_b16 v[54:55], v18 offset:16832
    s_waitcnt lgkmcnt(8)
    v_mfma_f32_16x16x32_bf16 a[104:107], v[56:59], v[36:39], a[104:107]
    v_mfma_f32_16x16x32_bf16 v[88:91], v[56:59], v[40:43], v[88:91]
    ds_read_b64_tr_b16 v[56:57], v18 offset:13536
    ds_read_b64_tr_b16 v[58:59], v18 offset:16864
    s_waitcnt lgkmcnt(8)
    v_mfma_f32_16x16x32_bf16 a[108:111], v[60:63], v[36:39], a[108:111]
    v_mfma_f32_16x16x32_bf16 v[92:95], v[60:63], v[40:43], v[92:95]
    ds_read_b64_tr_b16 v[60:61], v18 offset:13568
    ds_read_b64_tr_b16 v[62:63], v18 offset:16896
    s_waitcnt lgkmcnt(8)
    v_mfma_f32_16x16x32_bf16 a[112:115], v[44:47], v[36:39], a[112:115]
    v_mfma_f32_16x16x32_bf16 v[96:99], v[44:47], v[40:43], v[96:99]
    ds_read_b64_tr_b16 v[44:45], v18 offset:13600
    ds_read_b64_tr_b16 v[46:47], v18 offset:16928
    s_waitcnt lgkmcnt(8)
    v_mfma_f32_16x16x32_bf16 a[116:119], v[48:51], v[36:39], a[116:119]
    v_mfma_f32_16x16x32_bf16 v[100:103], v[48:51], v[40:43], v[100:103]
    ds_read_b64_tr_b16 v[48:49], v18 offset:13632
    ds_read_b64_tr_b16 v[50:51], v18 offset:16960
    s_waitcnt lgkmcnt(8)
    v_mfma_f32_16x16x32_bf16 a[120:123], v[52:55], v[36:39], a[120:123]
    v_mfma_f32_16x16x32_bf16 v[104:107], v[52:55], v[40:43], v[104:107]
    ds_read_b64_tr_b16 v[52:53], v18 offset:13664
    ds_read_b64_tr_b16 v[54:55], v18 offset:16992
    s_waitcnt lgkmcnt(8)
    v_mfma_f32_16x16x32_bf16 a[124:127], v[56:59], v[36:39], a[124:127]
    v_mfma_f32_16x16x32_bf16 v[108:111], v[56:59], v[40:43], v[108:111]
    s_barrier
    v_add_u32 v17, 0, v16
    ds_read_b64_tr_b16 v[56:57], v17 offset:0
    ds_read_b64_tr_b16 v[58:59], v17 offset:3328
    s_waitcnt lgkmcnt(8)
    v_mfma_f32_16x16x32_bf16 v[64:67], v[60:63], v[36:39], v[64:67]
    v_mfma_f32_16x16x32_bf16 v[112:115], v[60:63], v[40:43], v[112:115]
    ds_read_b64_tr_b16 v[60:61], v17 offset:32
    ds_read_b64_tr_b16 v[62:63], v17 offset:3360
    s_waitcnt lgkmcnt(8)
    v_mfma_f32_16x16x32_bf16 v[68:71], v[44:47], v[36:39], v[68:71]
    v_mfma_f32_16x16x32_bf16 v[116:119], v[44:47], v[40:43], v[116:119]
    s_mov_b32 s31, 4718592
    s_add_u32 m0, s29, 106496
    s_nop 0
    buffer_load_dwordx4 v10, s[12:15], s31 offen lds
    ds_read_b64_tr_b16 v[44:45], v17 offset:64
    ds_read_b64_tr_b16 v[46:47], v17 offset:3392
    s_waitcnt lgkmcnt(8)
    v_mfma_f32_16x16x32_bf16 v[72:75], v[48:51], v[36:39], v[72:75]
    v_mfma_f32_16x16x32_bf16 v[120:123], v[48:51], v[40:43], v[120:123]
    ds_read_b64_tr_b16 v[48:49], v17 offset:96
    ds_read_b64_tr_b16 v[50:51], v17 offset:3424
    s_waitcnt lgkmcnt(8)
    v_mfma_f32_16x16x32_bf16 v[76:79], v[52:55], v[36:39], v[76:79]
    v_mfma_f32_16x16x32_bf16 v[124:127], v[52:55], v[40:43], v[124:127]
    s_add_u32 m0, s29, 107520
    s_nop 0
    buffer_load_dwordx4 v11, s[12:15], s31 offen lds
    ds_read_b64_tr_b16 v[52:53], v17 offset:128
    ds_read_b64_tr_b16 v[54:55], v17 offset:3456
    s_waitcnt vmcnt(10)
    s_waitcnt lgkmcnt(8)
    v_mfma_f32_16x16x32_bf16 a[0:3], v[56:59], v[20:23], a[0:3]
    v_mfma_f32_16x16x32_bf16 a[48:51], v[56:59], v[24:27], a[48:51]
    ds_read_b64_tr_b16 v[56:57], v17 offset:160
    ds_read_b64_tr_b16 v[58:59], v17 offset:3488
    s_waitcnt lgkmcnt(8)
    v_mfma_f32_16x16x32_bf16 a[4:7], v[60:63], v[20:23], a[4:7]
    v_mfma_f32_16x16x32_bf16 a[52:55], v[60:63], v[24:27], a[52:55]
    s_mov_b32 s32, 14336
    buffer_load_dwordx4 v[36:39], v14, s[8:11], s32 offen
    ds_read_b64_tr_b16 v[60:61], v17 offset:192
    ds_read_b64_tr_b16 v[62:63], v17 offset:3520
    s_waitcnt lgkmcnt(8)
    v_mfma_f32_16x16x32_bf16 a[8:11], v[44:47], v[20:23], a[8:11]
    v_mfma_f32_16x16x32_bf16 a[56:59], v[44:47], v[24:27], a[56:59]
    ds_read_b64_tr_b16 v[44:45], v17 offset:224
    ds_read_b64_tr_b16 v[46:47], v17 offset:3552
    s_waitcnt lgkmcnt(8)
    v_mfma_f32_16x16x32_bf16 a[12:15], v[48:51], v[20:23], a[12:15]
    v_mfma_f32_16x16x32_bf16 a[60:63], v[48:51], v[24:27], a[60:63]
    buffer_load_dwordx4 v[40:43], v15, s[8:11], s32 offen
    ds_read_b64_tr_b16 v[48:49], v17 offset:256
    ds_read_b64_tr_b16 v[50:51], v17 offset:3584
    s_waitcnt lgkmcnt(8)
    v_mfma_f32_16x16x32_bf16 a[16:19], v[52:55], v[20:23], a[16:19]
    v_mfma_f32_16x16x32_bf16 a[64:67], v[52:55], v[24:27], a[64:67]
    ds_read_b64_tr_b16 v[52:53], v17 offset:288
    ds_read_b64_tr_b16 v[54:55], v17 offset:3616
    s_waitcnt lgkmcnt(8)
    v_mfma_f32_16x16x32_bf16 a[20:23], v[56:59], v[20:23], a[20:23]
    v_mfma_f32_16x16x32_bf16 a[68:71], v[56:59], v[24:27], a[68:71]
    s_add_u32 m0, s29, 108544
    s_nop 0
    buffer_load_dwordx4 v12, s[12:15], s31 offen lds
    ds_read_b64_tr_b16 v[56:57], v17 offset:320
    ds_read_b64_tr_b16 v[58:59], v17 offset:3648
    s_waitcnt lgkmcnt(8)
    v_mfma_f32_16x16x32_bf16 a[24:27], v[60:63], v[20:23], a[24:27]
    v_mfma_f32_16x16x32_bf16 a[72:75], v[60:63], v[24:27], a[72:75]
    ds_read_b64_tr_b16 v[60:61], v17 offset:352
    ds_read_b64_tr_b16 v[62:63], v17 offset:3680
    s_waitcnt lgkmcnt(8)
    v_mfma_f32_16x16x32_bf16 a[28:31], v[44:47], v[20:23], a[28:31]
    v_mfma_f32_16x16x32_bf16 a[76:79], v[44:47], v[24:27], a[76:79]
    s_add_u32 m0, s29, 109568
    s_mov_b64 exec, 0xffff
    buffer_load_dwordx4 v13, s[12:15], s31 offen lds
    s_mov_b64 exec, -1
    ds_read_b64_tr_b16 v[44:45], v17 offset:13312
    ds_read_b64_tr_b16 v[46:47], v17 offset:16640
    s_waitcnt lgkmcnt(8)
    v_mfma_f32_16x16x32_bf16 a[32:35], v[48:51], v[20:23], a[32:35]
    v_mfma_f32_16x16x32_bf16 a[80:83], v[48:51], v[24:27], a[80:83]
    ds_read_b64_tr_b16 v[48:49], v17 offset:13344
    ds_read_b64_tr_b16 v[50:51], v17 offset:16672
    s_waitcnt lgkmcnt(8)
    v_mfma_f32_16x16x32_bf16 a[36:39], v[52:55], v[20:23], a[36:39]
    v_mfma_f32_16x16x32_bf16 a[84:87], v[52:55], v[24:27], a[84:87]
    ds_read_b64_tr_b16 v[52:53], v17 offset:13376
    ds_read_b64_tr_b16 v[54:55], v17 offset:16704
    s_waitcnt lgkmcnt(8)
    v_mfma_f32_16x16x32_bf16 a[40:43], v[56:59], v[20:23], a[40:43]
    v_mfma_f32_16x16x32_bf16 a[88:91], v[56:59], v[24:27], a[88:91]
    ds_read_b64_tr_b16 v[56:57], v17 offset:13408
    ds_read_b64_tr_b16 v[58:59], v17 offset:16736
    s_waitcnt lgkmcnt(8)
    v_mfma_f32_16x16x32_bf16 a[44:47], v[60:63], v[20:23], a[44:47]
    v_mfma_f32_16x16x32_bf16 a[92:95], v[60:63], v[24:27], a[92:95]
    ds_read_b64_tr_b16 v[60:61], v17 offset:13440
    ds_read_b64_tr_b16 v[62:63], v17 offset:16768
    s_waitcnt lgkmcnt(8)
    v_mfma_f32_16x16x32_bf16 a[96:99], v[44:47], v[20:23], a[96:99]
    v_mfma_f32_16x16x32_bf16 v[80:83], v[44:47], v[24:27], v[80:83]
    ds_read_b64_tr_b16 v[44:45], v17 offset:13472
    ds_read_b64_tr_b16 v[46:47], v17 offset:16800
    s_waitcnt lgkmcnt(8)
    v_mfma_f32_16x16x32_bf16 a[100:103], v[48:51], v[20:23], a[100:103]
    v_mfma_f32_16x16x32_bf16 v[84:87], v[48:51], v[24:27], v[84:87]
    ds_read_b64_tr_b16 v[48:49], v17 offset:13504
    ds_read_b64_tr_b16 v[50:51], v17 offset:16832
    s_waitcnt lgkmcnt(8)
    v_mfma_f32_16x16x32_bf16 a[104:107], v[52:55], v[20:23], a[104:107]
    v_mfma_f32_16x16x32_bf16 v[88:91], v[52:55], v[24:27], v[88:91]
    ds_read_b64_tr_b16 v[52:53], v17 offset:13536
    ds_read_b64_tr_b16 v[54:55], v17 offset:16864
    s_waitcnt lgkmcnt(8)
    v_mfma_f32_16x16x32_bf16 a[108:111], v[56:59], v[20:23], a[108:111]
    v_mfma_f32_16x16x32_bf16 v[92:95], v[56:59], v[24:27], v[92:95]
    ds_read_b64_tr_b16 v[56:57], v17 offset:13568
    ds_read_b64_tr_b16 v[58:59], v17 offset:16896
    s_waitcnt lgkmcnt(8)
    v_mfma_f32_16x16x32_bf16 a[112:115], v[60:63], v[20:23], a[112:115]
    v_mfma_f32_16x16x32_bf16 v[96:99], v[60:63], v[24:27], v[96:99]
    ds_read_b64_tr_b16 v[60:61], v17 offset:13600
    ds_read_b64_tr_b16 v[62:63], v17 offset:16928
    s_waitcnt lgkmcnt(8)
    v_mfma_f32_16x16x32_bf16 a[116:119], v[44:47], v[20:23], a[116:119]
    v_mfma_f32_16x16x32_bf16 v[100:103], v[44:47], v[24:27], v[100:103]
    ds_read_b64_tr_b16 v[44:45], v17 offset:13632
    ds_read_b64_tr_b16 v[46:47], v17 offset:16960
    s_waitcnt lgkmcnt(8)
    v_mfma_f32_16x16x32_bf16 a[120:123], v[48:51], v[20:23], a[120:123]
    v_mfma_f32_16x16x32_bf16 v[104:107], v[48:51], v[24:27], v[104:107]
    ds_read_b64_tr_b16 v[48:49], v17 offset:13664
    ds_read_b64_tr_b16 v[50:51], v17 offset:16992
    s_waitcnt lgkmcnt(8)
    v_mfma_f32_16x16x32_bf16 a[124:127], v[52:55], v[20:23], a[124:127]
    v_mfma_f32_16x16x32_bf16 v[108:111], v[52:55], v[24:27], v[108:111]
    s_barrier
    v_add_u32 v18, 26624, v16
    ds_read_b64_tr_b16 v[52:53], v18 offset:0
    ds_read_b64_tr_b16 v[54:55], v18 offset:3328
    s_waitcnt lgkmcnt(8)
    v_mfma_f32_16x16x32_bf16 v[64:67], v[56:59], v[20:23], v[64:67]
    v_mfma_f32_16x16x32_bf16 v[112:115], v[56:59], v[24:27], v[112:115]
    ds_read_b64_tr_b16 v[56:57], v18 offset:32
    ds_read_b64_tr_b16 v[58:59], v18 offset:3360
    s_waitcnt lgkmcnt(8)
    v_mfma_f32_16x16x32_bf16 v[68:71], v[60:63], v[20:23], v[68:71]
    v_mfma_f32_16x16x32_bf16 v[116:119], v[60:63], v[24:27], v[116:119]
    s_mov_b32 s31, 5013504
    s_add_u32 m0, s29, 133120
    s_nop 0
    buffer_load_dwordx4 v10, s[12:15], s31 offen lds
    ds_read_b64_tr_b16 v[60:61], v18 offset:64
    ds_read_b64_tr_b16 v[62:63], v18 offset:3392
    s_waitcnt lgkmcnt(8)
    v_mfma_f32_16x16x32_bf16 v[72:75], v[44:47], v[20:23], v[72:75]
    v_mfma_f32_16x16x32_bf16 v[120:123], v[44:47], v[24:27], v[120:123]
    ds_read_b64_tr_b16 v[44:45], v18 offset:96
    ds_read_b64_tr_b16 v[46:47], v18 offset:3424
    s_waitcnt lgkmcnt(8)
    v_mfma_f32_16x16x32_bf16 v[76:79], v[48:51], v[20:23], v[76:79]
    v_mfma_f32_16x16x32_bf16 v[124:127], v[48:51], v[24:27], v[124:127]
    s_add_u32 m0, s29, 134144
    s_nop 0
    buffer_load_dwordx4 v11, s[12:15], s31 offen lds
    ds_read_b64_tr_b16 v[48:49], v18 offset:128
    ds_read_b64_tr_b16 v[50:51], v18 offset:3456
    s_waitcnt vmcnt(10)
    s_waitcnt lgkmcnt(8)
    v_mfma_f32_16x16x32_bf16 a[0:3], v[52:55], v[28:31], a[0:3]
    v_mfma_f32_16x16x32_bf16 a[48:51], v[52:55], v[32:35], a[48:51]
    ds_read_b64_tr_b16 v[52:53], v18 offset:160
    ds_read_b64_tr_b16 v[54:55], v18 offset:3488
    s_waitcnt lgkmcnt(8)
    v_mfma_f32_16x16x32_bf16 a[4:7], v[56:59], v[28:31], a[4:7]
    v_mfma_f32_16x16x32_bf16 a[52:55], v[56:59], v[32:35], a[52:55]
    s_mov_b32 s32, 15360
    buffer_load_dwordx4 v[20:23], v14, s[8:11], s32 offen
    ds_read_b64_tr_b16 v[56:57], v18 offset:192
    ds_read_b64_tr_b16 v[58:59], v18 offset:3520
    s_waitcnt lgkmcnt(8)
    v_mfma_f32_16x16x32_bf16 a[8:11], v[60:63], v[28:31], a[8:11]
    v_mfma_f32_16x16x32_bf16 a[56:59], v[60:63], v[32:35], a[56:59]
    ds_read_b64_tr_b16 v[60:61], v18 offset:224
    ds_read_b64_tr_b16 v[62:63], v18 offset:3552
    s_waitcnt lgkmcnt(8)
    v_mfma_f32_16x16x32_bf16 a[12:15], v[44:47], v[28:31], a[12:15]
    v_mfma_f32_16x16x32_bf16 a[60:63], v[44:47], v[32:35], a[60:63]
    buffer_load_dwordx4 v[24:27], v15, s[8:11], s32 offen
    ds_read_b64_tr_b16 v[44:45], v18 offset:256
    ds_read_b64_tr_b16 v[46:47], v18 offset:3584
    s_waitcnt lgkmcnt(8)
    v_mfma_f32_16x16x32_bf16 a[16:19], v[48:51], v[28:31], a[16:19]
    v_mfma_f32_16x16x32_bf16 a[64:67], v[48:51], v[32:35], a[64:67]
    ds_read_b64_tr_b16 v[48:49], v18 offset:288
    ds_read_b64_tr_b16 v[50:51], v18 offset:3616
    s_waitcnt lgkmcnt(8)
    v_mfma_f32_16x16x32_bf16 a[20:23], v[52:55], v[28:31], a[20:23]
    v_mfma_f32_16x16x32_bf16 a[68:71], v[52:55], v[32:35], a[68:71]
    s_add_u32 m0, s29, 135168
    s_nop 0
    buffer_load_dwordx4 v12, s[12:15], s31 offen lds
    ds_read_b64_tr_b16 v[52:53], v18 offset:320
    ds_read_b64_tr_b16 v[54:55], v18 offset:3648
    s_waitcnt lgkmcnt(8)
    v_mfma_f32_16x16x32_bf16 a[24:27], v[56:59], v[28:31], a[24:27]
    v_mfma_f32_16x16x32_bf16 a[72:75], v[56:59], v[32:35], a[72:75]
    ds_read_b64_tr_b16 v[56:57], v18 offset:352
    ds_read_b64_tr_b16 v[58:59], v18 offset:3680
    s_waitcnt lgkmcnt(8)
    v_mfma_f32_16x16x32_bf16 a[28:31], v[60:63], v[28:31], a[28:31]
    v_mfma_f32_16x16x32_bf16 a[76:79], v[60:63], v[32:35], a[76:79]
    s_add_u32 m0, s29, 136192
    s_mov_b64 exec, 0xffff
    buffer_load_dwordx4 v13, s[12:15], s31 offen lds
    s_mov_b64 exec, -1
    ds_read_b64_tr_b16 v[60:61], v18 offset:13312
    ds_read_b64_tr_b16 v[62:63], v18 offset:16640
    s_waitcnt lgkmcnt(8)
    v_mfma_f32_16x16x32_bf16 a[32:35], v[44:47], v[28:31], a[32:35]
    v_mfma_f32_16x16x32_bf16 a[80:83], v[44:47], v[32:35], a[80:83]
    ds_read_b64_tr_b16 v[44:45], v18 offset:13344
    ds_read_b64_tr_b16 v[46:47], v18 offset:16672
    s_waitcnt lgkmcnt(8)
    v_mfma_f32_16x16x32_bf16 a[36:39], v[48:51], v[28:31], a[36:39]
    v_mfma_f32_16x16x32_bf16 a[84:87], v[48:51], v[32:35], a[84:87]
    ds_read_b64_tr_b16 v[48:49], v18 offset:13376
    ds_read_b64_tr_b16 v[50:51], v18 offset:16704
    s_waitcnt lgkmcnt(8)
    v_mfma_f32_16x16x32_bf16 a[40:43], v[52:55], v[28:31], a[40:43]
    v_mfma_f32_16x16x32_bf16 a[88:91], v[52:55], v[32:35], a[88:91]
    ds_read_b64_tr_b16 v[52:53], v18 offset:13408
    ds_read_b64_tr_b16 v[54:55], v18 offset:16736
    s_waitcnt lgkmcnt(8)
    v_mfma_f32_16x16x32_bf16 a[44:47], v[56:59], v[28:31], a[44:47]
    v_mfma_f32_16x16x32_bf16 a[92:95], v[56:59], v[32:35], a[92:95]
    ds_read_b64_tr_b16 v[56:57], v18 offset:13440
    ds_read_b64_tr_b16 v[58:59], v18 offset:16768
    s_waitcnt lgkmcnt(8)
    v_mfma_f32_16x16x32_bf16 a[96:99], v[60:63], v[28:31], a[96:99]
    v_mfma_f32_16x16x32_bf16 v[80:83], v[60:63], v[32:35], v[80:83]
    ds_read_b64_tr_b16 v[60:61], v18 offset:13472
    ds_read_b64_tr_b16 v[62:63], v18 offset:16800
    s_waitcnt lgkmcnt(8)
    v_mfma_f32_16x16x32_bf16 a[100:103], v[44:47], v[28:31], a[100:103]
    v_mfma_f32_16x16x32_bf16 v[84:87], v[44:47], v[32:35], v[84:87]
    ds_read_b64_tr_b16 v[44:45], v18 offset:13504
    ds_read_b64_tr_b16 v[46:47], v18 offset:16832
    s_waitcnt lgkmcnt(8)
    v_mfma_f32_16x16x32_bf16 a[104:107], v[48:51], v[28:31], a[104:107]
    v_mfma_f32_16x16x32_bf16 v[88:91], v[48:51], v[32:35], v[88:91]
    ds_read_b64_tr_b16 v[48:49], v18 offset:13536
    ds_read_b64_tr_b16 v[50:51], v18 offset:16864
    s_waitcnt lgkmcnt(8)
    v_mfma_f32_16x16x32_bf16 a[108:111], v[52:55], v[28:31], a[108:111]
    v_mfma_f32_16x16x32_bf16 v[92:95], v[52:55], v[32:35], v[92:95]
    ds_read_b64_tr_b16 v[52:53], v18 offset:13568
    ds_read_b64_tr_b16 v[54:55], v18 offset:16896
    s_waitcnt lgkmcnt(8)
    v_mfma_f32_16x16x32_bf16 a[112:115], v[56:59], v[28:31], a[112:115]
    v_mfma_f32_16x16x32_bf16 v[96:99], v[56:59], v[32:35], v[96:99]
    ds_read_b64_tr_b16 v[56:57], v18 offset:13600
    ds_read_b64_tr_b16 v[58:59], v18 offset:16928
    s_waitcnt lgkmcnt(8)
    v_mfma_f32_16x16x32_bf16 a[116:119], v[60:63], v[28:31], a[116:119]
    v_mfma_f32_16x16x32_bf16 v[100:103], v[60:63], v[32:35], v[100:103]
    ds_read_b64_tr_b16 v[60:61], v18 offset:13632
    ds_read_b64_tr_b16 v[62:63], v18 offset:16960
    s_waitcnt lgkmcnt(8)
    v_mfma_f32_16x16x32_bf16 a[120:123], v[44:47], v[28:31], a[120:123]
    v_mfma_f32_16x16x32_bf16 v[104:107], v[44:47], v[32:35], v[104:107]
    ds_read_b64_tr_b16 v[44:45], v18 offset:13664
    ds_read_b64_tr_b16 v[46:47], v18 offset:16992
    s_waitcnt lgkmcnt(8)
    v_mfma_f32_16x16x32_bf16 a[124:127], v[48:51], v[28:31], a[124:127]
    v_mfma_f32_16x16x32_bf16 v[108:111], v[48:51], v[32:35], v[108:111]
    s_barrier
    v_add_u32 v17, 53248, v16
    ds_read_b64_tr_b16 v[48:49], v17 offset:0
    ds_read_b64_tr_b16 v[50:51], v17 offset:3328
    s_waitcnt lgkmcnt(8)
    v_mfma_f32_16x16x32_bf16 v[64:67], v[52:55], v[28:31], v[64:67]
    v_mfma_f32_16x16x32_bf16 v[112:115], v[52:55], v[32:35], v[112:115]
    ds_read_b64_tr_b16 v[52:53], v17 offset:32
    ds_read_b64_tr_b16 v[54:55], v17 offset:3360
    s_waitcnt lgkmcnt(8)
    v_mfma_f32_16x16x32_bf16 v[68:71], v[56:59], v[28:31], v[68:71]
    v_mfma_f32_16x16x32_bf16 v[116:119], v[56:59], v[32:35], v[116:119]
    ds_read_b64_tr_b16 v[56:57], v17 offset:64
    ds_read_b64_tr_b16 v[58:59], v17 offset:3392
    s_waitcnt lgkmcnt(8)
    v_mfma_f32_16x16x32_bf16 v[72:75], v[60:63], v[28:31], v[72:75]
    v_mfma_f32_16x16x32_bf16 v[120:123], v[60:63], v[32:35], v[120:123]
    ds_read_b64_tr_b16 v[60:61], v17 offset:96
    ds_read_b64_tr_b16 v[62:63], v17 offset:3424
    s_waitcnt lgkmcnt(8)
    v_mfma_f32_16x16x32_bf16 v[76:79], v[44:47], v[28:31], v[76:79]
    v_mfma_f32_16x16x32_bf16 v[124:127], v[44:47], v[32:35], v[124:127]
    ds_read_b64_tr_b16 v[44:45], v17 offset:128
    ds_read_b64_tr_b16 v[46:47], v17 offset:3456
    s_waitcnt vmcnt(8)
    s_waitcnt lgkmcnt(8)
    v_mfma_f32_16x16x32_bf16 a[0:3], v[48:51], v[36:39], a[0:3]
    v_mfma_f32_16x16x32_bf16 a[48:51], v[48:51], v[40:43], a[48:51]
    ds_read_b64_tr_b16 v[48:49], v17 offset:160
    ds_read_b64_tr_b16 v[50:51], v17 offset:3488
    s_waitcnt lgkmcnt(8)
    v_mfma_f32_16x16x32_bf16 a[4:7], v[52:55], v[36:39], a[4:7]
    v_mfma_f32_16x16x32_bf16 a[52:55], v[52:55], v[40:43], a[52:55]
    s_mov_b32 s32, 16384
    buffer_load_dwordx4 v[28:31], v14, s[8:11], s32 offen
    ds_read_b64_tr_b16 v[52:53], v17 offset:192
    ds_read_b64_tr_b16 v[54:55], v17 offset:3520
    s_waitcnt lgkmcnt(8)
    v_mfma_f32_16x16x32_bf16 a[8:11], v[56:59], v[36:39], a[8:11]
    v_mfma_f32_16x16x32_bf16 a[56:59], v[56:59], v[40:43], a[56:59]
    ds_read_b64_tr_b16 v[56:57], v17 offset:224
    ds_read_b64_tr_b16 v[58:59], v17 offset:3552
    s_waitcnt lgkmcnt(8)
    v_mfma_f32_16x16x32_bf16 a[12:15], v[60:63], v[36:39], a[12:15]
    v_mfma_f32_16x16x32_bf16 a[60:63], v[60:63], v[40:43], a[60:63]
    buffer_load_dwordx4 v[32:35], v15, s[8:11], s32 offen
    ds_read_b64_tr_b16 v[60:61], v17 offset:256
    ds_read_b64_tr_b16 v[62:63], v17 offset:3584
    s_waitcnt lgkmcnt(8)
    v_mfma_f32_16x16x32_bf16 a[16:19], v[44:47], v[36:39], a[16:19]
    v_mfma_f32_16x16x32_bf16 a[64:67], v[44:47], v[40:43], a[64:67]
    ds_read_b64_tr_b16 v[44:45], v17 offset:288
    ds_read_b64_tr_b16 v[46:47], v17 offset:3616
    s_waitcnt lgkmcnt(8)
    v_mfma_f32_16x16x32_bf16 a[20:23], v[48:51], v[36:39], a[20:23]
    v_mfma_f32_16x16x32_bf16 a[68:71], v[48:51], v[40:43], a[68:71]
    ds_read_b64_tr_b16 v[48:49], v17 offset:320
    ds_read_b64_tr_b16 v[50:51], v17 offset:3648
    s_waitcnt lgkmcnt(8)
    v_mfma_f32_16x16x32_bf16 a[24:27], v[52:55], v[36:39], a[24:27]
    v_mfma_f32_16x16x32_bf16 a[72:75], v[52:55], v[40:43], a[72:75]
    ds_read_b64_tr_b16 v[52:53], v17 offset:352
    ds_read_b64_tr_b16 v[54:55], v17 offset:3680
    s_waitcnt lgkmcnt(8)
    v_mfma_f32_16x16x32_bf16 a[28:31], v[56:59], v[36:39], a[28:31]
    v_mfma_f32_16x16x32_bf16 a[76:79], v[56:59], v[40:43], a[76:79]
    ds_read_b64_tr_b16 v[56:57], v17 offset:13312
    ds_read_b64_tr_b16 v[58:59], v17 offset:16640
    s_waitcnt lgkmcnt(8)
    v_mfma_f32_16x16x32_bf16 a[32:35], v[60:63], v[36:39], a[32:35]
    v_mfma_f32_16x16x32_bf16 a[80:83], v[60:63], v[40:43], a[80:83]
    ds_read_b64_tr_b16 v[60:61], v17 offset:13344
    ds_read_b64_tr_b16 v[62:63], v17 offset:16672
    s_waitcnt lgkmcnt(8)
    v_mfma_f32_16x16x32_bf16 a[36:39], v[44:47], v[36:39], a[36:39]
    v_mfma_f32_16x16x32_bf16 a[84:87], v[44:47], v[40:43], a[84:87]
    ds_read_b64_tr_b16 v[44:45], v17 offset:13376
    ds_read_b64_tr_b16 v[46:47], v17 offset:16704
    s_waitcnt lgkmcnt(8)
    v_mfma_f32_16x16x32_bf16 a[40:43], v[48:51], v[36:39], a[40:43]
    v_mfma_f32_16x16x32_bf16 a[88:91], v[48:51], v[40:43], a[88:91]
    ds_read_b64_tr_b16 v[48:49], v17 offset:13408
    ds_read_b64_tr_b16 v[50:51], v17 offset:16736
    s_waitcnt lgkmcnt(8)
    v_mfma_f32_16x16x32_bf16 a[44:47], v[52:55], v[36:39], a[44:47]
    v_mfma_f32_16x16x32_bf16 a[92:95], v[52:55], v[40:43], a[92:95]
    ds_read_b64_tr_b16 v[52:53], v17 offset:13440
    ds_read_b64_tr_b16 v[54:55], v17 offset:16768
    s_waitcnt lgkmcnt(8)
    v_mfma_f32_16x16x32_bf16 a[96:99], v[56:59], v[36:39], a[96:99]
    v_mfma_f32_16x16x32_bf16 v[80:83], v[56:59], v[40:43], v[80:83]
    ds_read_b64_tr_b16 v[56:57], v17 offset:13472
    ds_read_b64_tr_b16 v[58:59], v17 offset:16800
    s_waitcnt lgkmcnt(8)
    v_mfma_f32_16x16x32_bf16 a[100:103], v[60:63], v[36:39], a[100:103]
    v_mfma_f32_16x16x32_bf16 v[84:87], v[60:63], v[40:43], v[84:87]
    ds_read_b64_tr_b16 v[60:61], v17 offset:13504
    ds_read_b64_tr_b16 v[62:63], v17 offset:16832
    s_waitcnt lgkmcnt(8)
    v_mfma_f32_16x16x32_bf16 a[104:107], v[44:47], v[36:39], a[104:107]
    v_mfma_f32_16x16x32_bf16 v[88:91], v[44:47], v[40:43], v[88:91]
    ds_read_b64_tr_b16 v[44:45], v17 offset:13536
    ds_read_b64_tr_b16 v[46:47], v17 offset:16864
    s_waitcnt lgkmcnt(8)
    v_mfma_f32_16x16x32_bf16 a[108:111], v[48:51], v[36:39], a[108:111]
    v_mfma_f32_16x16x32_bf16 v[92:95], v[48:51], v[40:43], v[92:95]
    ds_read_b64_tr_b16 v[48:49], v17 offset:13568
    ds_read_b64_tr_b16 v[50:51], v17 offset:16896
    s_waitcnt lgkmcnt(8)
    v_mfma_f32_16x16x32_bf16 a[112:115], v[52:55], v[36:39], a[112:115]
    v_mfma_f32_16x16x32_bf16 v[96:99], v[52:55], v[40:43], v[96:99]
    ds_read_b64_tr_b16 v[52:53], v17 offset:13600
    ds_read_b64_tr_b16 v[54:55], v17 offset:16928
    s_waitcnt lgkmcnt(8)
    v_mfma_f32_16x16x32_bf16 a[116:119], v[56:59], v[36:39], a[116:119]
    v_mfma_f32_16x16x32_bf16 v[100:103], v[56:59], v[40:43], v[100:103]
    ds_read_b64_tr_b16 v[56:57], v17 offset:13632
    ds_read_b64_tr_b16 v[58:59], v17 offset:16960
    s_waitcnt lgkmcnt(8)
    v_mfma_f32_16x16x32_bf16 a[120:123], v[60:63], v[36:39], a[120:123]
    v_mfma_f32_16x16x32_bf16 v[104:107], v[60:63], v[40:43], v[104:107]
    ds_read_b64_tr_b16 v[60:61], v17 offset:13664
    ds_read_b64_tr_b16 v[62:63], v17 offset:16992
    s_waitcnt lgkmcnt(8)
    v_mfma_f32_16x16x32_bf16 a[124:127], v[44:47], v[36:39], a[124:127]
    v_mfma_f32_16x16x32_bf16 v[108:111], v[44:47], v[40:43], v[108:111]
    s_barrier
    v_add_u32 v18, 79872, v16
    ds_read_b64_tr_b16 v[44:45], v18 offset:0
    ds_read_b64_tr_b16 v[46:47], v18 offset:3328
    s_waitcnt lgkmcnt(8)
    v_mfma_f32_16x16x32_bf16 v[64:67], v[48:51], v[36:39], v[64:67]
    v_mfma_f32_16x16x32_bf16 v[112:115], v[48:51], v[40:43], v[112:115]
    ds_read_b64_tr_b16 v[48:49], v18 offset:32
    ds_read_b64_tr_b16 v[50:51], v18 offset:3360
    s_waitcnt lgkmcnt(8)
    v_mfma_f32_16x16x32_bf16 v[68:71], v[52:55], v[36:39], v[68:71]
    v_mfma_f32_16x16x32_bf16 v[116:119], v[52:55], v[40:43], v[116:119]
    ds_read_b64_tr_b16 v[52:53], v18 offset:64
    ds_read_b64_tr_b16 v[54:55], v18 offset:3392
    s_waitcnt lgkmcnt(8)
    v_mfma_f32_16x16x32_bf16 v[72:75], v[56:59], v[36:39], v[72:75]
    v_mfma_f32_16x16x32_bf16 v[120:123], v[56:59], v[40:43], v[120:123]
    ds_read_b64_tr_b16 v[56:57], v18 offset:96
    ds_read_b64_tr_b16 v[58:59], v18 offset:3424
    s_waitcnt lgkmcnt(8)
    v_mfma_f32_16x16x32_bf16 v[76:79], v[60:63], v[36:39], v[76:79]
    v_mfma_f32_16x16x32_bf16 v[124:127], v[60:63], v[40:43], v[124:127]
    ds_read_b64_tr_b16 v[60:61], v18 offset:128
    ds_read_b64_tr_b16 v[62:63], v18 offset:3456
    s_waitcnt vmcnt(4)
    s_waitcnt lgkmcnt(8)
    v_mfma_f32_16x16x32_bf16 a[0:3], v[44:47], v[20:23], a[0:3]
    v_mfma_f32_16x16x32_bf16 a[48:51], v[44:47], v[24:27], a[48:51]
    ds_read_b64_tr_b16 v[44:45], v18 offset:160
    ds_read_b64_tr_b16 v[46:47], v18 offset:3488
    s_waitcnt lgkmcnt(8)
    v_mfma_f32_16x16x32_bf16 a[4:7], v[48:51], v[20:23], a[4:7]
    v_mfma_f32_16x16x32_bf16 a[52:55], v[48:51], v[24:27], a[52:55]
    s_mov_b32 s32, 17408
    buffer_load_dwordx4 v[36:39], v14, s[8:11], s32 offen
    ds_read_b64_tr_b16 v[48:49], v18 offset:192
    ds_read_b64_tr_b16 v[50:51], v18 offset:3520
    s_waitcnt lgkmcnt(8)
    v_mfma_f32_16x16x32_bf16 a[8:11], v[52:55], v[20:23], a[8:11]
    v_mfma_f32_16x16x32_bf16 a[56:59], v[52:55], v[24:27], a[56:59]
    ds_read_b64_tr_b16 v[52:53], v18 offset:224
    ds_read_b64_tr_b16 v[54:55], v18 offset:3552
    s_waitcnt lgkmcnt(8)
    v_mfma_f32_16x16x32_bf16 a[12:15], v[56:59], v[20:23], a[12:15]
    v_mfma_f32_16x16x32_bf16 a[60:63], v[56:59], v[24:27], a[60:63]
    buffer_load_dwordx4 v[40:43], v15, s[8:11], s32 offen
    ds_read_b64_tr_b16 v[56:57], v18 offset:256
    ds_read_b64_tr_b16 v[58:59], v18 offset:3584
    s_waitcnt lgkmcnt(8)
    v_mfma_f32_16x16x32_bf16 a[16:19], v[60:63], v[20:23], a[16:19]
    v_mfma_f32_16x16x32_bf16 a[64:67], v[60:63], v[24:27], a[64:67]
    ds_read_b64_tr_b16 v[60:61], v18 offset:288
    ds_read_b64_tr_b16 v[62:63], v18 offset:3616
    s_waitcnt lgkmcnt(8)
    v_mfma_f32_16x16x32_bf16 a[20:23], v[44:47], v[20:23], a[20:23]
    v_mfma_f32_16x16x32_bf16 a[68:71], v[44:47], v[24:27], a[68:71]
    ds_read_b64_tr_b16 v[44:45], v18 offset:320
    ds_read_b64_tr_b16 v[46:47], v18 offset:3648
    s_waitcnt lgkmcnt(8)
    v_mfma_f32_16x16x32_bf16 a[24:27], v[48:51], v[20:23], a[24:27]
    v_mfma_f32_16x16x32_bf16 a[72:75], v[48:51], v[24:27], a[72:75]
    ds_read_b64_tr_b16 v[48:49], v18 offset:352
    ds_read_b64_tr_b16 v[50:51], v18 offset:3680
    s_waitcnt lgkmcnt(8)
    v_mfma_f32_16x16x32_bf16 a[28:31], v[52:55], v[20:23], a[28:31]
    v_mfma_f32_16x16x32_bf16 a[76:79], v[52:55], v[24:27], a[76:79]
    ds_read_b64_tr_b16 v[52:53], v18 offset:13312
    ds_read_b64_tr_b16 v[54:55], v18 offset:16640
    s_waitcnt lgkmcnt(8)
    v_mfma_f32_16x16x32_bf16 a[32:35], v[56:59], v[20:23], a[32:35]
    v_mfma_f32_16x16x32_bf16 a[80:83], v[56:59], v[24:27], a[80:83]
    ds_read_b64_tr_b16 v[56:57], v18 offset:13344
    ds_read_b64_tr_b16 v[58:59], v18 offset:16672
    s_waitcnt lgkmcnt(8)
    v_mfma_f32_16x16x32_bf16 a[36:39], v[60:63], v[20:23], a[36:39]
    v_mfma_f32_16x16x32_bf16 a[84:87], v[60:63], v[24:27], a[84:87]
    ds_read_b64_tr_b16 v[60:61], v18 offset:13376
    ds_read_b64_tr_b16 v[62:63], v18 offset:16704
    s_waitcnt lgkmcnt(8)
    v_mfma_f32_16x16x32_bf16 a[40:43], v[44:47], v[20:23], a[40:43]
    v_mfma_f32_16x16x32_bf16 a[88:91], v[44:47], v[24:27], a[88:91]
    ds_read_b64_tr_b16 v[44:45], v18 offset:13408
    ds_read_b64_tr_b16 v[46:47], v18 offset:16736
    s_waitcnt lgkmcnt(8)
    v_mfma_f32_16x16x32_bf16 a[44:47], v[48:51], v[20:23], a[44:47]
    v_mfma_f32_16x16x32_bf16 a[92:95], v[48:51], v[24:27], a[92:95]
    ds_read_b64_tr_b16 v[48:49], v18 offset:13440
    ds_read_b64_tr_b16 v[50:51], v18 offset:16768
    s_waitcnt lgkmcnt(8)
    v_mfma_f32_16x16x32_bf16 a[96:99], v[52:55], v[20:23], a[96:99]
    v_mfma_f32_16x16x32_bf16 v[80:83], v[52:55], v[24:27], v[80:83]
    ds_read_b64_tr_b16 v[52:53], v18 offset:13472
    ds_read_b64_tr_b16 v[54:55], v18 offset:16800
    s_waitcnt lgkmcnt(8)
    v_mfma_f32_16x16x32_bf16 a[100:103], v[56:59], v[20:23], a[100:103]
    v_mfma_f32_16x16x32_bf16 v[84:87], v[56:59], v[24:27], v[84:87]
    ds_read_b64_tr_b16 v[56:57], v18 offset:13504
    ds_read_b64_tr_b16 v[58:59], v18 offset:16832
    s_waitcnt lgkmcnt(8)
    v_mfma_f32_16x16x32_bf16 a[104:107], v[60:63], v[20:23], a[104:107]
    v_mfma_f32_16x16x32_bf16 v[88:91], v[60:63], v[24:27], v[88:91]
    ds_read_b64_tr_b16 v[60:61], v18 offset:13536
    ds_read_b64_tr_b16 v[62:63], v18 offset:16864
    s_waitcnt lgkmcnt(8)
    v_mfma_f32_16x16x32_bf16 a[108:111], v[44:47], v[20:23], a[108:111]
    v_mfma_f32_16x16x32_bf16 v[92:95], v[44:47], v[24:27], v[92:95]
    ds_read_b64_tr_b16 v[44:45], v18 offset:13568
    ds_read_b64_tr_b16 v[46:47], v18 offset:16896
    s_waitcnt lgkmcnt(8)
    v_mfma_f32_16x16x32_bf16 a[112:115], v[48:51], v[20:23], a[112:115]
    v_mfma_f32_16x16x32_bf16 v[96:99], v[48:51], v[24:27], v[96:99]
    ds_read_b64_tr_b16 v[48:49], v18 offset:13600
    ds_read_b64_tr_b16 v[50:51], v18 offset:16928
    s_waitcnt lgkmcnt(8)
    v_mfma_f32_16x16x32_bf16 a[116:119], v[52:55], v[20:23], a[116:119]
    v_mfma_f32_16x16x32_bf16 v[100:103], v[52:55], v[24:27], v[100:103]
    ds_read_b64_tr_b16 v[52:53], v18 offset:13632
    ds_read_b64_tr_b16 v[54:55], v18 offset:16960
    s_waitcnt lgkmcnt(8)
    v_mfma_f32_16x16x32_bf16 a[120:123], v[56:59], v[20:23], a[120:123]
    v_mfma_f32_16x16x32_bf16 v[104:107], v[56:59], v[24:27], v[104:107]
    ds_read_b64_tr_b16 v[56:57], v18 offset:13664
    ds_read_b64_tr_b16 v[58:59], v18 offset:16992
    s_waitcnt lgkmcnt(8)
    v_mfma_f32_16x16x32_bf16 a[124:127], v[60:63], v[20:23], a[124:127]
    v_mfma_f32_16x16x32_bf16 v[108:111], v[60:63], v[24:27], v[108:111]
    s_barrier
    v_add_u32 v17, 106496, v16
    ds_read_b64_tr_b16 v[60:61], v17 offset:0
    ds_read_b64_tr_b16 v[62:63], v17 offset:3328
    s_waitcnt lgkmcnt(8)
    v_mfma_f32_16x16x32_bf16 v[64:67], v[44:47], v[20:23], v[64:67]
    v_mfma_f32_16x16x32_bf16 v[112:115], v[44:47], v[24:27], v[112:115]
    ds_read_b64_tr_b16 v[44:45], v17 offset:32
    ds_read_b64_tr_b16 v[46:47], v17 offset:3360
    s_waitcnt lgkmcnt(8)
    v_mfma_f32_16x16x32_bf16 v[68:71], v[48:51], v[20:23], v[68:71]
    v_mfma_f32_16x16x32_bf16 v[116:119], v[48:51], v[24:27], v[116:119]
    ds_read_b64_tr_b16 v[48:49], v17 offset:64
    ds_read_b64_tr_b16 v[50:51], v17 offset:3392
    s_waitcnt lgkmcnt(8)
    v_mfma_f32_16x16x32_bf16 v[72:75], v[52:55], v[20:23], v[72:75]
    v_mfma_f32_16x16x32_bf16 v[120:123], v[52:55], v[24:27], v[120:123]
    ds_read_b64_tr_b16 v[52:53], v17 offset:96
    ds_read_b64_tr_b16 v[54:55], v17 offset:3424
    s_waitcnt lgkmcnt(8)
    v_mfma_f32_16x16x32_bf16 v[76:79], v[56:59], v[20:23], v[76:79]
    v_mfma_f32_16x16x32_bf16 v[124:127], v[56:59], v[24:27], v[124:127]
    ds_read_b64_tr_b16 v[56:57], v17 offset:128
    ds_read_b64_tr_b16 v[58:59], v17 offset:3456
    s_waitcnt vmcnt(2)
    s_waitcnt lgkmcnt(8)
    v_mfma_f32_16x16x32_bf16 a[0:3], v[60:63], v[28:31], a[0:3]
    v_mfma_f32_16x16x32_bf16 a[48:51], v[60:63], v[32:35], a[48:51]
    ds_read_b64_tr_b16 v[60:61], v17 offset:160
    ds_read_b64_tr_b16 v[62:63], v17 offset:3488
    s_waitcnt lgkmcnt(8)
    v_mfma_f32_16x16x32_bf16 a[4:7], v[44:47], v[28:31], a[4:7]
    v_mfma_f32_16x16x32_bf16 a[52:55], v[44:47], v[32:35], a[52:55]
    ds_read_b64_tr_b16 v[44:45], v17 offset:192
    ds_read_b64_tr_b16 v[46:47], v17 offset:3520
    s_waitcnt lgkmcnt(8)
    v_mfma_f32_16x16x32_bf16 a[8:11], v[48:51], v[28:31], a[8:11]
    v_mfma_f32_16x16x32_bf16 a[56:59], v[48:51], v[32:35], a[56:59]
    ds_read_b64_tr_b16 v[48:49], v17 offset:224
    ds_read_b64_tr_b16 v[50:51], v17 offset:3552
    s_waitcnt lgkmcnt(8)
    v_mfma_f32_16x16x32_bf16 a[12:15], v[52:55], v[28:31], a[12:15]
    v_mfma_f32_16x16x32_bf16 a[60:63], v[52:55], v[32:35], a[60:63]
    ds_read_b64_tr_b16 v[52:53], v17 offset:256
    ds_read_b64_tr_b16 v[54:55], v17 offset:3584
    s_waitcnt lgkmcnt(8)
    v_mfma_f32_16x16x32_bf16 a[16:19], v[56:59], v[28:31], a[16:19]
    v_mfma_f32_16x16x32_bf16 a[64:67], v[56:59], v[32:35], a[64:67]
    ds_read_b64_tr_b16 v[56:57], v17 offset:288
    ds_read_b64_tr_b16 v[58:59], v17 offset:3616
    s_waitcnt lgkmcnt(8)
    v_mfma_f32_16x16x32_bf16 a[20:23], v[60:63], v[28:31], a[20:23]
    v_mfma_f32_16x16x32_bf16 a[68:71], v[60:63], v[32:35], a[68:71]
    ds_read_b64_tr_b16 v[60:61], v17 offset:320
    ds_read_b64_tr_b16 v[62:63], v17 offset:3648
    s_waitcnt lgkmcnt(8)
    v_mfma_f32_16x16x32_bf16 a[24:27], v[44:47], v[28:31], a[24:27]
    v_mfma_f32_16x16x32_bf16 a[72:75], v[44:47], v[32:35], a[72:75]
    ds_read_b64_tr_b16 v[44:45], v17 offset:352
    ds_read_b64_tr_b16 v[46:47], v17 offset:3680
    s_waitcnt lgkmcnt(8)
    v_mfma_f32_16x16x32_bf16 a[28:31], v[48:51], v[28:31], a[28:31]
    v_mfma_f32_16x16x32_bf16 a[76:79], v[48:51], v[32:35], a[76:79]
    ds_read_b64_tr_b16 v[48:49], v17 offset:13312
    ds_read_b64_tr_b16 v[50:51], v17 offset:16640
    s_waitcnt lgkmcnt(8)
    v_mfma_f32_16x16x32_bf16 a[32:35], v[52:55], v[28:31], a[32:35]
    v_mfma_f32_16x16x32_bf16 a[80:83], v[52:55], v[32:35], a[80:83]
    ds_read_b64_tr_b16 v[52:53], v17 offset:13344
    ds_read_b64_tr_b16 v[54:55], v17 offset:16672
    s_waitcnt lgkmcnt(8)
    v_mfma_f32_16x16x32_bf16 a[36:39], v[56:59], v[28:31], a[36:39]
    v_mfma_f32_16x16x32_bf16 a[84:87], v[56:59], v[32:35], a[84:87]
    ds_read_b64_tr_b16 v[56:57], v17 offset:13376
    ds_read_b64_tr_b16 v[58:59], v17 offset:16704
    s_waitcnt lgkmcnt(8)
    v_mfma_f32_16x16x32_bf16 a[40:43], v[60:63], v[28:31], a[40:43]
    v_mfma_f32_16x16x32_bf16 a[88:91], v[60:63], v[32:35], a[88:91]
    ds_read_b64_tr_b16 v[60:61], v17 offset:13408
    ds_read_b64_tr_b16 v[62:63], v17 offset:16736
    s_waitcnt lgkmcnt(8)
    v_mfma_f32_16x16x32_bf16 a[44:47], v[44:47], v[28:31], a[44:47]
    v_mfma_f32_16x16x32_bf16 a[92:95], v[44:47], v[32:35], a[92:95]
    ds_read_b64_tr_b16 v[44:45], v17 offset:13440
    ds_read_b64_tr_b16 v[46:47], v17 offset:16768
    s_waitcnt lgkmcnt(8)
    v_mfma_f32_16x16x32_bf16 a[96:99], v[48:51], v[28:31], a[96:99]
    v_mfma_f32_16x16x32_bf16 v[80:83], v[48:51], v[32:35], v[80:83]
    ds_read_b64_tr_b16 v[48:49], v17 offset:13472
    ds_read_b64_tr_b16 v[50:51], v17 offset:16800
    s_waitcnt lgkmcnt(8)
    v_mfma_f32_16x16x32_bf16 a[100:103], v[52:55], v[28:31], a[100:103]
    v_mfma_f32_16x16x32_bf16 v[84:87], v[52:55], v[32:35], v[84:87]
    ds_read_b64_tr_b16 v[52:53], v17 offset:13504
    ds_read_b64_tr_b16 v[54:55], v17 offset:16832
    s_waitcnt lgkmcnt(8)
    v_mfma_f32_16x16x32_bf16 a[104:107], v[56:59], v[28:31], a[104:107]
    v_mfma_f32_16x16x32_bf16 v[88:91], v[56:59], v[32:35], v[88:91]
    ds_read_b64_tr_b16 v[56:57], v17 offset:13536
    ds_read_b64_tr_b16 v[58:59], v17 offset:16864
    s_waitcnt lgkmcnt(8)
    v_mfma_f32_16x16x32_bf16 a[108:111], v[60:63], v[28:31], a[108:111]
    v_mfma_f32_16x16x32_bf16 v[92:95], v[60:63], v[32:35], v[92:95]
    ds_read_b64_tr_b16 v[60:61], v17 offset:13568
    ds_read_b64_tr_b16 v[62:63], v17 offset:16896
    s_waitcnt lgkmcnt(8)
    v_mfma_f32_16x16x32_bf16 a[112:115], v[44:47], v[28:31], a[112:115]
    v_mfma_f32_16x16x32_bf16 v[96:99], v[44:47], v[32:35], v[96:99]
    ds_read_b64_tr_b16 v[44:45], v17 offset:13600
    ds_read_b64_tr_b16 v[46:47], v17 offset:16928
    s_waitcnt lgkmcnt(8)
    v_mfma_f32_16x16x32_bf16 a[116:119], v[48:51], v[28:31], a[116:119]
    v_mfma_f32_16x16x32_bf16 v[100:103], v[48:51], v[32:35], v[100:103]
    ds_read_b64_tr_b16 v[48:49], v17 offset:13632
    ds_read_b64_tr_b16 v[50:51], v17 offset:16960
    s_waitcnt lgkmcnt(8)
    v_mfma_f32_16x16x32_bf16 a[120:123], v[52:55], v[28:31], a[120:123]
    v_mfma_f32_16x16x32_bf16 v[104:107], v[52:55], v[32:35], v[104:107]
    ds_read_b64_tr_b16 v[52:53], v17 offset:13664
    ds_read_b64_tr_b16 v[54:55], v17 offset:16992
    s_waitcnt lgkmcnt(8)
    v_mfma_f32_16x16x32_bf16 a[124:127], v[56:59], v[28:31], a[124:127]
    v_mfma_f32_16x16x32_bf16 v[108:111], v[56:59], v[32:35], v[108:111]
    s_barrier
    v_add_u32 v18, 133120, v16
    ds_read_b64_tr_b16 v[56:57], v18 offset:0
    ds_read_b64_tr_b16 v[58:59], v18 offset:3328
    s_waitcnt lgkmcnt(8)
    v_mfma_f32_16x16x32_bf16 v[64:67], v[60:63], v[28:31], v[64:67]
    v_mfma_f32_16x16x32_bf16 v[112:115], v[60:63], v[32:35], v[112:115]
    ds_read_b64_tr_b16 v[60:61], v18 offset:32
    ds_read_b64_tr_b16 v[62:63], v18 offset:3360
    s_waitcnt lgkmcnt(8)
    v_mfma_f32_16x16x32_bf16 v[68:71], v[44:47], v[28:31], v[68:71]
    v_mfma_f32_16x16x32_bf16 v[116:119], v[44:47], v[32:35], v[116:119]
    ds_read_b64_tr_b16 v[44:45], v18 offset:64
    ds_read_b64_tr_b16 v[46:47], v18 offset:3392
    s_waitcnt lgkmcnt(8)
    v_mfma_f32_16x16x32_bf16 v[72:75], v[48:51], v[28:31], v[72:75]
    v_mfma_f32_16x16x32_bf16 v[120:123], v[48:51], v[32:35], v[120:123]
    ds_read_b64_tr_b16 v[48:49], v18 offset:96
    ds_read_b64_tr_b16 v[50:51], v18 offset:3424
    s_waitcnt lgkmcnt(8)
    v_mfma_f32_16x16x32_bf16 v[76:79], v[52:55], v[28:31], v[76:79]
    v_mfma_f32_16x16x32_bf16 v[124:127], v[52:55], v[32:35], v[124:127]
    ds_read_b64_tr_b16 v[52:53], v18 offset:128
    ds_read_b64_tr_b16 v[54:55], v18 offset:3456
    s_waitcnt vmcnt(0)
    s_waitcnt lgkmcnt(8)
    v_mfma_f32_16x16x32_bf16 a[0:3], v[56:59], v[36:39], a[0:3]
    v_mfma_f32_16x16x32_bf16 a[48:51], v[56:59], v[40:43], a[48:51]
    ds_read_b64_tr_b16 v[56:57], v18 offset:160
    ds_read_b64_tr_b16 v[58:59], v18 offset:3488
    s_waitcnt lgkmcnt(8)
    v_mfma_f32_16x16x32_bf16 a[4:7], v[60:63], v[36:39], a[4:7]
    v_mfma_f32_16x16x32_bf16 a[52:55], v[60:63], v[40:43], a[52:55]
    ds_read_b64_tr_b16 v[60:61], v18 offset:192
    ds_read_b64_tr_b16 v[62:63], v18 offset:3520
    s_waitcnt lgkmcnt(8)
    v_mfma_f32_16x16x32_bf16 a[8:11], v[44:47], v[36:39], a[8:11]
    v_mfma_f32_16x16x32_bf16 a[56:59], v[44:47], v[40:43], a[56:59]
    ds_read_b64_tr_b16 v[44:45], v18 offset:224
    ds_read_b64_tr_b16 v[46:47], v18 offset:3552
    s_waitcnt lgkmcnt(8)
    v_mfma_f32_16x16x32_bf16 a[12:15], v[48:51], v[36:39], a[12:15]
    v_mfma_f32_16x16x32_bf16 a[60:63], v[48:51], v[40:43], a[60:63]
    ds_read_b64_tr_b16 v[48:49], v18 offset:256
    ds_read_b64_tr_b16 v[50:51], v18 offset:3584
    s_waitcnt lgkmcnt(8)
    v_mfma_f32_16x16x32_bf16 a[16:19], v[52:55], v[36:39], a[16:19]
    v_mfma_f32_16x16x32_bf16 a[64:67], v[52:55], v[40:43], a[64:67]
    ds_read_b64_tr_b16 v[52:53], v18 offset:288
    ds_read_b64_tr_b16 v[54:55], v18 offset:3616
    s_waitcnt lgkmcnt(8)
    v_mfma_f32_16x16x32_bf16 a[20:23], v[56:59], v[36:39], a[20:23]
    v_mfma_f32_16x16x32_bf16 a[68:71], v[56:59], v[40:43], a[68:71]
    ds_read_b64_tr_b16 v[56:57], v18 offset:320
    ds_read_b64_tr_b16 v[58:59], v18 offset:3648
    s_waitcnt lgkmcnt(8)
    v_mfma_f32_16x16x32_bf16 a[24:27], v[60:63], v[36:39], a[24:27]
    v_mfma_f32_16x16x32_bf16 a[72:75], v[60:63], v[40:43], a[72:75]
    ds_read_b64_tr_b16 v[60:61], v18 offset:352
    ds_read_b64_tr_b16 v[62:63], v18 offset:3680
    s_waitcnt lgkmcnt(8)
    v_mfma_f32_16x16x32_bf16 a[28:31], v[44:47], v[36:39], a[28:31]
    v_mfma_f32_16x16x32_bf16 a[76:79], v[44:47], v[40:43], a[76:79]
    ds_read_b64_tr_b16 v[44:45], v18 offset:13312
    ds_read_b64_tr_b16 v[46:47], v18 offset:16640
    s_waitcnt lgkmcnt(8)
    v_mfma_f32_16x16x32_bf16 a[32:35], v[48:51], v[36:39], a[32:35]
    v_mfma_f32_16x16x32_bf16 a[80:83], v[48:51], v[40:43], a[80:83]
    ds_read_b64_tr_b16 v[48:49], v18 offset:13344
    ds_read_b64_tr_b16 v[50:51], v18 offset:16672
    s_waitcnt lgkmcnt(8)
    v_mfma_f32_16x16x32_bf16 a[36:39], v[52:55], v[36:39], a[36:39]
    v_mfma_f32_16x16x32_bf16 a[84:87], v[52:55], v[40:43], a[84:87]
    ds_read_b64_tr_b16 v[52:53], v18 offset:13376
    ds_read_b64_tr_b16 v[54:55], v18 offset:16704
    s_waitcnt lgkmcnt(8)
    v_mfma_f32_16x16x32_bf16 a[40:43], v[56:59], v[36:39], a[40:43]
    v_mfma_f32_16x16x32_bf16 a[88:91], v[56:59], v[40:43], a[88:91]
    ds_read_b64_tr_b16 v[56:57], v18 offset:13408
    ds_read_b64_tr_b16 v[58:59], v18 offset:16736
    s_waitcnt lgkmcnt(8)
    v_mfma_f32_16x16x32_bf16 a[44:47], v[60:63], v[36:39], a[44:47]
    v_mfma_f32_16x16x32_bf16 a[92:95], v[60:63], v[40:43], a[92:95]
    ds_read_b64_tr_b16 v[60:61], v18 offset:13440
    ds_read_b64_tr_b16 v[62:63], v18 offset:16768
    s_waitcnt lgkmcnt(8)
    v_mfma_f32_16x16x32_bf16 a[96:99], v[44:47], v[36:39], a[96:99]
    v_mfma_f32_16x16x32_bf16 v[80:83], v[44:47], v[40:43], v[80:83]
    ds_read_b64_tr_b16 v[44:45], v18 offset:13472
    ds_read_b64_tr_b16 v[46:47], v18 offset:16800
    s_waitcnt lgkmcnt(8)
    v_mfma_f32_16x16x32_bf16 a[100:103], v[48:51], v[36:39], a[100:103]
    v_mfma_f32_16x16x32_bf16 v[84:87], v[48:51], v[40:43], v[84:87]
    ds_read_b64_tr_b16 v[48:49], v18 offset:13504
    ds_read_b64_tr_b16 v[50:51], v18 offset:16832
    s_waitcnt lgkmcnt(8)
    v_mfma_f32_16x16x32_bf16 a[104:107], v[52:55], v[36:39], a[104:107]
    v_mfma_f32_16x16x32_bf16 v[88:91], v[52:55], v[40:43], v[88:91]
    ds_read_b64_tr_b16 v[52:53], v18 offset:13536
    ds_read_b64_tr_b16 v[54:55], v18 offset:16864
    s_waitcnt lgkmcnt(8)
    v_mfma_f32_16x16x32_bf16 a[108:111], v[56:59], v[36:39], a[108:111]
    v_mfma_f32_16x16x32_bf16 v[92:95], v[56:59], v[40:43], v[92:95]
    ds_read_b64_tr_b16 v[56:57], v18 offset:13568
    ds_read_b64_tr_b16 v[58:59], v18 offset:16896
    s_waitcnt lgkmcnt(8)
    v_mfma_f32_16x16x32_bf16 a[112:115], v[60:63], v[36:39], a[112:115]
    v_mfma_f32_16x16x32_bf16 v[96:99], v[60:63], v[40:43], v[96:99]
    ds_read_b64_tr_b16 v[60:61], v18 offset:13600
    ds_read_b64_tr_b16 v[62:63], v18 offset:16928
    s_waitcnt lgkmcnt(8)
    v_mfma_f32_16x16x32_bf16 a[116:119], v[44:47], v[36:39], a[116:119]
    v_mfma_f32_16x16x32_bf16 v[100:103], v[44:47], v[40:43], v[100:103]
    ds_read_b64_tr_b16 v[44:45], v18 offset:13632
    ds_read_b64_tr_b16 v[46:47], v18 offset:16960
    s_waitcnt lgkmcnt(8)
    v_mfma_f32_16x16x32_bf16 a[120:123], v[48:51], v[36:39], a[120:123]
    v_mfma_f32_16x16x32_bf16 v[104:107], v[48:51], v[40:43], v[104:107]
    ds_read_b64_tr_b16 v[48:49], v18 offset:13664
    ds_read_b64_tr_b16 v[50:51], v18 offset:16992
    s_waitcnt lgkmcnt(8)
    v_mfma_f32_16x16x32_bf16 a[124:127], v[52:55], v[36:39], a[124:127]
    v_mfma_f32_16x16x32_bf16 v[108:111], v[52:55], v[40:43], v[108:111]
    s_waitcnt lgkmcnt(6)
    v_mfma_f32_16x16x32_bf16 v[64:67], v[56:59], v[36:39], v[64:67]
    v_mfma_f32_16x16x32_bf16 v[112:115], v[56:59], v[40:43], v[112:115]
    s_waitcnt lgkmcnt(4)
    v_mfma_f32_16x16x32_bf16 v[68:71], v[60:63], v[36:39], v[68:71]
    v_mfma_f32_16x16x32_bf16 v[116:119], v[60:63], v[40:43], v[116:119]
    s_waitcnt lgkmcnt(2)
    v_mfma_f32_16x16x32_bf16 v[72:75], v[44:47], v[36:39], v[72:75]
    v_mfma_f32_16x16x32_bf16 v[120:123], v[44:47], v[40:43], v[120:123]
    s_waitcnt lgkmcnt(0)
    v_mfma_f32_16x16x32_bf16 v[76:79], v[48:51], v[36:39], v[76:79]
    v_mfma_f32_16x16x32_bf16 v[124:127], v[48:51], v[40:43], v[124:127]
    s_nop 7
    s_nop 3
    s_mul_i32 s24, s21, 6
    s_mul_i32 s25, s28, 162
    s_add_u32 s24, s24, s25
    s_lshl_b32 s24, s24, 10
    s_add_u32 s25, s24, 0
    s_add_u32 s33, s25, 4096
    v_accvgpr_read_b32 v2, a0
    v_accvgpr_read_b32 v3, a1
    v_accvgpr_read_b32 v4, a2
    v_accvgpr_read_b32 v5, a3
    v_accvgpr_read_b32 v10, a96
    v_accvgpr_read_b32 v11, a97
    v_accvgpr_read_b32 v12, a98
    v_accvgpr_read_b32 v13, a99
    v_max_f32 v2, 0, v2
    v_max_f32 v3, 0, v3
    v_max_f32 v4, 0, v4
    v_max_f32 v5, 0, v5
    v_mul_f32 v2, v2, v10
    v_mul_f32 v3, v3, v11
    v_mul_f32 v4, v4, v12
    v_mul_f32 v5, v5, v13
    v_cvt_pk_bf16_f32 v20, v2, v3
    v_cvt_pk_bf16_f32 v21, v4, v5
    v_accvgpr_read_b32 v2, a4
    v_accvgpr_read_b32 v3, a5
    v_accvgpr_read_b32 v4, a6
    v_accvgpr_read_b32 v5, a7
    v_accvgpr_read_b32 v10, a100
    v_accvgpr_read_b32 v11, a101
    v_accvgpr_read_b32 v12, a102
    v_accvgpr_read_b32 v13, a103
    v_max_f32 v2, 0, v2
    v_max_f32 v3, 0, v3
    v_max_f32 v4, 0, v4
    v_max_f32 v5, 0, v5
    v_mul_f32 v2, v2, v10
    v_mul_f32 v3, v3, v11
    v_mul_f32 v4, v4, v12
    v_mul_f32 v5, v5, v13
    v_cvt_pk_bf16_f32 v22, v2, v3
    v_cvt_pk_bf16_f32 v23, v4, v5
    buffer_store_dwordx4 v[20:23], v19, s[16:19], s25 offen offset:0
    v_accvgpr_read_b32 v2, a8
    v_accvgpr_read_b32 v3, a9
    v_accvgpr_read_b32 v4, a10
    v_accvgpr_read_b32 v5, a11
    v_accvgpr_read_b32 v10, a104
    v_accvgpr_read_b32 v11, a105
    v_accvgpr_read_b32 v12, a106
    v_accvgpr_read_b32 v13, a107
    v_max_f32 v2, 0, v2
    v_max_f32 v3, 0, v3
    v_max_f32 v4, 0, v4
    v_max_f32 v5, 0, v5
    v_mul_f32 v2, v2, v10
    v_mul_f32 v3, v3, v11
    v_mul_f32 v4, v4, v12
    v_mul_f32 v5, v5, v13
    v_cvt_pk_bf16_f32 v24, v2, v3
    v_cvt_pk_bf16_f32 v25, v4, v5
    v_accvgpr_read_b32 v2, a12
    v_accvgpr_read_b32 v3, a13
    v_accvgpr_read_b32 v4, a14
    v_accvgpr_read_b32 v5, a15
    v_accvgpr_read_b32 v10, a108
    v_accvgpr_read_b32 v11, a109
    v_accvgpr_read_b32 v12, a110
    v_accvgpr_read_b32 v13, a111
    v_max_f32 v2, 0, v2
    v_max_f32 v3, 0, v3
    v_max_f32 v4, 0, v4
    v_max_f32 v5, 0, v5
    v_mul_f32 v2, v2, v10
    v_mul_f32 v3, v3, v11
    v_mul_f32 v4, v4, v12
    v_mul_f32 v5, v5, v13
    v_cvt_pk_bf16_f32 v26, v2, v3
    v_cvt_pk_bf16_f32 v27, v4, v5
    buffer_store_dwordx4 v[24:27], v19, s[16:19], s25 offen offset:1024
    v_accvgpr_read_b32 v2, a16
    v_accvgpr_read_b32 v3, a17
    v_accvgpr_read_b32 v4, a18
    v_accvgpr_read_b32 v5, a19
    v_accvgpr_read_b32 v10, a112
    v_accvgpr_read_b32 v11, a113
    v_accvgpr_read_b32 v12, a114
    v_accvgpr_read_b32 v13, a115
    v_max_f32 v2, 0, v2
    v_max_f32 v3, 0, v3
    v_max_f32 v4, 0, v4
    v_max_f32 v5, 0, v5
    v_mul_f32 v2, v2, v10
    v_mul_f32 v3, v3, v11
    v_mul_f32 v4, v4, v12
    v_mul_f32 v5, v5, v13
    v_cvt_pk_bf16_f32 v28, v2, v3
    v_cvt_pk_bf16_f32 v29, v4, v5
    v_accvgpr_read_b32 v2, a20
    v_accvgpr_read_b32 v3, a21
    v_accvgpr_read_b32 v4, a22
    v_accvgpr_read_b32 v5, a23
    v_accvgpr_read_b32 v10, a116
    v_accvgpr_read_b32 v11, a117
    v_accvgpr_read_b32 v12, a118
    v_accvgpr_read_b32 v13, a119
    v_max_f32 v2, 0, v2
    v_max_f32 v3, 0, v3
    v_max_f32 v4, 0, v4
    v_max_f32 v5, 0, v5
    v_mul_f32 v2, v2, v10
    v_mul_f32 v3, v3, v11
    v_mul_f32 v4, v4, v12
    v_mul_f32 v5, v5, v13
    v_cvt_pk_bf16_f32 v30, v2, v3
    v_cvt_pk_bf16_f32 v31, v4, v5
    buffer_store_dwordx4 v[28:31], v19, s[16:19], s25 offen offset:2048
    v_accvgpr_read_b32 v2, a24
    v_accvgpr_read_b32 v3, a25
    v_accvgpr_read_b32 v4, a26
    v_accvgpr_read_b32 v5, a27
    v_accvgpr_read_b32 v10, a120
    v_accvgpr_read_b32 v11, a121
    v_accvgpr_read_b32 v12, a122
    v_accvgpr_read_b32 v13, a123
    v_max_f32 v2, 0, v2
    v_max_f32 v3, 0, v3
    v_max_f32 v4, 0, v4
    v_max_f32 v5, 0, v5
    v_mul_f32 v2, v2, v10
    v_mul_f32 v3, v3, v11
    v_mul_f32 v4, v4, v12
    v_mul_f32 v5, v5, v13
    v_cvt_pk_bf16_f32 v32, v2, v3
    v_cvt_pk_bf16_f32 v33, v4, v5
    v_accvgpr_read_b32 v2, a28
    v_accvgpr_read_b32 v3, a29
    v_accvgpr_read_b32 v4, a30
    v_accvgpr_read_b32 v5, a31
    v_accvgpr_read_b32 v10, a124
    v_accvgpr_read_b32 v11, a125
    v_accvgpr_read_b32 v12, a126
    v_accvgpr_read_b32 v13, a127
    v_max_f32 v2, 0, v2
    v_max_f32 v3, 0, v3
    v_max_f32 v4, 0, v4
    v_max_f32 v5, 0, v5
    v_mul_f32 v2, v2, v10
    v_mul_f32 v3, v3, v11
    v_mul_f32 v4, v4, v12
    v_mul_f32 v5, v5, v13
    v_cvt_pk_bf16_f32 v34, v2, v3
    v_cvt_pk_bf16_f32 v35, v4, v5
    buffer_store_dwordx4 v[32:35], v19, s[16:19], s25 offen offset:3072
    v_accvgpr_read_b32 v2, a32
    v_accvgpr_read_b32 v3, a33
    v_accvgpr_read_b32 v4, a34
    v_accvgpr_read_b32 v5, a35
    v_max_f32 v2, 0, v2
    v_max_f32 v3, 0, v3
    v_max_f32 v4, 0, v4
    v_max_f32 v5, 0, v5
    v_mul_f32 v2, v2, v64
    v_mul_f32 v3, v3, v65
    v_mul_f32 v4, v4, v66
    v_mul_f32 v5, v5, v67
    v_cvt_pk_bf16_f32 v36, v2, v3
    v_cvt_pk_bf16_f32 v37, v4, v5
    v_accvgpr_read_b32 v2, a36
    v_accvgpr_read_b32 v3, a37
    v_accvgpr_read_b32 v4, a38
    v_accvgpr_read_b32 v5, a39
    v_max_f32 v2, 0, v2
    v_max_f32 v3, 0, v3
    v_max_f32 v4, 0, v4
    v_max_f32 v5, 0, v5
    v_mul_f32 v2, v2, v68
    v_mul_f32 v3, v3, v69
    v_mul_f32 v4, v4, v70
    v_mul_f32 v5, v5, v71
    v_cvt_pk_bf16_f32 v38, v2, v3
    v_cvt_pk_bf16_f32 v39, v4, v5
    buffer_store_dwordx4 v[36:39], v19, s[16:19], s33 offen offset:0
    v_accvgpr_read_b32 v2, a40
    v_accvgpr_read_b32 v3, a41
    v_accvgpr_read_b32 v4, a42
    v_accvgpr_read_b32 v5, a43
    v_max_f32 v2, 0, v2
    v_max_f32 v3, 0, v3
    v_max_f32 v4, 0, v4
    v_max_f32 v5, 0, v5
    v_mul_f32 v2, v2, v72
    v_mul_f32 v3, v3, v73
    v_mul_f32 v4, v4, v74
    v_mul_f32 v5, v5, v75
    v_cvt_pk_bf16_f32 v40, v2, v3
    v_cvt_pk_bf16_f32 v41, v4, v5
    v_accvgpr_read_b32 v2, a44
    v_accvgpr_read_b32 v3, a45
    v_accvgpr_read_b32 v4, a46
    v_accvgpr_read_b32 v5, a47
    v_max_f32 v2, 0, v2
    v_max_f32 v3, 0, v3
    v_max_f32 v4, 0, v4
    v_max_f32 v5, 0, v5
    v_mul_f32 v2, v2, v76
    v_mul_f32 v3, v3, v77
    v_mul_f32 v4, v4, v78
    v_mul_f32 v5, v5, v79
    v_cvt_pk_bf16_f32 v42, v2, v3
    v_cvt_pk_bf16_f32 v43, v4, v5
    buffer_store_dwordx4 v[40:43], v19, s[16:19], s33 offen offset:1024
    s_add_u32 s25, s24, 165888
    s_add_u32 s33, s25, 4096
    v_accvgpr_read_b32 v2, a48
    v_accvgpr_read_b32 v3, a49
    v_accvgpr_read_b32 v4, a50
    v_accvgpr_read_b32 v5, a51
    v_max_f32 v2, 0, v2
    v_max_f32 v3, 0, v3
    v_max_f32 v4, 0, v4
    v_max_f32 v5, 0, v5
    v_mul_f32 v2, v2, v80
    v_mul_f32 v3, v3, v81
    v_mul_f32 v4, v4, v82
    v_mul_f32 v5, v5, v83
    v_cvt_pk_bf16_f32 v44, v2, v3
    v_cvt_pk_bf16_f32 v45, v4, v5
    v_accvgpr_read_b32 v2, a52
    v_accvgpr_read_b32 v3, a53
    v_accvgpr_read_b32 v4, a54
    v_accvgpr_read_b32 v5, a55
    v_max_f32 v2, 0, v2
    v_max_f32 v3, 0, v3
    v_max_f32 v4, 0, v4
    v_max_f32 v5, 0, v5
    v_mul_f32 v2, v2, v84
    v_mul_f32 v3, v3, v85
    v_mul_f32 v4, v4, v86
    v_mul_f32 v5, v5, v87
    v_cvt_pk_bf16_f32 v46, v2, v3
    v_cvt_pk_bf16_f32 v47, v4, v5
    buffer_store_dwordx4 v[44:47], v19, s[16:19], s25 offen offset:0
    v_accvgpr_read_b32 v2, a56
    v_accvgpr_read_b32 v3, a57
    v_accvgpr_read_b32 v4, a58
    v_accvgpr_read_b32 v5, a59
    v_max_f32 v2, 0, v2
    v_max_f32 v3, 0, v3
    v_max_f32 v4, 0, v4
    v_max_f32 v5, 0, v5
    v_mul_f32 v2, v2, v88
    v_mul_f32 v3, v3, v89
    v_mul_f32 v4, v4, v90
    v_mul_f32 v5, v5, v91
    v_cvt_pk_bf16_f32 v48, v2, v3
    v_cvt_pk_bf16_f32 v49, v4, v5
    v_accvgpr_read_b32 v2, a60
    v_accvgpr_read_b32 v3, a61
    v_accvgpr_read_b32 v4, a62
    v_accvgpr_read_b32 v5, a63
    v_max_f32 v2, 0, v2
    v_max_f32 v3, 0, v3
    v_max_f32 v4, 0, v4
    v_max_f32 v5, 0, v5
    v_mul_f32 v2, v2, v92
    v_mul_f32 v3, v3, v93
    v_mul_f32 v4, v4, v94
    v_mul_f32 v5, v5, v95
    v_cvt_pk_bf16_f32 v50, v2, v3
    v_cvt_pk_bf16_f32 v51, v4, v5
    buffer_store_dwordx4 v[48:51], v19, s[16:19], s25 offen offset:1024
    v_accvgpr_read_b32 v2, a64
    v_accvgpr_read_b32 v3, a65
    v_accvgpr_read_b32 v4, a66
    v_accvgpr_read_b32 v5, a67
    v_max_f32 v2, 0, v2
    v_max_f32 v3, 0, v3
    v_max_f32 v4, 0, v4
    v_max_f32 v5, 0, v5
    v_mul_f32 v2, v2, v96
    v_mul_f32 v3, v3, v97
    v_mul_f32 v4, v4, v98
    v_mul_f32 v5, v5, v99
    v_cvt_pk_bf16_f32 v20, v2, v3
    v_cvt_pk_bf16_f32 v21, v4, v5
    v_accvgpr_read_b32 v2, a68
    v_accvgpr_read_b32 v3, a69
    v_accvgpr_read_b32 v4, a70
    v_accvgpr_read_b32 v5, a71
    v_max_f32 v2, 0, v2
    v_max_f32 v3, 0, v3
    v_max_f32 v4, 0, v4
    v_max_f32 v5, 0, v5
    v_mul_f32 v2, v2, v100
    v_mul_f32 v3, v3, v101
    v_mul_f32 v4, v4, v102
    v_mul_f32 v5, v5, v103
    v_cvt_pk_bf16_f32 v22, v2, v3
    v_cvt_pk_bf16_f32 v23, v4, v5
    buffer_store_dwordx4 v[20:23], v19, s[16:19], s25 offen offset:2048
    v_accvgpr_read_b32 v2, a72
    v_accvgpr_read_b32 v3, a73
    v_accvgpr_read_b32 v4, a74
    v_accvgpr_read_b32 v5, a75
    v_max_f32 v2, 0, v2
    v_max_f32 v3, 0, v3
    v_max_f32 v4, 0, v4
    v_max_f32 v5, 0, v5
    v_mul_f32 v2, v2, v104
    v_mul_f32 v3, v3, v105
    v_mul_f32 v4, v4, v106
    v_mul_f32 v5, v5, v107
    v_cvt_pk_bf16_f32 v24, v2, v3
    v_cvt_pk_bf16_f32 v25, v4, v5
    v_accvgpr_read_b32 v2, a76
    v_accvgpr_read_b32 v3, a77
    v_accvgpr_read_b32 v4, a78
    v_accvgpr_read_b32 v5, a79
    v_max_f32 v2, 0, v2
    v_max_f32 v3, 0, v3
    v_max_f32 v4, 0, v4
    v_max_f32 v5, 0, v5
    v_mul_f32 v2, v2, v108
    v_mul_f32 v3, v3, v109
    v_mul_f32 v4, v4, v110
    v_mul_f32 v5, v5, v111
    v_cvt_pk_bf16_f32 v26, v2, v3
    v_cvt_pk_bf16_f32 v27, v4, v5
    buffer_store_dwordx4 v[24:27], v19, s[16:19], s25 offen offset:3072
    v_accvgpr_read_b32 v2, a80
    v_accvgpr_read_b32 v3, a81
    v_accvgpr_read_b32 v4, a82
    v_accvgpr_read_b32 v5, a83
    v_max_f32 v2, 0, v2
    v_max_f32 v3, 0, v3
    v_max_f32 v4, 0, v4
    v_max_f32 v5, 0, v5
    v_mul_f32 v2, v2, v112
    v_mul_f32 v3, v3, v113
    v_mul_f32 v4, v4, v114
    v_mul_f32 v5, v5, v115
    v_cvt_pk_bf16_f32 v28, v2, v3
    v_cvt_pk_bf16_f32 v29, v4, v5
    v_accvgpr_read_b32 v2, a84
    v_accvgpr_read_b32 v3, a85
    v_accvgpr_read_b32 v4, a86
    v_accvgpr_read_b32 v5, a87
    v_max_f32 v2, 0, v2
    v_max_f32 v3, 0, v3
    v_max_f32 v4, 0, v4
    v_max_f32 v5, 0, v5
    v_mul_f32 v2, v2, v116
    v_mul_f32 v3, v3, v117
    v_mul_f32 v4, v4, v118
    v_mul_f32 v5, v5, v119
    v_cvt_pk_bf16_f32 v30, v2, v3
    v_cvt_pk_bf16_f32 v31, v4, v5
    buffer_store_dwordx4 v[28:31], v19, s[16:19], s33 offen offset:0
    v_accvgpr_read_b32 v2, a88
    v_accvgpr_read_b32 v3, a89
    v_accvgpr_read_b32 v4, a90
    v_accvgpr_read_b32 v5, a91
    v_max_f32 v2, 0, v2
    v_max_f32 v3, 0, v3
    v_max_f32 v4, 0, v4
    v_max_f32 v5, 0, v5
    v_mul_f32 v2, v2, v120
    v_mul_f32 v3, v3, v121
    v_mul_f32 v4, v4, v122
    v_mul_f32 v5, v5, v123
    v_cvt_pk_bf16_f32 v32, v2, v3
    v_cvt_pk_bf16_f32 v33, v4, v5
    v_accvgpr_read_b32 v2, a92
    v_accvgpr_read_b32 v3, a93
    v_accvgpr_read_b32 v4, a94
    v_accvgpr_read_b32 v5, a95
    v_max_f32 v2, 0, v2
    v_max_f32 v3, 0, v3
    v_max_f32 v4, 0, v4
    v_max_f32 v5, 0, v5
    v_mul_f32 v2, v2, v124
    v_mul_f32 v3, v3, v125
    v_mul_f32 v4, v4, v126
    v_mul_f32 v5, v5, v127
    v_cvt_pk_bf16_f32 v34, v2, v3
    v_cvt_pk_bf16_f32 v35, v4, v5
    buffer_store_dwordx4 v[32:35], v19, s[16:19], s33 offen offset:1024
    s_branch L_ka_end
L_ka_qkv:
    s_lshr_b32 s21, s38, 1
    s_and_b32 s22, s38, 1
    s_lshl_b32 s22, s22, 3
    s_add_u32 s22, s22, s39
    s_sub_u32 s22, s22, 24
    v_lshlrev_b32 v22, 4, v1
    s_lshl_b32 s28, s22, 3
    s_lshr_b32 s35, s20, 2
    s_and_b32 s53, s20, 3
    s_mul_i32 s25, s21, 288
    s_lshr_b32 s24, s20, 1
    s_mul_i32 s24, s24, 1152
    s_add_u32 s25, s25, s24
    s_and_b32 s24, s20, 1
    s_mul_i32 s24, s24, 288
    s_sub_u32 s23, s28, 1
    s_cmp_ge_u32 s20, 6
    s_cselect_b64 s[30:31], -1, 0
    s_add_u32 s29, s24, 0
    v_add_u32 v2, s29, v1
    s_mov_b32 s33, 911
    v_mul_u32_u24 v5, s33, v2
    v_lshrrev_b32 v5, 14, v5
    v_mul_u32_u24 v6, 18, v5
    v_sub_u32 v6, v2, v6
    v_min_u32 v5, 31, v5
    v_and_b32 v9, 0x13, v5
    v_and_b32 v7, 4, v5
    v_lshl_or_b32 v9, v7, 1, v9
    v_and_b32 v7, 8, v5
    v_lshrrev_b32 v7, 1, v7
    v_or_b32 v9, v9, v7
    v_mul_u32_u24 v9, 3456, v9
    v_lshl_add_u32 v9, v6, 4, v9
    v_add_u32 v9, s25, v9
    v_lshrrev_b32 v8, 6, v2
    v_add_u32 v8, s23, v8
    v_max_i32 v8, 0, v8
    v_mul_u32_u24 v8, 18432, v8
    v_and_b32 v7, 63, v2
    v_lshl_add_u32 v8, v7, 4, v8
    v_cndmask_b32 v10, v9, v8, s[30:31]
    s_add_u32 s29, s24, 64
    v_add_u32 v2, s29, v1
    s_mov_b32 s33, 911
    v_mul_u32_u24 v5, s33, v2
    v_lshrrev_b32 v5, 14, v5
    v_mul_u32_u24 v6, 18, v5
    v_sub_u32 v6, v2, v6
    v_min_u32 v5, 31, v5
    v_and_b32 v9, 0x13, v5
    v_and_b32 v7, 4, v5
    v_lshl_or_b32 v9, v7, 1, v9
    v_and_b32 v7, 8, v5
    v_lshrrev_b32 v7, 1, v7
    v_or_b32 v9, v9, v7
    v_mul_u32_u24 v9, 3456, v9
    v_lshl_add_u32 v9, v6, 4, v9
    v_add_u32 v9, s25, v9
    v_lshrrev_b32 v8, 6, v2
    v_add_u32 v8, s23, v8
    v_max_i32 v8, 0, v8
    v_mul_u32_u24 v8, 18432, v8
    v_and_b32 v7, 63, v2
    v_lshl_add_u32 v8, v7, 4, v8
    v_cndmask_b32 v11, v9, v8, s[30:31]
    s_add_u32 s29, s24, 128
    v_add_u32 v2, s29, v1
    s_mov_b32 s33, 911
    v_mul_u32_u24 v5, s33, v2
    v_lshrrev_b32 v5, 14, v5
    v_mul_u32_u24 v6, 18, v5
    v_sub_u32 v6, v2, v6
    v_min_u32 v5, 31, v5
    v_and_b32 v9, 0x13, v5
    v_and_b32 v7, 4, v5
    v_lshl_or_b32 v9, v7, 1, v9
    v_and_b32 v7, 8, v5
    v_lshrrev_b32 v7, 1, v7
    v_or_b32 v9, v9, v7
    v_mul_u32_u24 v9, 3456, v9
    v_lshl_add_u32 v9, v6, 4, v9
    v_add_u32 v9, s25, v9
    v_lshrrev_b32 v8, 6, v2
    v_add_u32 v8, s23, v8
    v_max_i32 v8, 0, v8
    v_mul_u32_u24 v8, 18432, v8
    v_and_b32 v7, 63, v2
    v_lshl_add_u32 v8, v7, 4, v8
    v_cndmask_b32 v12, v9, v8, s[30:31]
    s_add_u32 s29, s24, 192
    v_add_u32 v2, s29, v1
    s_mov_b32 s33, 911
    v_mul_u32_u24 v5, s33, v2
    v_lshrrev_b32 v5, 14, v5
    v_mul_u32_u24 v6, 18, v5
    v_sub_u32 v6, v2, v6
    v_min_u32 v5, 31, v5
    v_and_b32 v9, 0x13, v5
    v_and_b32 v7, 4, v5
    v_lshl_or_b32 v9, v7, 1, v9
    v_and_b32 v7, 8, v5
    v_lshrrev_b32 v7, 1, v7
    v_or_b32 v9, v9, v7
    v_mul_u32_u24 v9, 3456, v9
    v_lshl_add_u32 v9, v6, 4, v9
    v_add_u32 v9, s25, v9
    v_lshrrev_b32 v8, 6, v2
    v_add_u32 v8, s23, v8
    v_max_i32 v8, 0, v8
    v_mul_u32_u24 v8, 18432, v8
    v_and_b32 v7, 63, v2
    v_lshl_add_u32 v8, v7, 4, v8
    v_cndmask_b32 v13, v9, v8, s[30:31]
    s_add_u32 s29, s24, 256
    v_add_u32 v2, s29, v1
    s_mov_b32 s33, 911
    v_mul_u32_u24 v5, s33, v2
    v_lshrrev_b32 v5, 14, v5
    v_mul_u32_u24 v6, 18, v5
    v_sub_u32 v6, v2, v6
    v_min_u32 v5, 31, v5
    v_and_b32 v9, 0x13, v5
    v_and_b32 v7, 4, v5
    v_lshl_or_b32 v9, v7, 1, v9
    v_and_b32 v7, 8, v5
    v_lshrrev_b32 v7, 1, v7
    v_or_b32 v9, v9, v7
    v_mul_u32_u24 v9, 3456, v9
    v_lshl_add_u32 v9, v6, 4, v9
    v_add_u32 v9, s25, v9
    v_lshrrev_b32 v8, 6, v2
    v_add_u32 v8, s23, v8
    v_max_i32 v8, 0, v8
    v_mul_u32_u24 v8, 18432, v8
    v_and_b32 v7, 63, v2
    v_lshl_add_u32 v8, v7, 4, v8
    v_cndmask_b32 v14, v9, v8, s[30:31]
    v_lshrrev_b32 v2, 5, v1
    v_lshlrev_b32 v2, 4, v2
    v_bfe_u32 v3, v1, 4, 1
    v_lshl_add_u32 v2, v3, 2, v2
    v_bfe_u32 v3, v1, 2, 2
    v_add_u32 v2, v2, v3
    v_mul_u32_u24 v2, 288, v2
    v_and_b32 v3, 3, v1
    v_lshl_add_u32 v2, v3, 3, v2
    v_and_b32 v4, 15, v1
    v_mul_u32_u24 v4, 968, v4
    s_mul_i32 s23, s35, 61952
    v_add_u32 v4, s23, v4
    v_lshrrev_b32 v5, 4, v1
    v_lshlrev_b32 v5, 2, v5
    s_mul_i32 s23, s53, 7
    s_add_u32 s23, s23, 0
    s_min_u32 s23, s23, 26
    s_mul_i32 s24, s23, 57
    s_lshr_b32 s24, s24, 9
    s_mul_i32 s25, s24, 9
    s_sub_u32 s25, s23, s25
    s_mul_i32 s29, s24, 9216
    s_lshl_b32 s30, s25, 5
    s_add_u32 s29, s29, s30
    v_add_u32 v15, s29, v2
    s_mul_i32 s23, s53, 7
    s_add_u32 s23, s23, 1
    s_min_u32 s23, s23, 26
    s_mul_i32 s24, s23, 57
    s_lshr_b32 s24, s24, 9
    s_mul_i32 s25, s24, 9
    s_sub_u32 s25, s23, s25
    s_mul_i32 s29, s24, 9216
    s_lshl_b32 s30, s25, 5
    s_add_u32 s29, s29, s30
    v_add_u32 v16, s29, v2
    s_mul_i32 s23, s53, 7
    s_add_u32 s23, s23, 2
    s_min_u32 s23, s23, 26
    s_mul_i32 s24, s23, 57
    s_lshr_b32 s24, s24, 9
    s_mul_i32 s25, s24, 9
    s_sub_u32 s25, s23, s25
    s_mul_i32 s29, s24, 9216
    s_lshl_b32 s30, s25, 5
    s_add_u32 s29, s29, s30
    v_add_u32 v17, s29, v2
    s_mul_i32 s23, s53, 7
    s_add_u32 s23, s23, 3
    s_min_u32 s23, s23, 26
    s_mul_i32 s24, s23, 57
    s_lshr_b32 s24, s24, 9
    s_mul_i32 s25, s24, 9
    s_sub_u32 s25, s23, s25
    s_mul_i32 s29, s24, 9216
    s_lshl_b32 s30, s25, 5
    s_add_u32 s29, s29, s30
    v_add_u32 v18, s29, v2
    s_mul_i32 s23, s53, 7
    s_add_u32 s23, s23, 4
    s_min_u32 s23, s23, 26
    s_mul_i32 s24, s23, 57
    s_lshr_b32 s24, s24, 9
    s_mul_i32 s25, s24, 9
    s_sub_u32 s25, s23, s25
    s_mul_i32 s29, s24, 9216
    s_lshl_b32 s30, s25, 5
    s_add_u32 s29, s29, s30
    v_add_u32 v19, s29, v2
    s_mul_i32 s23, s53, 7
    s_add_u32 s23, s23, 5
    s_min_u32 s23, s23, 26
    s_mul_i32 s24, s23, 57
    s_lshr_b32 s24, s24, 9
    s_mul_i32 s25, s24, 9
    s_sub_u32 s25, s23, s25
    s_mul_i32 s29, s24, 9216
    s_lshl_b32 s30, s25, 5
    s_add_u32 s29, s29, s30
    v_add_u32 v20, s29, v2
    s_mul_i32 s23, s53, 7
    s_add_u32 s23, s23, 6
    s_min_u32 s23, s23, 26
    s_mul_i32 s24, s23, 57
    s_lshr_b32 s24, s24, 9
    s_mul_i32 s25, s24, 9
    s_sub_u32 s25, s23, s25
    s_mul_i32 s29, s24, 9216
    s_lshl_b32 s30, s25, 5
    s_add_u32 s29, s29, s30
    v_add_u32 v21, s29, v2
    s_mul_i32 s29, s20, 4608
    s_lshl_b32 s54, s35, 12
    s_waitcnt lgkmcnt(0)
    s_mov_b32 s8, s26
    s_and_b32 s9, s27, 0xffff
    s_mov_b32 s10, 2359296
    s_mov_b32 s11, 0x00020000
    s_add_u32 s16, s26, 4194304
    s_addc_u32 s17, s27, 0
    s_and_b32 s17, s17, 0xffff
    s_mov_b32 s18, 21233664
    s_mov_b32 s19, 0x00020000
    s_and_b32 s37, s37, 0xffff
    s_mov_b32 s33, 1990656
    s_mov_b32 s34, 110592
    s_cmp_ge_u32 s20, 6
    s_cselect_b32 s12, s8, s36
    s_cselect_b32 s13, s9, s37
    s_cselect_b32 s14, s10, s33
    s_mov_b32 s15, 0x00020000
    s_cselect_b32 s34, 1024, s34
    s_mov_b32 s31, 0
    v_add_u32 v45, s54, v22
    s_add_u32 m0, s29, 0
    s_nop 0
    buffer_load_dwordx4 v10, s[12:15], s31 offen lds
    s_add_u32 m0, s29, 1024
    s_nop 0
    buffer_load_dwordx4 v11, s[12:15], s31 offen lds
    s_add_u32 m0, s29, 2048
    s_nop 0
    buffer_load_dwordx4 v12, s[12:15], s31 offen lds
    s_add_u32 m0, s29, 3072
    s_nop 0
    buffer_load_dwordx4 v13, s[12:15], s31 offen lds
    s_add_u32 m0, s29, 4096
    s_mov_b32 exec_hi, 0
    buffer_load_dwordx4 v14, s[12:15], s31 offen lds
    s_mov_b32 exec_hi, -1
    s_add_u32 s31, s31, s34
    s_add_u32 m0, s29, 36864
    s_nop 0
    buffer_load_dwordx4 v10, s[12:15], s31 offen lds
    s_add_u32 m0, s29, 37888
    s_nop 0
    buffer_load_dwordx4 v11, s[12:15], s31 offen lds
    s_add_u32 m0, s29, 38912
    s_nop 0
    buffer_load_dwordx4 v12, s[12:15], s31 offen lds
    s_add_u32 m0, s29, 39936
    s_nop 0
    buffer_load_dwordx4 v13, s[12:15], s31 offen lds
    s_add_u32 m0, s29, 40960
    s_mov_b32 exec_hi, 0
    buffer_load_dwordx4 v14, s[12:15], s31 offen lds
    s_mov_b32 exec_hi, -1
    s_add_u32 s31, s31, s34
    s_mov_b32 s52, 43
    v_mul_u32_u24 v6, s52, v1
    v_lshrrev_b32 v6, 8, v6
    v_mul_u32_u24 v7, 6, v6
    v_sub_u32 v7, v1, v7
    v_min_u32 v6, 8, v6
    v_mul_u32_u24 v6, 3456, v6
    v_lshl_add_u32 v6, v7, 6, v6
    s_sub_u32 s23, s39, 24
    s_lshl_b32 s23, s23, 3
    s_add_u32 s23, s23, s20
    s_mul_i32 s23, s23, 9*3456
    s_mul_i32 s24, s21, 288
    s_add_u32 s23, s23, s24
    s_mov_b32 s44, s36
    s_and_b32 s45, s37, 0xffff
    s_mov_b32 s46, 1990656
    s_mov_b32 s47, 0x00020000
    buffer_load_dword v127, v6, s[44:47], s23 offen offset:0
    buffer_load_dword v127, v6, s[44:47], s23 offen offset:1152
    buffer_load_dword v127, v6, s[44:47], s23 offen offset:2304
    s_mul_i32 s23, s53, 7
    s_add_u32 s23, s23, 0
    s_min_u32 s23, s23, 26
    s_mul_i32 s24, s23, 57
    s_lshr_b32 s24, s24, 9
    s_mul_i32 s25, s24, 9
    s_sub_u32 s25, s23, s25
    s_lshl_b32 s30, s25, 4
    s_mul_i32 s55, s24, 320
    v_add_u32 v6, s30, v5
    s_mov_b32 s52, 57
    v_mul_u32_u24 v7, s52, v6
    v_lshrrev_b32 v7, 10, v7
    v_mul_u32_u24 v8, 18, v7
    v_sub_u32 v8, v6, v8
    v_mul_u32_u24 v7, 40, v7
    v_lshl_add_u32 v7, v8, 1, v7
    v_add_u32 v7, v7, v4
    v_add_u32 v31, s55, v7
    v_add_u32 v6, s30, v5
    v_add_u32 v6, 2, v6
    s_mov_b32 s52, 57
    v_mul_u32_u24 v7, s52, v6
    v_lshrrev_b32 v7, 10, v7
    v_mul_u32_u24 v8, 18, v7
    v_sub_u32 v8, v6, v8
    v_mul_u32_u24 v7, 40, v7
    v_lshl_add_u32 v7, v8, 1, v7
    v_add_u32 v7, v7, v4
    v_add_u32 v32, s55, v7
    s_mul_i32 s23, s53, 7
    s_add_u32 s23, s23, 1
    s_min_u32 s23, s23, 26
    s_mul_i32 s24, s23, 57
    s_lshr_b32 s24, s24, 9
    s_mul_i32 s25, s24, 9
    s_sub_u32 s25, s23, s25
    s_lshl_b32 s30, s25, 4
    s_mul_i32 s55, s24, 320
    v_add_u32 v6, s30, v5
    s_mov_b32 s52, 57
    v_mul_u32_u24 v7, s52, v6
    v_lshrrev_b32 v7, 10, v7
    v_mul_u32_u24 v8, 18, v7
    v_sub_u32 v8, v6, v8
    v_mul_u32_u24 v7, 40, v7
    v_lshl_add_u32 v7, v8, 1, v7
    v_add_u32 v7, v7, v4
    v_add_u32 v33, s55, v7
    v_add_u32 v6, s30, v5
    v_add_u32 v6, 2, v6
    s_mov_b32 s52, 57
    v_mul_u32_u24 v7, s52, v6
    v_lshrrev_b32 v7, 10, v7
    v_mul_u32_u24 v8, 18, v7
    v_sub_u32 v8, v6, v8
    v_mul_u32_u24 v7, 40, v7
    v_lshl_add_u32 v7, v8, 1, v7
    v_add_u32 v7, v7, v4
    v_add_u32 v34, s55, v7
    s_mul_i32 s23, s53, 7
    s_add_u32 s23, s23, 2
    s_min_u32 s23, s23, 26
    s_mul_i32 s24, s23, 57
    s_lshr_b32 s24, s24, 9
    s_mul_i32 s25, s24, 9
    s_sub_u32 s25, s23, s25
    s_lshl_b32 s30, s25, 4
    s_mul_i32 s55, s24, 320
    v_add_u32 v6, s30, v5
    s_mov_b32 s52, 57
    v_mul_u32_u24 v7, s52, v6
    v_lshrrev_b32 v7, 10, v7
    v_mul_u32_u24 v8, 18, v7
    v_sub_u32 v8, v6, v8
    v_mul_u32_u24 v7, 40, v7
    v_lshl_add_u32 v7, v8, 1, v7
    v_add_u32 v7, v7, v4
    v_add_u32 v35, s55, v7
    v_add_u32 v6, s30, v5
    v_add_u32 v6, 2, v6
    s_mov_b32 s52, 57
    v_mul_u32_u24 v7, s52, v6
    v_lshrrev_b32 v7, 10, v7
    v_mul_u32_u24 v8, 18, v7
    v_sub_u32 v8, v6, v8
    v_mul_u32_u24 v7, 40, v7
    v_lshl_add_u32 v7, v8, 1, v7
    v_add_u32 v7, v7, v4
    v_add_u32 v36, s55, v7
    s_mul_i32 s23, s53, 7
    s_add_u32 s23, s23, 3
    s_min_u32 s23, s23, 26
    s_mul_i32 s24, s23, 57
    s_lshr_b32 s24, s24, 9
    s_mul_i32 s25, s24, 9
    s_sub_u32 s25, s23, s25
    s_lshl_b32 s30, s25, 4
    s_mul_i32 s55, s24, 320
    v_add_u32 v6, s30, v5
    s_mov_b32 s52, 57
    v_mul_u32_u24 v7, s52, v6
    v_lshrrev_b32 v7, 10, v7
    v_mul_u32_u24 v8, 18, v7
    v_sub_u32 v8, v6, v8
    v_mul_u32_u24 v7, 40, v7
    v_lshl_add_u32 v7, v8, 1, v7
    v_add_u32 v7, v7, v4
    v_add_u32 v37, s55, v7
    v_add_u32 v6, s30, v5
    v_add_u32 v6, 2, v6
    s_mov_b32 s52, 57
    v_mul_u32_u24 v7, s52, v6
    v_lshrrev_b32 v7, 10, v7
    v_mul_u32_u24 v8, 18, v7
    v_sub_u32 v8, v6, v8
    v_mul_u32_u24 v7, 40, v7
    v_lshl_add_u32 v7, v8, 1, v7
    v_add_u32 v7, v7, v4
    v_add_u32 v38, s55, v7
    s_mul_i32 s23, s53, 7
    s_add_u32 s23, s23, 4
    s_min_u32 s23, s23, 26
    s_mul_i32 s24, s23, 57
    s_lshr_b32 s24, s24, 9
    s_mul_i32 s25, s24, 9
    s_sub_u32 s25, s23, s25
    s_lshl_b32 s30, s25, 4
    s_mul_i32 s55, s24, 320
    v_add_u32 v6, s30, v5
    s_mov_b32 s52, 57
    v_mul_u32_u24 v7, s52, v6
    v_lshrrev_b32 v7, 10, v7
    v_mul_u32_u24 v8, 18, v7
    v_sub_u32 v8, v6, v8
    v_mul_u32_u24 v7, 40, v7
    v_lshl_add_u32 v7, v8, 1, v7
    v_add_u32 v7, v7, v4
    v_add_u32 v39, s55, v7
    v_add_u32 v6, s30, v5
    v_add_u32 v6, 2, v6
    s_mov_b32 s52, 57
    v_mul_u32_u24 v7, s52, v6
    v_lshrrev_b32 v7, 10, v7
    v_mul_u32_u24 v8, 18, v7
    v_sub_u32 v8, v6, v8
    v_mul_u32_u24 v7, 40, v7
    v_lshl_add_u32 v7, v8, 1, v7
    v_add_u32 v7, v7, v4
    v_add_u32 v40, s55, v7
    s_mul_i32 s23, s53, 7
    s_add_u32 s23, s23, 5
    s_min_u32 s23, s23, 26
    s_mul_i32 s24, s23, 57
    s_lshr_b32 s24, s24, 9
    s_mul_i32 s25, s24, 9
    s_sub_u32 s25, s23, s25
    s_lshl_b32 s30, s25, 4
    s_mul_i32 s55, s24, 320
    v_add_u32 v6, s30, v5
    s_mov_b32 s52, 57
    v_mul_u32_u24 v7, s52, v6
    v_lshrrev_b32 v7, 10, v7
    v_mul_u32_u24 v8, 18, v7
    v_sub_u32 v8, v6, v8
    v_mul_u32_u24 v7, 40, v7
    v_lshl_add_u32 v7, v8, 1, v7
    v_add_u32 v7, v7, v4
    v_add_u32 v41, s55, v7
    v_add_u32 v6, s30, v5
    v_add_u32 v6, 2, v6
    s_mov_b32 s52, 57
    v_mul_u32_u24 v7, s52, v6
    v_lshrrev_b32 v7, 10, v7
    v_mul_u32_u24 v8, 18, v7
    v_sub_u32 v8, v6, v8
    v_mul_u32_u24 v7, 40, v7
    v_lshl_add_u32 v7, v8, 1, v7
    v_add_u32 v7, v7, v4
    v_add_u32 v42, s55, v7
    s_mul_i32 s23, s53, 7
    s_add_u32 s23, s23, 6
    s_min_u32 s23, s23, 26
    s_mul_i32 s24, s23, 57
    s_lshr_b32 s24, s24, 9
    s_mul_i32 s25, s24, 9
    s_sub_u32 s25, s23, s25
    s_lshl_b32 s30, s25, 4
    s_mul_i32 s55, s24, 320
    v_add_u32 v6, s30, v5
    s_mov_b32 s52, 57
    v_mul_u32_u24 v7, s52, v6
    v_lshrrev_b32 v7, 10, v7
    v_mul_u32_u24 v8, 18, v7
    v_sub_u32 v8, v6, v8
    v_mul_u32_u24 v7, 40, v7
    v_lshl_add_u32 v7, v8, 1, v7
    v_add_u32 v7, v7, v4
    v_add_u32 v43, s55, v7
    v_add_u32 v6, s30, v5
    v_add_u32 v6, 2, v6
    s_mov_b32 s52, 57
    v_mul_u32_u24 v7, s52, v6
    v_lshrrev_b32 v7, 10, v7
    v_mul_u32_u24 v8, 18, v7
    v_sub_u32 v8, v6, v8
    v_mul_u32_u24 v7, 40, v7
    v_lshl_add_u32 v7, v8, 1, v7
    v_add_u32 v7, v7, v4
    v_add_u32 v44, s55, v7
    s_waitcnt vmcnt(8)
    s_barrier
    v_add_u32 v30, 27648, v45
    v_add_u32 v23, 0, v15
    v_add_u32 v24, 0, v16
    v_add_u32 v25, 0, v17
    v_add_u32 v26, 0, v18
    v_add_u32 v27, 0, v19
    v_add_u32 v28, 0, v20
    v_add_u32 v29, 0, v21
    ds_read_b128 v[46:49], v30 offset:0
    ds_read_b128 v[50:53], v30 offset:1024
    ds_read_b128 v[54:57], v30 offset:2048
    ds_read_b128 v[58:61], v30 offset:3072
    ds_read_b128 v[62:65], v30 offset:4096
    ds_read_b64_tr_b16 v[86:87], v23
    ds_read_b64_tr_b16 v[88:89], v23 offset:2304
    ds_read_b64_tr_b16 v[90:91], v24
    ds_read_b64_tr_b16 v[92:93], v24 offset:2304
    ds_read_b64_tr_b16 v[94:95], v25
    ds_read_b64_tr_b16 v[96:97], v25 offset:2304
    ds_read_b64_tr_b16 v[98:99], v26
    ds_read_b64_tr_b16 v[100:101], v26 offset:2304
    s_waitcnt lgkmcnt(8)
    s_waitcnt lgkmcnt(6)
    v_mfma_f32_16x16x32_bf16 a[0:3], v[86:89], v[46:49], 0
    v_mfma_f32_16x16x32_bf16 a[28:31], v[86:89], v[50:53], 0
    s_add_u32 m0, s29, 73728
    s_nop 0
    buffer_load_dwordx4 v10, s[12:15], s31 offen lds
    v_mfma_f32_16x16x32_bf16 a[56:59], v[86:89], v[54:57], 0
    v_mfma_f32_16x16x32_bf16 a[84:87], v[86:89], v[58:61], 0
    s_add_u32 m0, s29, 74752
    s_nop 0
    buffer_load_dwordx4 v11, s[12:15], s31 offen lds
    v_mfma_f32_16x16x32_bf16 a[112:115], v[86:89], v[62:65], 0
    ds_read_b64_tr_b16 v[86:87], v27
    ds_read_b64_tr_b16 v[88:89], v27 offset:2304
    s_waitcnt lgkmcnt(6)
    v_mfma_f32_16x16x32_bf16 a[4:7], v[90:93], v[46:49], 0
    v_mfma_f32_16x16x32_bf16 a[32:35], v[90:93], v[50:53], 0
    s_add_u32 m0, s29, 75776
    s_nop 0
    buffer_load_dwordx4 v12, s[12:15], s31 offen lds
    v_mfma_f32_16x16x32_bf16 a[60:63], v[90:93], v[54:57], 0
    v_mfma_f32_16x16x32_bf16 a[88:91], v[90:93], v[58:61], 0
    s_add_u32 m0, s29, 76800
    s_nop 0
    buffer_load_dwordx4 v13, s[12:15], s31 offen lds
    v_mfma_f32_16x16x32_bf16 a[116:119], v[90:93], v[62:65], 0
    ds_read_b64_tr_b16 v[90:91], v28
    ds_read_b64_tr_b16 v[92:93], v28 offset:2304
    s_waitcnt lgkmcnt(6)
    v_mfma_f32_16x16x32_bf16 a[8:11], v[94:97], v[46:49], 0
    v_mfma_f32_16x16x32_bf16 a[36:39], v[94:97], v[50:53], 0
    s_add_u32 m0, s29, 77824
    s_mov_b32 exec_hi, 0
    buffer_load_dwordx4 v14, s[12:15], s31 offen lds
    s_mov_b32 exec_hi, -1
    s_add_u32 s31, s31, s34
    v_mfma_f32_16x16x32_bf16 a[64:67], v[94:97], v[54:57], 0
    v_mfma_f32_16x16x32_bf16 a[92:95], v[94:97], v[58:61], 0
    s_add_u32 m0, s29, 110592
    s_nop 0
    buffer_load_dwordx4 v10, s[12:15], s31 offen lds
    v_mfma_f32_16x16x32_bf16 a[120:123], v[94:97], v[62:65], 0
    ds_read_b64_tr_b16 v[94:95], v29
    ds_read_b64_tr_b16 v[96:97], v29 offset:2304
    s_waitcnt lgkmcnt(6)
    v_mfma_f32_16x16x32_bf16 a[12:15], v[98:101], v[46:49], 0
    v_mfma_f32_16x16x32_bf16 a[40:43], v[98:101], v[50:53], 0
    s_add_u32 m0, s29, 111616
    s_nop 0
    buffer_load_dwordx4 v11, s[12:15], s31 offen lds
    v_mfma_f32_16x16x32_bf16 a[68:71], v[98:101], v[54:57], 0
    v_mfma_f32_16x16x32_bf16 a[96:99], v[98:101], v[58:61], 0
    s_add_u32 m0, s29, 112640
    s_nop 0
    buffer_load_dwordx4 v12, s[12:15], s31 offen lds
    v_mfma_f32_16x16x32_bf16 a[124:127], v[98:101], v[62:65], 0
    s_waitcnt lgkmcnt(0)
    s_waitcnt vmcnt(11)
    s_barrier
    v_add_u32 v30, 64512, v45
    v_add_u32 v23, 36864, v15
    v_add_u32 v24, 36864, v16
    v_add_u32 v25, 36864, v17
    v_add_u32 v26, 36864, v18
    v_add_u32 v27, 36864, v19
    v_add_u32 v28, 36864, v20
    v_add_u32 v29, 36864, v21
    ds_read_b64_tr_b16 v[98:99], v23
    ds_read_b64_tr_b16 v[100:101], v23 offset:2304
    v_mfma_f32_16x16x32_bf16 a[16:19], v[86:89], v[46:49], 0
    v_mfma_f32_16x16x32_bf16 a[44:47], v[86:89], v[50:53], 0
    s_add_u32 m0, s29, 113664
    s_nop 0
    buffer_load_dwordx4 v13, s[12:15], s31 offen lds
    v_mfma_f32_16x16x32_bf16 a[72:75], v[86:89], v[54:57], 0
    v_mfma_f32_16x16x32_bf16 a[100:103], v[86:89], v[58:61], 0
    s_add_u32 m0, s29, 114688
    s_mov_b32 exec_hi, 0
    buffer_load_dwordx4 v14, s[12:15], s31 offen lds
    s_mov_b32 exec_hi, -1
    s_add_u32 s31, s31, s34
    v_mfma_f32_16x16x32_bf16 v[104:107], v[86:89], v[62:65], 0
    ds_read_b64_tr_b16 v[86:87], v24
    ds_read_b64_tr_b16 v[88:89], v24 offset:2304
    v_mfma_f32_16x16x32_bf16 a[20:23], v[90:93], v[46:49], 0
    v_mfma_f32_16x16x32_bf16 a[48:51], v[90:93], v[50:53], 0
    ds_read_b128 v[66:69], v30 offset:0
    v_mfma_f32_16x16x32_bf16 a[76:79], v[90:93], v[54:57], 0
    v_mfma_f32_16x16x32_bf16 a[104:107], v[90:93], v[58:61], 0
    ds_read_b128 v[70:73], v30 offset:1024
    v_mfma_f32_16x16x32_bf16 v[108:111], v[90:93], v[62:65], 0
    ds_read_b64_tr_b16 v[90:91], v25
    ds_read_b64_tr_b16 v[92:93], v25 offset:2304
    v_mfma_f32_16x16x32_bf16 a[24:27], v[94:97], v[46:49], 0
    v_mfma_f32_16x16x32_bf16 a[52:55], v[94:97], v[50:53], 0
    ds_read_b128 v[74:77], v30 offset:2048
    v_mfma_f32_16x16x32_bf16 a[80:83], v[94:97], v[54:57], 0
    v_mfma_f32_16x16x32_bf16 a[108:111], v[94:97], v[58:61], 0
    ds_read_b128 v[78:81], v30 offset:3072
    v_mfma_f32_16x16x32_bf16 v[112:115], v[94:97], v[62:65], 0
    ds_read_b128 v[82:85], v30 offset:4096
    s_add_u32 m0, s29, 0
    s_nop 0
    buffer_load_dwordx4 v10, s[12:15], s31 offen lds
    s_add_u32 m0, s29, 1024
    s_nop 0
    buffer_load_dwordx4 v11, s[12:15], s31 offen lds
    s_add_u32 m0, s29, 2048
    s_nop 0
    buffer_load_dwordx4 v12, s[12:15], s31 offen lds
    s_add_u32 m0, s29, 3072
    s_nop 0
    buffer_load_dwordx4 v13, s[12:15], s31 offen lds
    s_add_u32 m0, s29, 4096
    s_mov_b32 exec_hi, 0
    buffer_load_dwordx4 v14, s[12:15], s31 offen lds
    s_mov_b32 exec_hi, -1
    s_add_u32 s31, s31, s34
    ds_read_b64_tr_b16 v[94:95], v26
    ds_read_b64_tr_b16 v[96:97], v26 offset:2304
    s_waitcnt lgkmcnt(2)
    v_mfma_f32_16x16x32_bf16 a[0:3], v[98:101], v[66:69], a[0:3]
    v_mfma_f32_16x16x32_bf16 a[28:31], v[98:101], v[70:73], a[28:31]
    v_mfma_f32_16x16x32_bf16 a[56:59], v[98:101], v[74:77], a[56:59]
    v_mfma_f32_16x16x32_bf16 a[84:87], v[98:101], v[78:81], a[84:87]
    v_mfma_f32_16x16x32_bf16 a[112:115], v[98:101], v[82:85], a[112:115]
    ds_read_b64_tr_b16 v[98:99], v27
    ds_read_b64_tr_b16 v[100:101], v27 offset:2304
    v_mfma_f32_16x16x32_bf16 a[4:7], v[86:89], v[66:69], a[4:7]
    v_mfma_f32_16x16x32_bf16 a[32:35], v[86:89], v[70:73], a[32:35]
    v_mfma_f32_16x16x32_bf16 a[60:63], v[86:89], v[74:77], a[60:63]
    v_mfma_f32_16x16x32_bf16 a[88:91], v[86:89], v[78:81], a[88:91]
    v_mfma_f32_16x16x32_bf16 a[116:119], v[86:89], v[82:85], a[116:119]
    ds_read_b64_tr_b16 v[86:87], v28
    ds_read_b64_tr_b16 v[88:89], v28 offset:2304
    v_mfma_f32_16x16x32_bf16 a[8:11], v[90:93], v[66:69], a[8:11]
    v_mfma_f32_16x16x32_bf16 a[36:39], v[90:93], v[70:73], a[36:39]
    v_mfma_f32_16x16x32_bf16 a[64:67], v[90:93], v[74:77], a[64:67]
    v_mfma_f32_16x16x32_bf16 a[92:95], v[90:93], v[78:81], a[92:95]
    v_mfma_f32_16x16x32_bf16 a[120:123], v[90:93], v[82:85], a[120:123]
    ds_read_b64_tr_b16 v[90:91], v29
    ds_read_b64_tr_b16 v[92:93], v29 offset:2304
    s_waitcnt lgkmcnt(6)
    v_mfma_f32_16x16x32_bf16 a[12:15], v[94:97], v[66:69], a[12:15]
    v_mfma_f32_16x16x32_bf16 a[40:43], v[94:97], v[70:73], a[40:43]
    v_mfma_f32_16x16x32_bf16 a[68:71], v[94:97], v[74:77], a[68:71]
    v_mfma_f32_16x16x32_bf16 a[96:99], v[94:97], v[78:81], a[96:99]
    v_mfma_f32_16x16x32_bf16 a[124:127], v[94:97], v[82:85], a[124:127]
    s_waitcnt lgkmcnt(0)
    s_waitcnt vmcnt(10)
    s_barrier
    v_add_u32 v30, 101376, v45
    v_add_u32 v23, 73728, v15
    v_add_u32 v24, 73728, v16
    v_add_u32 v25, 73728, v17
    v_add_u32 v26, 73728, v18
    v_add_u32 v27, 73728, v19
    v_add_u32 v28, 73728, v20
    v_add_u32 v29, 73728, v21
    ds_read_b64_tr_b16 v[94:95], v23
    ds_read_b64_tr_b16 v[96:97], v23 offset:2304
    v_mfma_f32_16x16x32_bf16 a[16:19], v[98:101], v[66:69], a[16:19]
    v_mfma_f32_16x16x32_bf16 a[44:47], v[98:101], v[70:73], a[44:47]
    ds_read_b128 v[46:49], v30 offset:0
    v_mfma_f32_16x16x32_bf16 a[72:75], v[98:101], v[74:77], a[72:75]
    v_mfma_f32_16x16x32_bf16 a[100:103], v[98:101], v[78:81], a[100:103]
    ds_read_b128 v[50:53], v30 offset:1024
    v_mfma_f32_16x16x32_bf16 v[104:107], v[98:101], v[82:85], v[104:107]
    ds_read_b64_tr_b16 v[98:99], v24
    ds_read_b64_tr_b16 v[100:101], v24 offset:2304
    v_mfma_f32_16x16x32_bf16 a[20:23], v[86:89], v[66:69], a[20:23]
    v_mfma_f32_16x16x32_bf16 a[48:51], v[86:89], v[70:73], a[48:51]
    ds_read_b128 v[54:57], v30 offset:2048
    v_mfma_f32_16x16x32_bf16 a[76:79], v[86:89], v[74:77], a[76:79]
    v_mfma_f32_16x16x32_bf16 a[104:107], v[86:89], v[78:81], a[104:107]
    ds_read_b128 v[58:61], v30 offset:3072
    v_mfma_f32_16x16x32_bf16 v[108:111], v[86:89], v[82:85], v[108:111]
    ds_read_b64_tr_b16 v[86:87], v25
    ds_read_b64_tr_b16 v[88:89], v25 offset:2304
    v_mfma_f32_16x16x32_bf16 a[24:27], v[90:93], v[66:69], a[24:27]
    v_mfma_f32_16x16x32_bf16 a[52:55], v[90:93], v[70:73], a[52:55]
    ds_read_b128 v[62:65], v30 offset:4096
    v_mfma_f32_16x16x32_bf16 a[80:83], v[90:93], v[74:77], a[80:83]
    v_mfma_f32_16x16x32_bf16 a[108:111], v[90:93], v[78:81], a[108:111]
    s_add_u32 m0, s29, 36864
    s_nop 0
    buffer_load_dwordx4 v10, s[12:15], s31 offen lds
    v_mfma_f32_16x16x32_bf16 v[112:115], v[90:93], v[82:85], v[112:115]
    s_add_u32 m0, s29, 37888
    s_nop 0
    buffer_load_dwordx4 v11, s[12:15], s31 offen lds
    s_add_u32 m0, s29, 38912
    s_nop 0
    buffer_load_dwordx4 v12, s[12:15], s31 offen lds
    s_add_u32 m0, s29, 39936
    s_nop 0
    buffer_load_dwordx4 v13, s[12:15], s31 offen lds
    s_add_u32 m0, s29, 40960
    s_mov_b32 exec_hi, 0
    buffer_load_dwordx4 v14, s[12:15], s31 offen lds
    s_mov_b32 exec_hi, -1
    s_add_u32 s31, s31, s34
    ds_read_b64_tr_b16 v[90:91], v26
    ds_read_b64_tr_b16 v[92:93], v26 offset:2304
    s_waitcnt lgkmcnt(2)
    v_mfma_f32_16x16x32_bf16 a[0:3], v[94:97], v[46:49], a[0:3]
    v_mfma_f32_16x16x32_bf16 a[28:31], v[94:97], v[50:53], a[28:31]
    v_mfma_f32_16x16x32_bf16 a[56:59], v[94:97], v[54:57], a[56:59]
    v_mfma_f32_16x16x32_bf16 a[84:87], v[94:97], v[58:61], a[84:87]
    v_mfma_f32_16x16x32_bf16 a[112:115], v[94:97], v[62:65], a[112:115]
    ds_read_b64_tr_b16 v[94:95], v27
    ds_read_b64_tr_b16 v[96:97], v27 offset:2304
    v_mfma_f32_16x16x32_bf16 a[4:7], v[98:101], v[46:49], a[4:7]
    v_mfma_f32_16x16x32_bf16 a[32:35], v[98:101], v[50:53], a[32:35]
    v_mfma_f32_16x16x32_bf16 a[60:63], v[98:101], v[54:57], a[60:63]
    v_mfma_f32_16x16x32_bf16 a[88:91], v[98:101], v[58:61], a[88:91]
    v_mfma_f32_16x16x32_bf16 a[116:119], v[98:101], v[62:65], a[116:119]
    ds_read_b64_tr_b16 v[98:99], v28
    ds_read_b64_tr_b16 v[100:101], v28 offset:2304
    v_mfma_f32_16x16x32_bf16 a[8:11], v[86:89], v[46:49], a[8:11]
    v_mfma_f32_16x16x32_bf16 a[36:39], v[86:89], v[50:53], a[36:39]
    v_mfma_f32_16x16x32_bf16 a[64:67], v[86:89], v[54:57], a[64:67]
    v_mfma_f32_16x16x32_bf16 a[92:95], v[86:89], v[58:61], a[92:95]
    v_mfma_f32_16x16x32_bf16 a[120:123], v[86:89], v[62:65], a[120:123]
    ds_read_b64_tr_b16 v[86:87], v29
    ds_read_b64_tr_b16 v[88:89], v29 offset:2304
    s_waitcnt lgkmcnt(6)
    v_mfma_f32_16x16x32_bf16 a[12:15], v[90:93], v[46:49], a[12:15]
    v_mfma_f32_16x16x32_bf16 a[40:43], v[90:93], v[50:53], a[40:43]
    v_mfma_f32_16x16x32_bf16 a[68:71], v[90:93], v[54:57], a[68:71]
    v_mfma_f32_16x16x32_bf16 a[96:99], v[90:93], v[58:61], a[96:99]
    v_mfma_f32_16x16x32_bf16 a[124:127], v[90:93], v[62:65], a[124:127]
    s_waitcnt lgkmcnt(0)
    s_waitcnt vmcnt(10)
    s_barrier
    v_add_u32 v30, 138240, v45
    v_add_u32 v23, 110592, v15
    v_add_u32 v24, 110592, v16
    v_add_u32 v25, 110592, v17
    v_add_u32 v26, 110592, v18
    v_add_u32 v27, 110592, v19
    v_add_u32 v28, 110592, v20
    v_add_u32 v29, 110592, v21
    ds_read_b64_tr_b16 v[90:91], v23
    ds_read_b64_tr_b16 v[92:93], v23 offset:2304
    v_mfma_f32_16x16x32_bf16 a[16:19], v[94:97], v[46:49], a[16:19]
    v_mfma_f32_16x16x32_bf16 a[44:47], v[94:97], v[50:53], a[44:47]
    ds_read_b128 v[66:69], v30 offset:0
    v_mfma_f32_16x16x32_bf16 a[72:75], v[94:97], v[54:57], a[72:75]
    v_mfma_f32_16x16x32_bf16 a[100:103], v[94:97], v[58:61], a[100:103]
    ds_read_b128 v[70:73], v30 offset:1024
    v_mfma_f32_16x16x32_bf16 v[104:107], v[94:97], v[62:65], v[104:107]
    ds_read_b64_tr_b16 v[94:95], v24
    ds_read_b64_tr_b16 v[96:97], v24 offset:2304
    v_mfma_f32_16x16x32_bf16 a[20:23], v[98:101], v[46:49], a[20:23]
    v_mfma_f32_16x16x32_bf16 a[48:51], v[98:101], v[50:53], a[48:51]
    ds_read_b128 v[74:77], v30 offset:2048
    v_mfma_f32_16x16x32_bf16 a[76:79], v[98:101], v[54:57], a[76:79]
    v_mfma_f32_16x16x32_bf16 a[104:107], v[98:101], v[58:61], a[104:107]
    ds_read_b128 v[78:81], v30 offset:3072
    v_mfma_f32_16x16x32_bf16 v[108:111], v[98:101], v[62:65], v[108:111]
    ds_read_b64_tr_b16 v[98:99], v25
    ds_read_b64_tr_b16 v[100:101], v25 offset:2304
    v_mfma_f32_16x16x32_bf16 a[24:27], v[86:89], v[46:49], a[24:27]
    v_mfma_f32_16x16x32_bf16 a[52:55], v[86:89], v[50:53], a[52:55]
    ds_read_b128 v[82:85], v30 offset:4096
    v_mfma_f32_16x16x32_bf16 a[80:83], v[86:89], v[54:57], a[80:83]
    v_mfma_f32_16x16x32_bf16 a[108:111], v[86:89], v[58:61], a[108:111]
    s_add_u32 m0, s29, 73728
    s_nop 0
    buffer_load_dwordx4 v10, s[12:15], s31 offen lds
    v_mfma_f32_16x16x32_bf16 v[112:115], v[86:89], v[62:65], v[112:115]
    s_add_u32 m0, s29, 74752
    s_nop 0
    buffer_load_dwordx4 v11, s[12:15], s31 offen lds
    s_add_u32 m0, s29, 75776
    s_nop 0
    buffer_load_dwordx4 v12, s[12:15], s31 offen lds
    s_add_u32 m0, s29, 76800
    s_nop 0
    buffer_load_dwordx4 v13, s[12:15], s31 offen lds
    s_add_u32 m0, s29, 77824
    s_mov_b32 exec_hi, 0
    buffer_load_dwordx4 v14, s[12:15], s31 offen lds
    s_mov_b32 exec_hi, -1
    s_add_u32 s31, s31, s34
    ds_read_b64_tr_b16 v[86:87], v26
    ds_read_b64_tr_b16 v[88:89], v26 offset:2304
    s_waitcnt lgkmcnt(2)
    v_mfma_f32_16x16x32_bf16 a[0:3], v[90:93], v[66:69], a[0:3]
    v_mfma_f32_16x16x32_bf16 a[28:31], v[90:93], v[70:73], a[28:31]
    v_mfma_f32_16x16x32_bf16 a[56:59], v[90:93], v[74:77], a[56:59]
    v_mfma_f32_16x16x32_bf16 a[84:87], v[90:93], v[78:81], a[84:87]
    v_mfma_f32_16x16x32_bf16 a[112:115], v[90:93], v[82:85], a[112:115]
    ds_read_b64_tr_b16 v[90:91], v27
    ds_read_b64_tr_b16 v[92:93], v27 offset:2304
    v_mfma_f32_16x16x32_bf16 a[4:7], v[94:97], v[66:69], a[4:7]
    v_mfma_f32_16x16x32_bf16 a[32:35], v[94:97], v[70:73], a[32:35]
    v_mfma_f32_16x16x32_bf16 a[60:63], v[94:97], v[74:77], a[60:63]
    v_mfma_f32_16x16x32_bf16 a[88:91], v[94:97], v[78:81], a[88:91]
    v_mfma_f32_16x16x32_bf16 a[116:119], v[94:97], v[82:85], a[116:119]
    ds_read_b64_tr_b16 v[94:95], v28
    ds_read_b64_tr_b16 v[96:97], v28 offset:2304
    v_mfma_f32_16x16x32_bf16 a[8:11], v[98:101], v[66:69], a[8:11]
    v_mfma_f32_16x16x32_bf16 a[36:39], v[98:101], v[70:73], a[36:39]
    v_mfma_f32_16x16x32_bf16 a[64:67], v[98:101], v[74:77], a[64:67]
    v_mfma_f32_16x16x32_bf16 a[92:95], v[98:101], v[78:81], a[92:95]
    v_mfma_f32_16x16x32_bf16 a[120:123], v[98:101], v[82:85], a[120:123]
    ds_read_b64_tr_b16 v[98:99], v29
    ds_read_b64_tr_b16 v[100:101], v29 offset:2304
    s_waitcnt lgkmcnt(6)
    v_mfma_f32_16x16x32_bf16 a[12:15], v[86:89], v[66:69], a[12:15]
    v_mfma_f32_16x16x32_bf16 a[40:43], v[86:89], v[70:73], a[40:43]
    v_mfma_f32_16x16x32_bf16 a[68:71], v[86:89], v[74:77], a[68:71]
    v_mfma_f32_16x16x32_bf16 a[96:99], v[86:89], v[78:81], a[96:99]
    v_mfma_f32_16x16x32_bf16 a[124:127], v[86:89], v[82:85], a[124:127]
    s_waitcnt lgkmcnt(0)
    s_waitcnt vmcnt(10)
    s_barrier
    v_add_u32 v30, 27648, v45
    v_add_u32 v23, 0, v15
    v_add_u32 v24, 0, v16
    v_add_u32 v25, 0, v17
    v_add_u32 v26, 0, v18
    v_add_u32 v27, 0, v19
    v_add_u32 v28, 0, v20
    v_add_u32 v29, 0, v21
    ds_read_b64_tr_b16 v[86:87], v23
    ds_read_b64_tr_b16 v[88:89], v23 offset:2304
    v_mfma_f32_16x16x32_bf16 a[16:19], v[90:93], v[66:69], a[16:19]
    v_mfma_f32_16x16x32_bf16 a[44:47], v[90:93], v[70:73], a[44:47]
    ds_read_b128 v[46:49], v30 offset:0
    v_mfma_f32_16x16x32_bf16 a[72:75], v[90:93], v[74:77], a[72:75]
    v_mfma_f32_16x16x32_bf16 a[100:103], v[90:93], v[78:81], a[100:103]
    ds_read_b128 v[50:53], v30 offset:1024
    v_mfma_f32_16x16x32_bf16 v[104:107], v[90:93], v[82:85], v[104:107]
    ds_read_b64_tr_b16 v[90:91], v24
    ds_read_b64_tr_b16 v[92:93], v24 offset:2304
    v_mfma_f32_16x16x32_bf16 a[20:23], v[94:97], v[66:69], a[20:23]
    v_mfma_f32_16x16x32_bf16 a[48:51], v[94:97], v[70:73], a[48:51]
    ds_read_b128 v[54:57], v30 offset:2048
    v_mfma_f32_16x16x32_bf16 a[76:79], v[94:97], v[74:77], a[76:79]
    v_mfma_f32_16x16x32_bf16 a[104:107], v[94:97], v[78:81], a[104:107]
    ds_read_b128 v[58:61], v30 offset:3072
    v_mfma_f32_16x16x32_bf16 v[108:111], v[94:97], v[82:85], v[108:111]
    ds_read_b64_tr_b16 v[94:95], v25
    ds_read_b64_tr_b16 v[96:97], v25 offset:2304
    v_mfma_f32_16x16x32_bf16 a[24:27], v[98:101], v[66:69], a[24:27]
    v_mfma_f32_16x16x32_bf16 a[52:55], v[98:101], v[70:73], a[52:55]
    ds_read_b128 v[62:65], v30 offset:4096
    v_mfma_f32_16x16x32_bf16 a[80:83], v[98:101], v[74:77], a[80:83]
    v_mfma_f32_16x16x32_bf16 a[108:111], v[98:101], v[78:81], a[108:111]
    s_add_u32 m0, s29, 110592
    s_nop 0
    buffer_load_dwordx4 v10, s[12:15], s31 offen lds
    v_mfma_f32_16x16x32_bf16 v[112:115], v[98:101], v[82:85], v[112:115]
    s_add_u32 m0, s29, 111616
    s_nop 0
    buffer_load_dwordx4 v11, s[12:15], s31 offen lds
    s_add_u32 m0, s29, 112640
    s_nop 0
    buffer_load_dwordx4 v12, s[12:15], s31 offen lds
    s_add_u32 m0, s29, 113664
    s_nop 0
    buffer_load_dwordx4 v13, s[12:15], s31 offen lds
    s_add_u32 m0, s29, 114688
    s_mov_b32 exec_hi, 0
    buffer_load_dwordx4 v14, s[12:15], s31 offen lds
    s_mov_b32 exec_hi, -1
    s_add_u32 s31, s31, s34
    ds_read_b64_tr_b16 v[98:99], v26
    ds_read_b64_tr_b16 v[100:101], v26 offset:2304
    s_waitcnt lgkmcnt(2)
    v_mfma_f32_16x16x32_bf16 a[0:3], v[86:89], v[46:49], a[0:3]
    v_mfma_f32_16x16x32_bf16 a[28:31], v[86:89], v[50:53], a[28:31]
    v_mfma_f32_16x16x32_bf16 a[56:59], v[86:89], v[54:57], a[56:59]
    v_mfma_f32_16x16x32_bf16 a[84:87], v[86:89], v[58:61], a[84:87]
    v_mfma_f32_16x16x32_bf16 a[112:115], v[86:89], v[62:65], a[112:115]
    ds_read_b64_tr_b16 v[86:87], v27
    ds_read_b64_tr_b16 v[88:89], v27 offset:2304
    v_mfma_f32_16x16x32_bf16 a[4:7], v[90:93], v[46:49], a[4:7]
    v_mfma_f32_16x16x32_bf16 a[32:35], v[90:93], v[50:53], a[32:35]
    v_mfma_f32_16x16x32_bf16 a[60:63], v[90:93], v[54:57], a[60:63]
    v_mfma_f32_16x16x32_bf16 a[88:91], v[90:93], v[58:61], a[88:91]
    v_mfma_f32_16x16x32_bf16 a[116:119], v[90:93], v[62:65], a[116:119]
    ds_read_b64_tr_b16 v[90:91], v28
    ds_read_b64_tr_b16 v[92:93], v28 offset:2304
    v_mfma_f32_16x16x32_bf16 a[8:11], v[94:97], v[46:49], a[8:11]
    v_mfma_f32_16x16x32_bf16 a[36:39], v[94:97], v[50:53], a[36:39]
    v_mfma_f32_16x16x32_bf16 a[64:67], v[94:97], v[54:57], a[64:67]
    v_mfma_f32_16x16x32_bf16 a[92:95], v[94:97], v[58:61], a[92:95]
    v_mfma_f32_16x16x32_bf16 a[120:123], v[94:97], v[62:65], a[120:123]
    ds_read_b64_tr_b16 v[94:95], v29
    ds_read_b64_tr_b16 v[96:97], v29 offset:2304
    s_waitcnt lgkmcnt(6)
    v_mfma_f32_16x16x32_bf16 a[12:15], v[98:101], v[46:49], a[12:15]
    v_mfma_f32_16x16x32_bf16 a[40:43], v[98:101], v[50:53], a[40:43]
    v_mfma_f32_16x16x32_bf16 a[68:71], v[98:101], v[54:57], a[68:71]
    v_mfma_f32_16x16x32_bf16 a[96:99], v[98:101], v[58:61], a[96:99]
    v_mfma_f32_16x16x32_bf16 a[124:127], v[98:101], v[62:65], a[124:127]
    s_waitcnt lgkmcnt(0)
    s_waitcnt vmcnt(10)
    s_barrier
    v_add_u32 v30, 64512, v45
    v_add_u32 v23, 36864, v15
    v_add_u32 v24, 36864, v16
    v_add_u32 v25, 36864, v17
    v_add_u32 v26, 36864, v18
    v_add_u32 v27, 36864, v19
    v_add_u32 v28, 36864, v20
    v_add_u32 v29, 36864, v21
    ds_read_b64_tr_b16 v[98:99], v23
    ds_read_b64_tr_b16 v[100:101], v23 offset:2304
    v_mfma_f32_16x16x32_bf16 a[16:19], v[86:89], v[46:49], a[16:19]
    v_mfma_f32_16x16x32_bf16 a[44:47], v[86:89], v[50:53], a[44:47]
    ds_read_b128 v[66:69], v30 offset:0
    v_mfma_f32_16x16x32_bf16 a[72:75], v[86:89], v[54:57], a[72:75]
    v_mfma_f32_16x16x32_bf16 a[100:103], v[86:89], v[58:61], a[100:103]
    ds_read_b128 v[70:73], v30 offset:1024
    v_mfma_f32_16x16x32_bf16 v[104:107], v[86:89], v[62:65], v[104:107]
    ds_read_b64_tr_b16 v[86:87], v24
    ds_read_b64_tr_b16 v[88:89], v24 offset:2304
    v_mfma_f32_16x16x32_bf16 a[20:23], v[90:93], v[46:49], a[20:23]
    v_mfma_f32_16x16x32_bf16 a[48:51], v[90:93], v[50:53], a[48:51]
    ds_read_b128 v[74:77], v30 offset:2048
    v_mfma_f32_16x16x32_bf16 a[76:79], v[90:93], v[54:57], a[76:79]
    v_mfma_f32_16x16x32_bf16 a[104:107], v[90:93], v[58:61], a[104:107]
    ds_read_b128 v[78:81], v30 offset:3072
    v_mfma_f32_16x16x32_bf16 v[108:111], v[90:93], v[62:65], v[108:111]
    ds_read_b64_tr_b16 v[90:91], v25
    ds_read_b64_tr_b16 v[92:93], v25 offset:2304
    v_mfma_f32_16x16x32_bf16 a[24:27], v[94:97], v[46:49], a[24:27]
    v_mfma_f32_16x16x32_bf16 a[52:55], v[94:97], v[50:53], a[52:55]
    ds_read_b128 v[82:85], v30 offset:4096
    v_mfma_f32_16x16x32_bf16 a[80:83], v[94:97], v[54:57], a[80:83]
    v_mfma_f32_16x16x32_bf16 a[108:111], v[94:97], v[58:61], a[108:111]
    s_add_u32 m0, s29, 0
    s_nop 0
    buffer_load_dwordx4 v10, s[12:15], s31 offen lds
    v_mfma_f32_16x16x32_bf16 v[112:115], v[94:97], v[62:65], v[112:115]
    s_add_u32 m0, s29, 1024
    s_nop 0
    buffer_load_dwordx4 v11, s[12:15], s31 offen lds
    s_add_u32 m0, s29, 2048
    s_nop 0
    buffer_load_dwordx4 v12, s[12:15], s31 offen lds
    s_add_u32 m0, s29, 3072
    s_nop 0
    buffer_load_dwordx4 v13, s[12:15], s31 offen lds
    s_add_u32 m0, s29, 4096
    s_mov_b32 exec_hi, 0
    buffer_load_dwordx4 v14, s[12:15], s31 offen lds
    s_mov_b32 exec_hi, -1
    s_add_u32 s31, s31, s34
    ds_read_b64_tr_b16 v[94:95], v26
    ds_read_b64_tr_b16 v[96:97], v26 offset:2304
    s_waitcnt lgkmcnt(2)
    v_mfma_f32_16x16x32_bf16 a[0:3], v[98:101], v[66:69], a[0:3]
    v_mfma_f32_16x16x32_bf16 a[28:31], v[98:101], v[70:73], a[28:31]
    v_mfma_f32_16x16x32_bf16 a[56:59], v[98:101], v[74:77], a[56:59]
    v_mfma_f32_16x16x32_bf16 a[84:87], v[98:101], v[78:81], a[84:87]
    v_mfma_f32_16x16x32_bf16 a[112:115], v[98:101], v[82:85], a[112:115]
    ds_read_b64_tr_b16 v[98:99], v27
    ds_read_b64_tr_b16 v[100:101], v27 offset:2304
    v_mfma_f32_16x16x32_bf16 a[4:7], v[86:89], v[66:69], a[4:7]
    v_mfma_f32_16x16x32_bf16 a[32:35], v[86:89], v[70:73], a[32:35]
    v_mfma_f32_16x16x32_bf16 a[60:63], v[86:89], v[74:77], a[60:63]
    v_mfma_f32_16x16x32_bf16 a[88:91], v[86:89], v[78:81], a[88:91]
    v_mfma_f32_16x16x32_bf16 a[116:119], v[86:89], v[82:85], a[116:119]
    ds_read_b64_tr_b16 v[86:87], v28
    ds_read_b64_tr_b16 v[88:89], v28 offset:2304
    v_mfma_f32_16x16x32_bf16 a[8:11], v[90:93], v[66:69], a[8:11]
    v_mfma_f32_16x16x32_bf16 a[36:39], v[90:93], v[70:73], a[36:39]
    v_mfma_f32_16x16x32_bf16 a[64:67], v[90:93], v[74:77], a[64:67]
    v_mfma_f32_16x16x32_bf16 a[92:95], v[90:93], v[78:81], a[92:95]
    v_mfma_f32_16x16x32_bf16 a[120:123], v[90:93], v[82:85], a[120:123]
    ds_read_b64_tr_b16 v[90:91], v29
    ds_read_b64_tr_b16 v[92:93], v29 offset:2304
    s_waitcnt lgkmcnt(6)
    v_mfma_f32_16x16x32_bf16 a[12:15], v[94:97], v[66:69], a[12:15]
    v_mfma_f32_16x16x32_bf16 a[40:43], v[94:97], v[70:73], a[40:43]
    v_mfma_f32_16x16x32_bf16 a[68:71], v[94:97], v[74:77], a[68:71]
    v_mfma_f32_16x16x32_bf16 a[96:99], v[94:97], v[78:81], a[96:99]
    v_mfma_f32_16x16x32_bf16 a[124:127], v[94:97], v[82:85], a[124:127]
    s_waitcnt lgkmcnt(0)
    s_waitcnt vmcnt(10)
    s_barrier
    v_add_u32 v30, 101376, v45
    v_add_u32 v23, 73728, v15
    v_add_u32 v24, 73728, v16
    v_add_u32 v25, 73728, v17
    v_add_u32 v26, 73728, v18
    v_add_u32 v27, 73728, v19
    v_add_u32 v28, 73728, v20
    v_add_u32 v29, 73728, v21
    ds_read_b64_tr_b16 v[94:95], v23
    ds_read_b64_tr_b16 v[96:97], v23 offset:2304
    v_mfma_f32_16x16x32_bf16 a[16:19], v[98:101], v[66:69], a[16:19]
    v_mfma_f32_16x16x32_bf16 a[44:47], v[98:101], v[70:73], a[44:47]
    ds_read_b128 v[46:49], v30 offset:0
    v_mfma_f32_16x16x32_bf16 a[72:75], v[98:101], v[74:77], a[72:75]
    v_mfma_f32_16x16x32_bf16 a[100:103], v[98:101], v[78:81], a[100:103]
    ds_read_b128 v[50:53], v30 offset:1024
    v_mfma_f32_16x16x32_bf16 v[104:107], v[98:101], v[82:85], v[104:107]
    ds_read_b64_tr_b16 v[98:99], v24
    ds_read_b64_tr_b16 v[100:101], v24 offset:2304
    v_mfma_f32_16x16x32_bf16 a[20:23], v[86:89], v[66:69], a[20:23]
    v_mfma_f32_16x16x32_bf16 a[48:51], v[86:89], v[70:73], a[48:51]
    ds_read_b128 v[54:57], v30 offset:2048
    v_mfma_f32_16x16x32_bf16 a[76:79], v[86:89], v[74:77], a[76:79]
    v_mfma_f32_16x16x32_bf16 a[104:107], v[86:89], v[78:81], a[104:107]
    ds_read_b128 v[58:61], v30 offset:3072
    v_mfma_f32_16x16x32_bf16 v[108:111], v[86:89], v[82:85], v[108:111]
    ds_read_b64_tr_b16 v[86:87], v25
    ds_read_b64_tr_b16 v[88:89], v25 offset:2304
    v_mfma_f32_16x16x32_bf16 a[24:27], v[90:93], v[66:69], a[24:27]
    v_mfma_f32_16x16x32_bf16 a[52:55], v[90:93], v[70:73], a[52:55]
    ds_read_b128 v[62:65], v30 offset:4096
    v_mfma_f32_16x16x32_bf16 a[80:83], v[90:93], v[74:77], a[80:83]
    v_mfma_f32_16x16x32_bf16 a[108:111], v[90:93], v[78:81], a[108:111]
    s_add_u32 m0, s29, 36864
    s_nop 0
    buffer_load_dwordx4 v10, s[12:15], s31 offen lds
    v_mfma_f32_16x16x32_bf16 v[112:115], v[90:93], v[82:85], v[112:115]
    s_add_u32 m0, s29, 37888
    s_nop 0
    buffer_load_dwordx4 v11, s[12:15], s31 offen lds
    s_add_u32 m0, s29, 38912
    s_nop 0
    buffer_load_dwordx4 v12, s[12:15], s31 offen lds
    s_add_u32 m0, s29, 39936
    s_nop 0
    buffer_load_dwordx4 v13, s[12:15], s31 offen lds
    s_add_u32 m0, s29, 40960
    s_mov_b32 exec_hi, 0
    buffer_load_dwordx4 v14, s[12:15], s31 offen lds
    s_mov_b32 exec_hi, -1
    s_add_u32 s31, s31, s34
    ds_read_b64_tr_b16 v[90:91], v26
    ds_read_b64_tr_b16 v[92:93], v26 offset:2304
    s_waitcnt lgkmcnt(2)
    v_mfma_f32_16x16x32_bf16 a[0:3], v[94:97], v[46:49], a[0:3]
    v_mfma_f32_16x16x32_bf16 a[28:31], v[94:97], v[50:53], a[28:31]
    v_mfma_f32_16x16x32_bf16 a[56:59], v[94:97], v[54:57], a[56:59]
    v_mfma_f32_16x16x32_bf16 a[84:87], v[94:97], v[58:61], a[84:87]
    v_mfma_f32_16x16x32_bf16 a[112:115], v[94:97], v[62:65], a[112:115]
    ds_read_b64_tr_b16 v[94:95], v27
    ds_read_b64_tr_b16 v[96:97], v27 offset:2304
    v_mfma_f32_16x16x32_bf16 a[4:7], v[98:101], v[46:49], a[4:7]
    v_mfma_f32_16x16x32_bf16 a[32:35], v[98:101], v[50:53], a[32:35]
    v_mfma_f32_16x16x32_bf16 a[60:63], v[98:101], v[54:57], a[60:63]
    v_mfma_f32_16x16x32_bf16 a[88:91], v[98:101], v[58:61], a[88:91]
    v_mfma_f32_16x16x32_bf16 a[116:119], v[98:101], v[62:65], a[116:119]
    ds_read_b64_tr_b16 v[98:99], v28
    ds_read_b64_tr_b16 v[100:101], v28 offset:2304
    v_mfma_f32_16x16x32_bf16 a[8:11], v[86:89], v[46:49], a[8:11]
    v_mfma_f32_16x16x32_bf16 a[36:39], v[86:89], v[50:53], a[36:39]
    v_mfma_f32_16x16x32_bf16 a[64:67], v[86:89], v[54:57], a[64:67]
    v_mfma_f32_16x16x32_bf16 a[92:95], v[86:89], v[58:61], a[92:95]
    v_mfma_f32_16x16x32_bf16 a[120:123], v[86:89], v[62:65], a[120:123]
    ds_read_b64_tr_b16 v[86:87], v29
    ds_read_b64_tr_b16 v[88:89], v29 offset:2304
    s_waitcnt lgkmcnt(6)
    v_mfma_f32_16x16x32_bf16 a[12:15], v[90:93], v[46:49], a[12:15]
    v_mfma_f32_16x16x32_bf16 a[40:43], v[90:93], v[50:53], a[40:43]
    v_mfma_f32_16x16x32_bf16 a[68:71], v[90:93], v[54:57], a[68:71]
    v_mfma_f32_16x16x32_bf16 a[96:99], v[90:93], v[58:61], a[96:99]
    v_mfma_f32_16x16x32_bf16 a[124:127], v[90:93], v[62:65], a[124:127]
    s_waitcnt lgkmcnt(0)
    s_waitcnt vmcnt(10)
    s_barrier
    v_add_u32 v30, 138240, v45
    v_add_u32 v23, 110592, v15
    v_add_u32 v24, 110592, v16
    v_add_u32 v25, 110592, v17
    v_add_u32 v26, 110592, v18
    v_add_u32 v27, 110592, v19
    v_add_u32 v28, 110592, v20
    v_add_u32 v29, 110592, v21
    ds_read_b64_tr_b16 v[90:91], v23
    ds_read_b64_tr_b16 v[92:93], v23 offset:2304
    v_mfma_f32_16x16x32_bf16 a[16:19], v[94:97], v[46:49], a[16:19]
    v_mfma_f32_16x16x32_bf16 a[44:47], v[94:97], v[50:53], a[44:47]
    ds_read_b128 v[66:69], v30 offset:0
    v_mfma_f32_16x16x32_bf16 a[72:75], v[94:97], v[54:57], a[72:75]
    v_mfma_f32_16x16x32_bf16 a[100:103], v[94:97], v[58:61], a[100:103]
    ds_read_b128 v[70:73], v30 offset:1024
    v_mfma_f32_16x16x32_bf16 v[104:107], v[94:97], v[62:65], v[104:107]
    ds_read_b64_tr_b16 v[94:95], v24
    ds_read_b64_tr_b16 v[96:97], v24 offset:2304
    v_mfma_f32_16x16x32_bf16 a[20:23], v[98:101], v[46:49], a[20:23]
    v_mfma_f32_16x16x32_bf16 a[48:51], v[98:101], v[50:53], a[48:51]
    ds_read_b128 v[74:77], v30 offset:2048
    v_mfma_f32_16x16x32_bf16 a[76:79], v[98:101], v[54:57], a[76:79]
    v_mfma_f32_16x16x32_bf16 a[104:107], v[98:101], v[58:61], a[104:107]
    ds_read_b128 v[78:81], v30 offset:3072
    v_mfma_f32_16x16x32_bf16 v[108:111], v[98:101], v[62:65], v[108:111]
    ds_read_b64_tr_b16 v[98:99], v25
    ds_read_b64_tr_b16 v[100:101], v25 offset:2304
    v_mfma_f32_16x16x32_bf16 a[24:27], v[86:89], v[46:49], a[24:27]
    v_mfma_f32_16x16x32_bf16 a[52:55], v[86:89], v[50:53], a[52:55]
    ds_read_b128 v[82:85], v30 offset:4096
    v_mfma_f32_16x16x32_bf16 a[80:83], v[86:89], v[54:57], a[80:83]
    v_mfma_f32_16x16x32_bf16 a[108:111], v[86:89], v[58:61], a[108:111]
    s_add_u32 m0, s29, 73728
    s_nop 0
    buffer_load_dwordx4 v10, s[12:15], s31 offen lds
    v_mfma_f32_16x16x32_bf16 v[112:115], v[86:89], v[62:65], v[112:115]
    s_add_u32 m0, s29, 74752
    s_nop 0
    buffer_load_dwordx4 v11, s[12:15], s31 offen lds
    s_add_u32 m0, s29, 75776
    s_nop 0
    buffer_load_dwordx4 v12, s[12:15], s31 offen lds
    s_add_u32 m0, s29, 76800
    s_nop 0
    buffer_load_dwordx4 v13, s[12:15], s31 offen lds
    s_add_u32 m0, s29, 77824
    s_mov_b32 exec_hi, 0
    buffer_load_dwordx4 v14, s[12:15], s31 offen lds
    s_mov_b32 exec_hi, -1
    s_add_u32 s31, s31, s34
    ds_read_b64_tr_b16 v[86:87], v26
    ds_read_b64_tr_b16 v[88:89], v26 offset:2304
    s_waitcnt lgkmcnt(2)
    v_mfma_f32_16x16x32_bf16 a[0:3], v[90:93], v[66:69], a[0:3]
    v_mfma_f32_16x16x32_bf16 a[28:31], v[90:93], v[70:73], a[28:31]
    v_mfma_f32_16x16x32_bf16 a[56:59], v[90:93], v[74:77], a[56:59]
    v_mfma_f32_16x16x32_bf16 a[84:87], v[90:93], v[78:81], a[84:87]
    v_mfma_f32_16x16x32_bf16 a[112:115], v[90:93], v[82:85], a[112:115]
    ds_read_b64_tr_b16 v[90:91], v27
    ds_read_b64_tr_b16 v[92:93], v27 offset:2304
    v_mfma_f32_16x16x32_bf16 a[4:7], v[94:97], v[66:69], a[4:7]
    v_mfma_f32_16x16x32_bf16 a[32:35], v[94:97], v[70:73], a[32:35]
    v_mfma_f32_16x16x32_bf16 a[60:63], v[94:97], v[74:77], a[60:63]
    v_mfma_f32_16x16x32_bf16 a[88:91], v[94:97], v[78:81], a[88:91]
    v_mfma_f32_16x16x32_bf16 a[116:119], v[94:97], v[82:85], a[116:119]
    ds_read_b64_tr_b16 v[94:95], v28
    ds_read_b64_tr_b16 v[96:97], v28 offset:2304
    v_mfma_f32_16x16x32_bf16 a[8:11], v[98:101], v[66:69], a[8:11]
    v_mfma_f32_16x16x32_bf16 a[36:39], v[98:101], v[70:73], a[36:39]
    v_mfma_f32_16x16x32_bf16 a[64:67], v[98:101], v[74:77], a[64:67]
    v_mfma_f32_16x16x32_bf16 a[92:95], v[98:101], v[78:81], a[92:95]
    v_mfma_f32_16x16x32_bf16 a[120:123], v[98:101], v[82:85], a[120:123]
    ds_read_b64_tr_b16 v[98:99], v29
    ds_read_b64_tr_b16 v[100:101], v29 offset:2304
    s_waitcnt lgkmcnt(6)
    v_mfma_f32_16x16x32_bf16 a[12:15], v[86:89], v[66:69], a[12:15]
    v_mfma_f32_16x16x32_bf16 a[40:43], v[86:89], v[70:73], a[40:43]
    v_mfma_f32_16x16x32_bf16 a[68:71], v[86:89], v[74:77], a[68:71]
    v_mfma_f32_16x16x32_bf16 a[96:99], v[86:89], v[78:81], a[96:99]
    v_mfma_f32_16x16x32_bf16 a[124:127], v[86:89], v[82:85], a[124:127]
    s_waitcnt lgkmcnt(0)
    s_waitcnt vmcnt(10)
    s_barrier
    v_add_u32 v30, 27648, v45
    v_add_u32 v23, 0, v15
    v_add_u32 v24, 0, v16
    v_add_u32 v25, 0, v17
    v_add_u32 v26, 0, v18
    v_add_u32 v27, 0, v19
    v_add_u32 v28, 0, v20
    v_add_u32 v29, 0, v21
    ds_read_b64_tr_b16 v[86:87], v23
    ds_read_b64_tr_b16 v[88:89], v23 offset:2304
    v_mfma_f32_16x16x32_bf16 a[16:19], v[90:93], v[66:69], a[16:19]
    v_mfma_f32_16x16x32_bf16 a[44:47], v[90:93], v[70:73], a[44:47]
    ds_read_b128 v[46:49], v30 offset:0
    v_mfma_f32_16x16x32_bf16 a[72:75], v[90:93], v[74:77], a[72:75]
    v_mfma_f32_16x16x32_bf16 a[100:103], v[90:93], v[78:81], a[100:103]
    ds_read_b128 v[50:53], v30 offset:1024
    v_mfma_f32_16x16x32_bf16 v[104:107], v[90:93], v[82:85], v[104:107]
    ds_read_b64_tr_b16 v[90:91], v24
    ds_read_b64_tr_b16 v[92:93], v24 offset:2304
    v_mfma_f32_16x16x32_bf16 a[20:23], v[94:97], v[66:69], a[20:23]
    v_mfma_f32_16x16x32_bf16 a[48:51], v[94:97], v[70:73], a[48:51]
    ds_read_b128 v[54:57], v30 offset:2048
    v_mfma_f32_16x16x32_bf16 a[76:79], v[94:97], v[74:77], a[76:79]
    v_mfma_f32_16x16x32_bf16 a[104:107], v[94:97], v[78:81], a[104:107]
    ds_read_b128 v[58:61], v30 offset:3072
    v_mfma_f32_16x16x32_bf16 v[108:111], v[94:97], v[82:85], v[108:111]
    ds_read_b64_tr_b16 v[94:95], v25
    ds_read_b64_tr_b16 v[96:97], v25 offset:2304
    v_mfma_f32_16x16x32_bf16 a[24:27], v[98:101], v[66:69], a[24:27]
    v_mfma_f32_16x16x32_bf16 a[52:55], v[98:101], v[70:73], a[52:55]
    ds_read_b128 v[62:65], v30 offset:4096
    v_mfma_f32_16x16x32_bf16 a[80:83], v[98:101], v[74:77], a[80:83]
    v_mfma_f32_16x16x32_bf16 a[108:111], v[98:101], v[78:81], a[108:111]
    s_add_u32 m0, s29, 110592
    s_nop 0
    buffer_load_dwordx4 v10, s[12:15], s31 offen lds
    v_mfma_f32_16x16x32_bf16 v[112:115], v[98:101], v[82:85], v[112:115]
    s_add_u32 m0, s29, 111616
    s_nop 0
    buffer_load_dwordx4 v11, s[12:15], s31 offen lds
    s_add_u32 m0, s29, 112640
    s_nop 0
    buffer_load_dwordx4 v12, s[12:15], s31 offen lds
    s_add_u32 m0, s29, 113664
    s_nop 0
    buffer_load_dwordx4 v13, s[12:15], s31 offen lds
    s_add_u32 m0, s29, 114688
    s_mov_b32 exec_hi, 0
    buffer_load_dwordx4 v14, s[12:15], s31 offen lds
    s_mov_b32 exec_hi, -1
    s_add_u32 s31, s31, s34
    ds_read_b64_tr_b16 v[98:99], v26
    ds_read_b64_tr_b16 v[100:101], v26 offset:2304
    s_waitcnt lgkmcnt(2)
    v_mfma_f32_16x16x32_bf16 a[0:3], v[86:89], v[46:49], a[0:3]
    v_mfma_f32_16x16x32_bf16 a[28:31], v[86:89], v[50:53], a[28:31]
    v_mfma_f32_16x16x32_bf16 a[56:59], v[86:89], v[54:57], a[56:59]
    v_mfma_f32_16x16x32_bf16 a[84:87], v[86:89], v[58:61], a[84:87]
    v_mfma_f32_16x16x32_bf16 a[112:115], v[86:89], v[62:65], a[112:115]
    ds_read_b64_tr_b16 v[86:87], v27
    ds_read_b64_tr_b16 v[88:89], v27 offset:2304
    v_mfma_f32_16x16x32_bf16 a[4:7], v[90:93], v[46:49], a[4:7]
    v_mfma_f32_16x16x32_bf16 a[32:35], v[90:93], v[50:53], a[32:35]
    v_mfma_f32_16x16x32_bf16 a[60:63], v[90:93], v[54:57], a[60:63]
    v_mfma_f32_16x16x32_bf16 a[88:91], v[90:93], v[58:61], a[88:91]
    v_mfma_f32_16x16x32_bf16 a[116:119], v[90:93], v[62:65], a[116:119]
    ds_read_b64_tr_b16 v[90:91], v28
    ds_read_b64_tr_b16 v[92:93], v28 offset:2304
    v_mfma_f32_16x16x32_bf16 a[8:11], v[94:97], v[46:49], a[8:11]
    v_mfma_f32_16x16x32_bf16 a[36:39], v[94:97], v[50:53], a[36:39]
    v_mfma_f32_16x16x32_bf16 a[64:67], v[94:97], v[54:57], a[64:67]
    v_mfma_f32_16x16x32_bf16 a[92:95], v[94:97], v[58:61], a[92:95]
    v_mfma_f32_16x16x32_bf16 a[120:123], v[94:97], v[62:65], a[120:123]
    ds_read_b64_tr_b16 v[94:95], v29
    ds_read_b64_tr_b16 v[96:97], v29 offset:2304
    s_waitcnt lgkmcnt(6)
    v_mfma_f32_16x16x32_bf16 a[12:15], v[98:101], v[46:49], a[12:15]
    v_mfma_f32_16x16x32_bf16 a[40:43], v[98:101], v[50:53], a[40:43]
    v_mfma_f32_16x16x32_bf16 a[68:71], v[98:101], v[54:57], a[68:71]
    v_mfma_f32_16x16x32_bf16 a[96:99], v[98:101], v[58:61], a[96:99]
    v_mfma_f32_16x16x32_bf16 a[124:127], v[98:101], v[62:65], a[124:127]
    s_waitcnt lgkmcnt(0)
    s_waitcnt vmcnt(10)
    s_barrier
    v_add_u32 v30, 64512, v45
    v_add_u32 v23, 36864, v15
    v_add_u32 v24, 36864, v16
    v_add_u32 v25, 36864, v17
    v_add_u32 v26, 36864, v18
    v_add_u32 v27, 36864, v19
    v_add_u32 v28, 36864, v20
    v_add_u32 v29, 36864, v21
    ds_read_b64_tr_b16 v[98:99], v23
    ds_read_b64_tr_b16 v[100:101], v23 offset:2304
    v_mfma_f32_16x16x32_bf16 a[16:19], v[86:89], v[46:49], a[16:19]
    v_mfma_f32_16x16x32_bf16 a[44:47], v[86:89], v[50:53], a[44:47]
    ds_read_b128 v[66:69], v30 offset:0
    v_mfma_f32_16x16x32_bf16 a[72:75], v[86:89], v[54:57], a[72:75]
    v_mfma_f32_16x16x32_bf16 a[100:103], v[86:89], v[58:61], a[100:103]
    ds_read_b128 v[70:73], v30 offset:1024
    v_mfma_f32_16x16x32_bf16 v[104:107], v[86:89], v[62:65], v[104:107]
    ds_read_b64_tr_b16 v[86:87], v24
    ds_read_b64_tr_b16 v[88:89], v24 offset:2304
    v_mfma_f32_16x16x32_bf16 a[20:23], v[90:93], v[46:49], a[20:23]
    v_mfma_f32_16x16x32_bf16 a[48:51], v[90:93], v[50:53], a[48:51]
    ds_read_b128 v[74:77], v30 offset:2048
    v_mfma_f32_16x16x32_bf16 a[76:79], v[90:93], v[54:57], a[76:79]
    v_mfma_f32_16x16x32_bf16 a[104:107], v[90:93], v[58:61], a[104:107]
    ds_read_b128 v[78:81], v30 offset:3072
    v_mfma_f32_16x16x32_bf16 v[108:111], v[90:93], v[62:65], v[108:111]
    ds_read_b64_tr_b16 v[90:91], v25
    ds_read_b64_tr_b16 v[92:93], v25 offset:2304
    v_mfma_f32_16x16x32_bf16 a[24:27], v[94:97], v[46:49], a[24:27]
    v_mfma_f32_16x16x32_bf16 a[52:55], v[94:97], v[50:53], a[52:55]
    ds_read_b128 v[82:85], v30 offset:4096
    v_mfma_f32_16x16x32_bf16 a[80:83], v[94:97], v[54:57], a[80:83]
    v_mfma_f32_16x16x32_bf16 a[108:111], v[94:97], v[58:61], a[108:111]
    s_add_u32 m0, s29, 0
    s_nop 0
    buffer_load_dwordx4 v10, s[12:15], s31 offen lds
    v_mfma_f32_16x16x32_bf16 v[112:115], v[94:97], v[62:65], v[112:115]
    s_add_u32 m0, s29, 1024
    s_nop 0
    buffer_load_dwordx4 v11, s[12:15], s31 offen lds
    s_add_u32 m0, s29, 2048
    s_nop 0
    buffer_load_dwordx4 v12, s[12:15], s31 offen lds
    s_add_u32 m0, s29, 3072
    s_nop 0
    buffer_load_dwordx4 v13, s[12:15], s31 offen lds
    s_add_u32 m0, s29, 4096
    s_mov_b32 exec_hi, 0
    buffer_load_dwordx4 v14, s[12:15], s31 offen lds
    s_mov_b32 exec_hi, -1
    s_add_u32 s31, s31, s34
    ds_read_b64_tr_b16 v[94:95], v26
    ds_read_b64_tr_b16 v[96:97], v26 offset:2304
    s_waitcnt lgkmcnt(2)
    v_mfma_f32_16x16x32_bf16 a[0:3], v[98:101], v[66:69], a[0:3]
    v_mfma_f32_16x16x32_bf16 a[28:31], v[98:101], v[70:73], a[28:31]
    v_mfma_f32_16x16x32_bf16 a[56:59], v[98:101], v[74:77], a[56:59]
    v_mfma_f32_16x16x32_bf16 a[84:87], v[98:101], v[78:81], a[84:87]
    v_mfma_f32_16x16x32_bf16 a[112:115], v[98:101], v[82:85], a[112:115]
    ds_read_b64_tr_b16 v[98:99], v27
    ds_read_b64_tr_b16 v[100:101], v27 offset:2304
    v_mfma_f32_16x16x32_bf16 a[4:7], v[86:89], v[66:69], a[4:7]
    v_mfma_f32_16x16x32_bf16 a[32:35], v[86:89], v[70:73], a[32:35]
    v_mfma_f32_16x16x32_bf16 a[60:63], v[86:89], v[74:77], a[60:63]
    v_mfma_f32_16x16x32_bf16 a[88:91], v[86:89], v[78:81], a[88:91]
    v_mfma_f32_16x16x32_bf16 a[116:119], v[86:89], v[82:85], a[116:119]
    ds_read_b64_tr_b16 v[86:87], v28
    ds_read_b64_tr_b16 v[88:89], v28 offset:2304
    v_mfma_f32_16x16x32_bf16 a[8:11], v[90:93], v[66:69], a[8:11]
    v_mfma_f32_16x16x32_bf16 a[36:39], v[90:93], v[70:73], a[36:39]
    v_mfma_f32_16x16x32_bf16 a[64:67], v[90:93], v[74:77], a[64:67]
    v_mfma_f32_16x16x32_bf16 a[92:95], v[90:93], v[78:81], a[92:95]
    v_mfma_f32_16x16x32_bf16 a[120:123], v[90:93], v[82:85], a[120:123]
    ds_read_b64_tr_b16 v[90:91], v29
    ds_read_b64_tr_b16 v[92:93], v29 offset:2304
    s_waitcnt lgkmcnt(6)
    v_mfma_f32_16x16x32_bf16 a[12:15], v[94:97], v[66:69], a[12:15]
    v_mfma_f32_16x16x32_bf16 a[40:43], v[94:97], v[70:73], a[40:43]
    v_mfma_f32_16x16x32_bf16 a[68:71], v[94:97], v[74:77], a[68:71]
    v_mfma_f32_16x16x32_bf16 a[96:99], v[94:97], v[78:81], a[96:99]
    v_mfma_f32_16x16x32_bf16 a[124:127], v[94:97], v[82:85], a[124:127]
    s_waitcnt lgkmcnt(0)
    s_waitcnt vmcnt(10)
    s_barrier
    v_add_u32 v30, 101376, v45
    v_add_u32 v23, 73728, v15
    v_add_u32 v24, 73728, v16
    v_add_u32 v25, 73728, v17
    v_add_u32 v26, 73728, v18
    v_add_u32 v27, 73728, v19
    v_add_u32 v28, 73728, v20
    v_add_u32 v29, 73728, v21
    ds_read_b64_tr_b16 v[94:95], v23
    ds_read_b64_tr_b16 v[96:97], v23 offset:2304
    v_mfma_f32_16x16x32_bf16 a[16:19], v[98:101], v[66:69], a[16:19]
    v_mfma_f32_16x16x32_bf16 a[44:47], v[98:101], v[70:73], a[44:47]
    ds_read_b128 v[46:49], v30 offset:0
    v_mfma_f32_16x16x32_bf16 a[72:75], v[98:101], v[74:77], a[72:75]
    v_mfma_f32_16x16x32_bf16 a[100:103], v[98:101], v[78:81], a[100:103]
    ds_read_b128 v[50:53], v30 offset:1024
    v_mfma_f32_16x16x32_bf16 v[104:107], v[98:101], v[82:85], v[104:107]
    ds_read_b64_tr_b16 v[98:99], v24
    ds_read_b64_tr_b16 v[100:101], v24 offset:2304
    v_mfma_f32_16x16x32_bf16 a[20:23], v[86:89], v[66:69], a[20:23]
    v_mfma_f32_16x16x32_bf16 a[48:51], v[86:89], v[70:73], a[48:51]
    ds_read_b128 v[54:57], v30 offset:2048
    v_mfma_f32_16x16x32_bf16 a[76:79], v[86:89], v[74:77], a[76:79]
    v_mfma_f32_16x16x32_bf16 a[104:107], v[86:89], v[78:81], a[104:107]
    ds_read_b128 v[58:61], v30 offset:3072
    v_mfma_f32_16x16x32_bf16 v[108:111], v[86:89], v[82:85], v[108:111]
    ds_read_b64_tr_b16 v[86:87], v25
    ds_read_b64_tr_b16 v[88:89], v25 offset:2304
    v_mfma_f32_16x16x32_bf16 a[24:27], v[90:93], v[66:69], a[24:27]
    v_mfma_f32_16x16x32_bf16 a[52:55], v[90:93], v[70:73], a[52:55]
    ds_read_b128 v[62:65], v30 offset:4096
    v_mfma_f32_16x16x32_bf16 a[80:83], v[90:93], v[74:77], a[80:83]
    v_mfma_f32_16x16x32_bf16 a[108:111], v[90:93], v[78:81], a[108:111]
    s_add_u32 m0, s29, 36864
    s_nop 0
    buffer_load_dwordx4 v10, s[12:15], s31 offen lds
    v_mfma_f32_16x16x32_bf16 v[112:115], v[90:93], v[82:85], v[112:115]
    s_add_u32 m0, s29, 37888
    s_nop 0
    buffer_load_dwordx4 v11, s[12:15], s31 offen lds
    s_add_u32 m0, s29, 38912
    s_nop 0
    buffer_load_dwordx4 v12, s[12:15], s31 offen lds
    s_add_u32 m0, s29, 39936
    s_nop 0
    buffer_load_dwordx4 v13, s[12:15], s31 offen lds
    s_add_u32 m0, s29, 40960
    s_mov_b32 exec_hi, 0
    buffer_load_dwordx4 v14, s[12:15], s31 offen lds
    s_mov_b32 exec_hi, -1
    s_add_u32 s31, s31, s34
    ds_read_b64_tr_b16 v[90:91], v26
    ds_read_b64_tr_b16 v[92:93], v26 offset:2304
    s_waitcnt lgkmcnt(2)
    v_mfma_f32_16x16x32_bf16 a[0:3], v[94:97], v[46:49], a[0:3]
    v_mfma_f32_16x16x32_bf16 a[28:31], v[94:97], v[50:53], a[28:31]
    v_mfma_f32_16x16x32_bf16 a[56:59], v[94:97], v[54:57], a[56:59]
    v_mfma_f32_16x16x32_bf16 a[84:87], v[94:97], v[58:61], a[84:87]
    v_mfma_f32_16x16x32_bf16 a[112:115], v[94:97], v[62:65], a[112:115]
    ds_read_b64_tr_b16 v[94:95], v27
    ds_read_b64_tr_b16 v[96:97], v27 offset:2304
    v_mfma_f32_16x16x32_bf16 a[4:7], v[98:101], v[46:49], a[4:7]
    v_mfma_f32_16x16x32_bf16 a[32:35], v[98:101], v[50:53], a[32:35]
    v_mfma_f32_16x16x32_bf16 a[60:63], v[98:101], v[54:57], a[60:63]
    v_mfma_f32_16x16x32_bf16 a[88:91], v[98:101], v[58:61], a[88:91]
    v_mfma_f32_16x16x32_bf16 a[116:119], v[98:101], v[62:65], a[116:119]
    ds_read_b64_tr_b16 v[98:99], v28
    ds_read_b64_tr_b16 v[100:101], v28 offset:2304
    v_mfma_f32_16x16x32_bf16 a[8:11], v[86:89], v[46:49], a[8:11]
    v_mfma_f32_16x16x32_bf16 a[36:39], v[86:89], v[50:53], a[36:39]
    v_mfma_f32_16x16x32_bf16 a[64:67], v[86:89], v[54:57], a[64:67]
    v_mfma_f32_16x16x32_bf16 a[92:95], v[86:89], v[58:61], a[92:95]
    v_mfma_f32_16x16x32_bf16 a[120:123], v[86:89], v[62:65], a[120:123]
    ds_read_b64_tr_b16 v[86:87], v29
    ds_read_b64_tr_b16 v[88:89], v29 offset:2304
    s_waitcnt lgkmcnt(6)
    v_mfma_f32_16x16x32_bf16 a[12:15], v[90:93], v[46:49], a[12:15]
    v_mfma_f32_16x16x32_bf16 a[40:43], v[90:93], v[50:53], a[40:43]
    v_mfma_f32_16x16x32_bf16 a[68:71], v[90:93], v[54:57], a[68:71]
    v_mfma_f32_16x16x32_bf16 a[96:99], v[90:93], v[58:61], a[96:99]
    v_mfma_f32_16x16x32_bf16 a[124:127], v[90:93], v[62:65], a[124:127]
    s_waitcnt lgkmcnt(0)
    s_waitcnt vmcnt(10)
    s_barrier
    v_add_u32 v30, 138240, v45
    v_add_u32 v23, 110592, v15
    v_add_u32 v24, 110592, v16
    v_add_u32 v25, 110592, v17
    v_add_u32 v26, 110592, v18
    v_add_u32 v27, 110592, v19
    v_add_u32 v28, 110592, v20
    v_add_u32 v29, 110592, v21
    ds_read_b64_tr_b16 v[90:91], v23
    ds_read_b64_tr_b16 v[92:93], v23 offset:2304
    v_mfma_f32_16x16x32_bf16 a[16:19], v[94:97], v[46:49], a[16:19]
    v_mfma_f32_16x16x32_bf16 a[44:47], v[94:97], v[50:53], a[44:47]
    ds_read_b128 v[66:69], v30 offset:0
    v_mfma_f32_16x16x32_bf16 a[72:75], v[94:97], v[54:57], a[72:75]
    v_mfma_f32_16x16x32_bf16 a[100:103], v[94:97], v[58:61], a[100:103]
    ds_read_b128 v[70:73], v30 offset:1024
    v_mfma_f32_16x16x32_bf16 v[104:107], v[94:97], v[62:65], v[104:107]
    ds_read_b64_tr_b16 v[94:95], v24
    ds_read_b64_tr_b16 v[96:97], v24 offset:2304
    v_mfma_f32_16x16x32_bf16 a[20:23], v[98:101], v[46:49], a[20:23]
    v_mfma_f32_16x16x32_bf16 a[48:51], v[98:101], v[50:53], a[48:51]
    ds_read_b128 v[74:77], v30 offset:2048
    v_mfma_f32_16x16x32_bf16 a[76:79], v[98:101], v[54:57], a[76:79]
    v_mfma_f32_16x16x32_bf16 a[104:107], v[98:101], v[58:61], a[104:107]
    ds_read_b128 v[78:81], v30 offset:3072
    v_mfma_f32_16x16x32_bf16 v[108:111], v[98:101], v[62:65], v[108:111]
    ds_read_b64_tr_b16 v[98:99], v25
    ds_read_b64_tr_b16 v[100:101], v25 offset:2304
    v_mfma_f32_16x16x32_bf16 a[24:27], v[86:89], v[46:49], a[24:27]
    v_mfma_f32_16x16x32_bf16 a[52:55], v[86:89], v[50:53], a[52:55]
    ds_read_b128 v[82:85], v30 offset:4096
    v_mfma_f32_16x16x32_bf16 a[80:83], v[86:89], v[54:57], a[80:83]
    v_mfma_f32_16x16x32_bf16 a[108:111], v[86:89], v[58:61], a[108:111]
    s_add_u32 m0, s29, 73728
    s_nop 0
    buffer_load_dwordx4 v10, s[12:15], s31 offen lds
    v_mfma_f32_16x16x32_bf16 v[112:115], v[86:89], v[62:65], v[112:115]
    s_add_u32 m0, s29, 74752
    s_nop 0
    buffer_load_dwordx4 v11, s[12:15], s31 offen lds
    s_add_u32 m0, s29, 75776
    s_nop 0
    buffer_load_dwordx4 v12, s[12:15], s31 offen lds
    s_add_u32 m0, s29, 76800
    s_nop 0
    buffer_load_dwordx4 v13, s[12:15], s31 offen lds
    s_add_u32 m0, s29, 77824
    s_mov_b32 exec_hi, 0
    buffer_load_dwordx4 v14, s[12:15], s31 offen lds
    s_mov_b32 exec_hi, -1
    s_add_u32 s31, s31, s34
    ds_read_b64_tr_b16 v[86:87], v26
    ds_read_b64_tr_b16 v[88:89], v26 offset:2304
    s_waitcnt lgkmcnt(2)
    v_mfma_f32_16x16x32_bf16 a[0:3], v[90:93], v[66:69], a[0:3]
    v_mfma_f32_16x16x32_bf16 a[28:31], v[90:93], v[70:73], a[28:31]
    v_mfma_f32_16x16x32_bf16 a[56:59], v[90:93], v[74:77], a[56:59]
    v_mfma_f32_16x16x32_bf16 a[84:87], v[90:93], v[78:81], a[84:87]
    v_mfma_f32_16x16x32_bf16 a[112:115], v[90:93], v[82:85], a[112:115]
    ds_read_b64_tr_b16 v[90:91], v27
    ds_read_b64_tr_b16 v[92:93], v27 offset:2304
    v_mfma_f32_16x16x32_bf16 a[4:7], v[94:97], v[66:69], a[4:7]
    v_mfma_f32_16x16x32_bf16 a[32:35], v[94:97], v[70:73], a[32:35]
    v_mfma_f32_16x16x32_bf16 a[60:63], v[94:97], v[74:77], a[60:63]
    v_mfma_f32_16x16x32_bf16 a[88:91], v[94:97], v[78:81], a[88:91]
    v_mfma_f32_16x16x32_bf16 a[116:119], v[94:97], v[82:85], a[116:119]
    ds_read_b64_tr_b16 v[94:95], v28
    ds_read_b64_tr_b16 v[96:97], v28 offset:2304
    v_mfma_f32_16x16x32_bf16 a[8:11], v[98:101], v[66:69], a[8:11]
    v_mfma_f32_16x16x32_bf16 a[36:39], v[98:101], v[70:73], a[36:39]
    v_mfma_f32_16x16x32_bf16 a[64:67], v[98:101], v[74:77], a[64:67]
    v_mfma_f32_16x16x32_bf16 a[92:95], v[98:101], v[78:81], a[92:95]
    v_mfma_f32_16x16x32_bf16 a[120:123], v[98:101], v[82:85], a[120:123]
    ds_read_b64_tr_b16 v[98:99], v29
    ds_read_b64_tr_b16 v[100:101], v29 offset:2304
    s_waitcnt lgkmcnt(6)
    v_mfma_f32_16x16x32_bf16 a[12:15], v[86:89], v[66:69], a[12:15]
    v_mfma_f32_16x16x32_bf16 a[40:43], v[86:89], v[70:73], a[40:43]
    v_mfma_f32_16x16x32_bf16 a[68:71], v[86:89], v[74:77], a[68:71]
    v_mfma_f32_16x16x32_bf16 a[96:99], v[86:89], v[78:81], a[96:99]
    v_mfma_f32_16x16x32_bf16 a[124:127], v[86:89], v[82:85], a[124:127]
    s_waitcnt lgkmcnt(0)
    s_waitcnt vmcnt(10)
    s_barrier
    v_add_u32 v30, 27648, v45
    v_add_u32 v23, 0, v15
    v_add_u32 v24, 0, v16
    v_add_u32 v25, 0, v17
    v_add_u32 v26, 0, v18
    v_add_u32 v27, 0, v19
    v_add_u32 v28, 0, v20
    v_add_u32 v29, 0, v21
    ds_read_b64_tr_b16 v[86:87], v23
    ds_read_b64_tr_b16 v[88:89], v23 offset:2304
    v_mfma_f32_16x16x32_bf16 a[16:19], v[90:93], v[66:69], a[16:19]
    v_mfma_f32_16x16x32_bf16 a[44:47], v[90:93], v[70:73], a[44:47]
    ds_read_b128 v[46:49], v30 offset:0
    v_mfma_f32_16x16x32_bf16 a[72:75], v[90:93], v[74:77], a[72:75]
    v_mfma_f32_16x16x32_bf16 a[100:103], v[90:93], v[78:81], a[100:103]
    ds_read_b128 v[50:53], v30 offset:1024
    v_mfma_f32_16x16x32_bf16 v[104:107], v[90:93], v[82:85], v[104:107]
    ds_read_b64_tr_b16 v[90:91], v24
    ds_read_b64_tr_b16 v[92:93], v24 offset:2304
    v_mfma_f32_16x16x32_bf16 a[20:23], v[94:97], v[66:69], a[20:23]
    v_mfma_f32_16x16x32_bf16 a[48:51], v[94:97], v[70:73], a[48:51]
    ds_read_b128 v[54:57], v30 offset:2048
    v_mfma_f32_16x16x32_bf16 a[76:79], v[94:97], v[74:77], a[76:79]
    v_mfma_f32_16x16x32_bf16 a[104:107], v[94:97], v[78:81], a[104:107]
    ds_read_b128 v[58:61], v30 offset:3072
    v_mfma_f32_16x16x32_bf16 v[108:111], v[94:97], v[82:85], v[108:111]
    ds_read_b64_tr_b16 v[94:95], v25
    ds_read_b64_tr_b16 v[96:97], v25 offset:2304
    v_mfma_f32_16x16x32_bf16 a[24:27], v[98:101], v[66:69], a[24:27]
    v_mfma_f32_16x16x32_bf16 a[52:55], v[98:101], v[70:73], a[52:55]
    ds_read_b128 v[62:65], v30 offset:4096
    v_mfma_f32_16x16x32_bf16 a[80:83], v[98:101], v[74:77], a[80:83]
    v_mfma_f32_16x16x32_bf16 a[108:111], v[98:101], v[78:81], a[108:111]
    s_add_u32 m0, s29, 110592
    s_nop 0
    buffer_load_dwordx4 v10, s[12:15], s31 offen lds
    v_mfma_f32_16x16x32_bf16 v[112:115], v[98:101], v[82:85], v[112:115]
    s_add_u32 m0, s29, 111616
    s_nop 0
    buffer_load_dwordx4 v11, s[12:15], s31 offen lds
    s_add_u32 m0, s29, 112640
    s_nop 0
    buffer_load_dwordx4 v12, s[12:15], s31 offen lds
    s_add_u32 m0, s29, 113664
    s_nop 0
    buffer_load_dwordx4 v13, s[12:15], s31 offen lds
    s_add_u32 m0, s29, 114688
    s_mov_b32 exec_hi, 0
    buffer_load_dwordx4 v14, s[12:15], s31 offen lds
    s_mov_b32 exec_hi, -1
    s_add_u32 s31, s31, s34
    ds_read_b64_tr_b16 v[98:99], v26
    ds_read_b64_tr_b16 v[100:101], v26 offset:2304
    s_waitcnt lgkmcnt(2)
    v_mfma_f32_16x16x32_bf16 a[0:3], v[86:89], v[46:49], a[0:3]
    v_mfma_f32_16x16x32_bf16 a[28:31], v[86:89], v[50:53], a[28:31]
    v_mfma_f32_16x16x32_bf16 a[56:59], v[86:89], v[54:57], a[56:59]
    v_mfma_f32_16x16x32_bf16 a[84:87], v[86:89], v[58:61], a[84:87]
    v_mfma_f32_16x16x32_bf16 a[112:115], v[86:89], v[62:65], a[112:115]
    ds_read_b64_tr_b16 v[86:87], v27
    ds_read_b64_tr_b16 v[88:89], v27 offset:2304
    v_mfma_f32_16x16x32_bf16 a[4:7], v[90:93], v[46:49], a[4:7]
    v_mfma_f32_16x16x32_bf16 a[32:35], v[90:93], v[50:53], a[32:35]
    v_mfma_f32_16x16x32_bf16 a[60:63], v[90:93], v[54:57], a[60:63]
    v_mfma_f32_16x16x32_bf16 a[88:91], v[90:93], v[58:61], a[88:91]
    v_mfma_f32_16x16x32_bf16 a[116:119], v[90:93], v[62:65], a[116:119]
    ds_read_b64_tr_b16 v[90:91], v28
    ds_read_b64_tr_b16 v[92:93], v28 offset:2304
    v_mfma_f32_16x16x32_bf16 a[8:11], v[94:97], v[46:49], a[8:11]
    v_mfma_f32_16x16x32_bf16 a[36:39], v[94:97], v[50:53], a[36:39]
    v_mfma_f32_16x16x32_bf16 a[64:67], v[94:97], v[54:57], a[64:67]
    v_mfma_f32_16x16x32_bf16 a[92:95], v[94:97], v[58:61], a[92:95]
    v_mfma_f32_16x16x32_bf16 a[120:123], v[94:97], v[62:65], a[120:123]
    ds_read_b64_tr_b16 v[94:95], v29
    ds_read_b64_tr_b16 v[96:97], v29 offset:2304
    s_waitcnt lgkmcnt(6)
    v_mfma_f32_16x16x32_bf16 a[12:15], v[98:101], v[46:49], a[12:15]
    v_mfma_f32_16x16x32_bf16 a[40:43], v[98:101], v[50:53], a[40:43]
    v_mfma_f32_16x16x32_bf16 a[68:71], v[98:101], v[54:57], a[68:71]
    v_mfma_f32_16x16x32_bf16 a[96:99], v[98:101], v[58:61], a[96:99]
    v_mfma_f32_16x16x32_bf16 a[124:127], v[98:101], v[62:65], a[124:127]
    s_waitcnt lgkmcnt(0)
    s_waitcnt vmcnt(10)
    s_barrier
    v_add_u32 v30, 64512, v45
    v_add_u32 v23, 36864, v15
    v_add_u32 v24, 36864, v16
    v_add_u32 v25, 36864, v17
    v_add_u32 v26, 36864, v18
    v_add_u32 v27, 36864, v19
    v_add_u32 v28, 36864, v20
    v_add_u32 v29, 36864, v21
    ds_read_b64_tr_b16 v[98:99], v23
    ds_read_b64_tr_b16 v[100:101], v23 offset:2304
    v_mfma_f32_16x16x32_bf16 a[16:19], v[86:89], v[46:49], a[16:19]
    v_mfma_f32_16x16x32_bf16 a[44:47], v[86:89], v[50:53], a[44:47]
    ds_read_b128 v[66:69], v30 offset:0
    v_mfma_f32_16x16x32_bf16 a[72:75], v[86:89], v[54:57], a[72:75]
    v_mfma_f32_16x16x32_bf16 a[100:103], v[86:89], v[58:61], a[100:103]
    ds_read_b128 v[70:73], v30 offset:1024
    v_mfma_f32_16x16x32_bf16 v[104:107], v[86:89], v[62:65], v[104:107]
    ds_read_b64_tr_b16 v[86:87], v24
    ds_read_b64_tr_b16 v[88:89], v24 offset:2304
    v_mfma_f32_16x16x32_bf16 a[20:23], v[90:93], v[46:49], a[20:23]
    v_mfma_f32_16x16x32_bf16 a[48:51], v[90:93], v[50:53], a[48:51]
    ds_read_b128 v[74:77], v30 offset:2048
    v_mfma_f32_16x16x32_bf16 a[76:79], v[90:93], v[54:57], a[76:79]
    v_mfma_f32_16x16x32_bf16 a[104:107], v[90:93], v[58:61], a[104:107]
    ds_read_b128 v[78:81], v30 offset:3072
    v_mfma_f32_16x16x32_bf16 v[108:111], v[90:93], v[62:65], v[108:111]
    ds_read_b64_tr_b16 v[90:91], v25
    ds_read_b64_tr_b16 v[92:93], v25 offset:2304
    v_mfma_f32_16x16x32_bf16 a[24:27], v[94:97], v[46:49], a[24:27]
    v_mfma_f32_16x16x32_bf16 a[52:55], v[94:97], v[50:53], a[52:55]
    ds_read_b128 v[82:85], v30 offset:4096
    v_mfma_f32_16x16x32_bf16 a[80:83], v[94:97], v[54:57], a[80:83]
    v_mfma_f32_16x16x32_bf16 a[108:111], v[94:97], v[58:61], a[108:111]
    s_add_u32 m0, s29, 0
    s_nop 0
    buffer_load_dwordx4 v10, s[12:15], s31 offen lds
    v_mfma_f32_16x16x32_bf16 v[112:115], v[94:97], v[62:65], v[112:115]
    s_add_u32 m0, s29, 1024
    s_nop 0
    buffer_load_dwordx4 v11, s[12:15], s31 offen lds
    s_add_u32 m0, s29, 2048
    s_nop 0
    buffer_load_dwordx4 v12, s[12:15], s31 offen lds
    s_add_u32 m0, s29, 3072
    s_nop 0
    buffer_load_dwordx4 v13, s[12:15], s31 offen lds
    s_add_u32 m0, s29, 4096
    s_mov_b32 exec_hi, 0
    buffer_load_dwordx4 v14, s[12:15], s31 offen lds
    s_mov_b32 exec_hi, -1
    s_add_u32 s31, s31, s34
    ds_read_b64_tr_b16 v[94:95], v26
    ds_read_b64_tr_b16 v[96:97], v26 offset:2304
    s_waitcnt lgkmcnt(2)
    v_mfma_f32_16x16x32_bf16 a[0:3], v[98:101], v[66:69], a[0:3]
    v_mfma_f32_16x16x32_bf16 a[28:31], v[98:101], v[70:73], a[28:31]
    v_mfma_f32_16x16x32_bf16 a[56:59], v[98:101], v[74:77], a[56:59]
    v_mfma_f32_16x16x32_bf16 a[84:87], v[98:101], v[78:81], a[84:87]
    v_mfma_f32_16x16x32_bf16 a[112:115], v[98:101], v[82:85], a[112:115]
    ds_read_b64_tr_b16 v[98:99], v27
    ds_read_b64_tr_b16 v[100:101], v27 offset:2304
    v_mfma_f32_16x16x32_bf16 a[4:7], v[86:89], v[66:69], a[4:7]
    v_mfma_f32_16x16x32_bf16 a[32:35], v[86:89], v[70:73], a[32:35]
    v_mfma_f32_16x16x32_bf16 a[60:63], v[86:89], v[74:77], a[60:63]
    v_mfma_f32_16x16x32_bf16 a[88:91], v[86:89], v[78:81], a[88:91]
    v_mfma_f32_16x16x32_bf16 a[116:119], v[86:89], v[82:85], a[116:119]
    ds_read_b64_tr_b16 v[86:87], v28
    ds_read_b64_tr_b16 v[88:89], v28 offset:2304
    v_mfma_f32_16x16x32_bf16 a[8:11], v[90:93], v[66:69], a[8:11]
    v_mfma_f32_16x16x32_bf16 a[36:39], v[90:93], v[70:73], a[36:39]
    v_mfma_f32_16x16x32_bf16 a[64:67], v[90:93], v[74:77], a[64:67]
    v_mfma_f32_16x16x32_bf16 a[92:95], v[90:93], v[78:81], a[92:95]
    v_mfma_f32_16x16x32_bf16 a[120:123], v[90:93], v[82:85], a[120:123]
    ds_read_b64_tr_b16 v[90:91], v29
    ds_read_b64_tr_b16 v[92:93], v29 offset:2304
    s_waitcnt lgkmcnt(6)
    v_mfma_f32_16x16x32_bf16 a[12:15], v[94:97], v[66:69], a[12:15]
    v_mfma_f32_16x16x32_bf16 a[40:43], v[94:97], v[70:73], a[40:43]
    v_mfma_f32_16x16x32_bf16 a[68:71], v[94:97], v[74:77], a[68:71]
    v_mfma_f32_16x16x32_bf16 a[96:99], v[94:97], v[78:81], a[96:99]
    v_mfma_f32_16x16x32_bf16 a[124:127], v[94:97], v[82:85], a[124:127]
    s_waitcnt lgkmcnt(0)
    s_waitcnt vmcnt(10)
    s_barrier
    v_add_u32 v30, 101376, v45
    v_add_u32 v23, 73728, v15
    v_add_u32 v24, 73728, v16
    v_add_u32 v25, 73728, v17
    v_add_u32 v26, 73728, v18
    v_add_u32 v27, 73728, v19
    v_add_u32 v28, 73728, v20
    v_add_u32 v29, 73728, v21
    ds_read_b64_tr_b16 v[94:95], v23
    ds_read_b64_tr_b16 v[96:97], v23 offset:2304
    v_mfma_f32_16x16x32_bf16 a[16:19], v[98:101], v[66:69], a[16:19]
    v_mfma_f32_16x16x32_bf16 a[44:47], v[98:101], v[70:73], a[44:47]
    ds_read_b128 v[46:49], v30 offset:0
    v_mfma_f32_16x16x32_bf16 a[72:75], v[98:101], v[74:77], a[72:75]
    v_mfma_f32_16x16x32_bf16 a[100:103], v[98:101], v[78:81], a[100:103]
    ds_read_b128 v[50:53], v30 offset:1024
    v_mfma_f32_16x16x32_bf16 v[104:107], v[98:101], v[82:85], v[104:107]
    ds_read_b64_tr_b16 v[98:99], v24
    ds_read_b64_tr_b16 v[100:101], v24 offset:2304
    v_mfma_f32_16x16x32_bf16 a[20:23], v[86:89], v[66:69], a[20:23]
    v_mfma_f32_16x16x32_bf16 a[48:51], v[86:89], v[70:73], a[48:51]
    ds_read_b128 v[54:57], v30 offset:2048
    v_mfma_f32_16x16x32_bf16 a[76:79], v[86:89], v[74:77], a[76:79]
    v_mfma_f32_16x16x32_bf16 a[104:107], v[86:89], v[78:81], a[104:107]
    ds_read_b128 v[58:61], v30 offset:3072
    v_mfma_f32_16x16x32_bf16 v[108:111], v[86:89], v[82:85], v[108:111]
    ds_read_b64_tr_b16 v[86:87], v25
    ds_read_b64_tr_b16 v[88:89], v25 offset:2304
    v_mfma_f32_16x16x32_bf16 a[24:27], v[90:93], v[66:69], a[24:27]
    v_mfma_f32_16x16x32_bf16 a[52:55], v[90:93], v[70:73], a[52:55]
    ds_read_b128 v[62:65], v30 offset:4096
    v_mfma_f32_16x16x32_bf16 a[80:83], v[90:93], v[74:77], a[80:83]
    v_mfma_f32_16x16x32_bf16 a[108:111], v[90:93], v[78:81], a[108:111]
    s_add_u32 m0, s29, 36864
    s_nop 0
    buffer_load_dwordx4 v10, s[12:15], s31 offen lds
    v_mfma_f32_16x16x32_bf16 v[112:115], v[90:93], v[82:85], v[112:115]
    s_add_u32 m0, s29, 37888
    s_nop 0
    buffer_load_dwordx4 v11, s[12:15], s31 offen lds
    s_add_u32 m0, s29, 38912
    s_nop 0
    buffer_load_dwordx4 v12, s[12:15], s31 offen lds
    s_add_u32 m0, s29, 39936
    s_nop 0
    buffer_load_dwordx4 v13, s[12:15], s31 offen lds
    s_add_u32 m0, s29, 40960
    s_mov_b32 exec_hi, 0
    buffer_load_dwordx4 v14, s[12:15], s31 offen lds
    s_mov_b32 exec_hi, -1
    s_add_u32 s31, s31, s34
    ds_read_b64_tr_b16 v[90:91], v26
    ds_read_b64_tr_b16 v[92:93], v26 offset:2304
    s_waitcnt lgkmcnt(2)
    v_mfma_f32_16x16x32_bf16 a[0:3], v[94:97], v[46:49], a[0:3]
    v_mfma_f32_16x16x32_bf16 a[28:31], v[94:97], v[50:53], a[28:31]
    v_mfma_f32_16x16x32_bf16 a[56:59], v[94:97], v[54:57], a[56:59]
    v_mfma_f32_16x16x32_bf16 a[84:87], v[94:97], v[58:61], a[84:87]
    v_mfma_f32_16x16x32_bf16 a[112:115], v[94:97], v[62:65], a[112:115]
    ds_read_b64_tr_b16 v[94:95], v27
    ds_read_b64_tr_b16 v[96:97], v27 offset:2304
    v_mfma_f32_16x16x32_bf16 a[4:7], v[98:101], v[46:49], a[4:7]
    v_mfma_f32_16x16x32_bf16 a[32:35], v[98:101], v[50:53], a[32:35]
    v_mfma_f32_16x16x32_bf16 a[60:63], v[98:101], v[54:57], a[60:63]
    v_mfma_f32_16x16x32_bf16 a[88:91], v[98:101], v[58:61], a[88:91]
    v_mfma_f32_16x16x32_bf16 a[116:119], v[98:101], v[62:65], a[116:119]
    ds_read_b64_tr_b16 v[98:99], v28
    ds_read_b64_tr_b16 v[100:101], v28 offset:2304
    v_mfma_f32_16x16x32_bf16 a[8:11], v[86:89], v[46:49], a[8:11]
    v_mfma_f32_16x16x32_bf16 a[36:39], v[86:89], v[50:53], a[36:39]
    v_mfma_f32_16x16x32_bf16 a[64:67], v[86:89], v[54:57], a[64:67]
    v_mfma_f32_16x16x32_bf16 a[92:95], v[86:89], v[58:61], a[92:95]
    v_mfma_f32_16x16x32_bf16 a[120:123], v[86:89], v[62:65], a[120:123]
    ds_read_b64_tr_b16 v[86:87], v29
    ds_read_b64_tr_b16 v[88:89], v29 offset:2304
    s_waitcnt lgkmcnt(6)
    v_mfma_f32_16x16x32_bf16 a[12:15], v[90:93], v[46:49], a[12:15]
    v_mfma_f32_16x16x32_bf16 a[40:43], v[90:93], v[50:53], a[40:43]
    v_mfma_f32_16x16x32_bf16 a[68:71], v[90:93], v[54:57], a[68:71]
    v_mfma_f32_16x16x32_bf16 a[96:99], v[90:93], v[58:61], a[96:99]
    v_mfma_f32_16x16x32_bf16 a[124:127], v[90:93], v[62:65], a[124:127]
    s_waitcnt lgkmcnt(0)
    s_waitcnt vmcnt(10)
    s_barrier
    v_add_u32 v30, 138240, v45
    v_add_u32 v23, 110592, v15
    v_add_u32 v24, 110592, v16
    v_add_u32 v25, 110592, v17
    v_add_u32 v26, 110592, v18
    v_add_u32 v27, 110592, v19
    v_add_u32 v28, 110592, v20
    v_add_u32 v29, 110592, v21
    ds_read_b64_tr_b16 v[90:91], v23
    ds_read_b64_tr_b16 v[92:93], v23 offset:2304
    v_mfma_f32_16x16x32_bf16 a[16:19], v[94:97], v[46:49], a[16:19]
    v_mfma_f32_16x16x32_bf16 a[44:47], v[94:97], v[50:53], a[44:47]
    ds_read_b128 v[66:69], v30 offset:0
    v_mfma_f32_16x16x32_bf16 a[72:75], v[94:97], v[54:57], a[72:75]
    v_mfma_f32_16x16x32_bf16 a[100:103], v[94:97], v[58:61], a[100:103]
    ds_read_b128 v[70:73], v30 offset:1024
    v_mfma_f32_16x16x32_bf16 v[104:107], v[94:97], v[62:65], v[104:107]
    ds_read_b64_tr_b16 v[94:95], v24
    ds_read_b64_tr_b16 v[96:97], v24 offset:2304
    v_mfma_f32_16x16x32_bf16 a[20:23], v[98:101], v[46:49], a[20:23]
    v_mfma_f32_16x16x32_bf16 a[48:51], v[98:101], v[50:53], a[48:51]
    ds_read_b128 v[74:77], v30 offset:2048
    v_mfma_f32_16x16x32_bf16 a[76:79], v[98:101], v[54:57], a[76:79]
    v_mfma_f32_16x16x32_bf16 a[104:107], v[98:101], v[58:61], a[104:107]
    ds_read_b128 v[78:81], v30 offset:3072
    v_mfma_f32_16x16x32_bf16 v[108:111], v[98:101], v[62:65], v[108:111]
    ds_read_b64_tr_b16 v[98:99], v25
    ds_read_b64_tr_b16 v[100:101], v25 offset:2304
    v_mfma_f32_16x16x32_bf16 a[24:27], v[86:89], v[46:49], a[24:27]
    v_mfma_f32_16x16x32_bf16 a[52:55], v[86:89], v[50:53], a[52:55]
    ds_read_b128 v[82:85], v30 offset:4096
    v_mfma_f32_16x16x32_bf16 a[80:83], v[86:89], v[54:57], a[80:83]
    v_mfma_f32_16x16x32_bf16 a[108:111], v[86:89], v[58:61], a[108:111]
    v_mfma_f32_16x16x32_bf16 v[112:115], v[86:89], v[62:65], v[112:115]
    ds_read_b64_tr_b16 v[86:87], v26
    ds_read_b64_tr_b16 v[88:89], v26 offset:2304
    s_waitcnt lgkmcnt(2)
    v_mfma_f32_16x16x32_bf16 a[0:3], v[90:93], v[66:69], a[0:3]
    v_mfma_f32_16x16x32_bf16 a[28:31], v[90:93], v[70:73], a[28:31]
    v_mfma_f32_16x16x32_bf16 a[56:59], v[90:93], v[74:77], a[56:59]
    v_mfma_f32_16x16x32_bf16 a[84:87], v[90:93], v[78:81], a[84:87]
    v_mfma_f32_16x16x32_bf16 a[112:115], v[90:93], v[82:85], a[112:115]
    ds_read_b64_tr_b16 v[90:91], v27
    ds_read_b64_tr_b16 v[92:93], v27 offset:2304
    v_mfma_f32_16x16x32_bf16 a[4:7], v[94:97], v[66:69], a[4:7]
    v_mfma_f32_16x16x32_bf16 a[32:35], v[94:97], v[70:73], a[32:35]
    v_mfma_f32_16x16x32_bf16 a[60:63], v[94:97], v[74:77], a[60:63]
    v_mfma_f32_16x16x32_bf16 a[88:91], v[94:97], v[78:81], a[88:91]
    v_mfma_f32_16x16x32_bf16 a[116:119], v[94:97], v[82:85], a[116:119]
    ds_read_b64_tr_b16 v[94:95], v28
    ds_read_b64_tr_b16 v[96:97], v28 offset:2304
    v_mfma_f32_16x16x32_bf16 a[8:11], v[98:101], v[66:69], a[8:11]
    v_mfma_f32_16x16x32_bf16 a[36:39], v[98:101], v[70:73], a[36:39]
    v_mfma_f32_16x16x32_bf16 a[64:67], v[98:101], v[74:77], a[64:67]
    v_mfma_f32_16x16x32_bf16 a[92:95], v[98:101], v[78:81], a[92:95]
    v_mfma_f32_16x16x32_bf16 a[120:123], v[98:101], v[82:85], a[120:123]
    ds_read_b64_tr_b16 v[98:99], v29
    ds_read_b64_tr_b16 v[100:101], v29 offset:2304
    s_waitcnt lgkmcnt(6)
    v_mfma_f32_16x16x32_bf16 a[12:15], v[86:89], v[66:69], a[12:15]
    v_mfma_f32_16x16x32_bf16 a[40:43], v[86:89], v[70:73], a[40:43]
    v_mfma_f32_16x16x32_bf16 a[68:71], v[86:89], v[74:77], a[68:71]
    v_mfma_f32_16x16x32_bf16 a[96:99], v[86:89], v[78:81], a[96:99]
    v_mfma_f32_16x16x32_bf16 a[124:127], v[86:89], v[82:85], a[124:127]
    s_waitcnt lgkmcnt(0)
    s_waitcnt vmcnt(5)
    s_barrier
    v_add_u32 v30, 27648, v45
    v_add_u32 v23, 0, v15
    v_add_u32 v24, 0, v16
    v_add_u32 v25, 0, v17
    v_add_u32 v26, 0, v18
    v_add_u32 v27, 0, v19
    v_add_u32 v28, 0, v20
    v_add_u32 v29, 0, v21
    ds_read_b64_tr_b16 v[86:87], v23
    ds_read_b64_tr_b16 v[88:89], v23 offset:2304
    v_mfma_f32_16x16x32_bf16 a[16:19], v[90:93], v[66:69], a[16:19]
    v_mfma_f32_16x16x32_bf16 a[44:47], v[90:93], v[70:73], a[44:47]
    ds_read_b128 v[46:49], v30 offset:0
    v_mfma_f32_16x16x32_bf16 a[72:75], v[90:93], v[74:77], a[72:75]
    v_mfma_f32_16x16x32_bf16 a[100:103], v[90:93], v[78:81], a[100:103]
    ds_read_b128 v[50:53], v30 offset:1024
    v_mfma_f32_16x16x32_bf16 v[104:107], v[90:93], v[82:85], v[104:107]
    ds_read_b64_tr_b16 v[90:91], v24
    ds_read_b64_tr_b16 v[92:93], v24 offset:2304
    v_mfma_f32_16x16x32_bf16 a[20:23], v[94:97], v[66:69], a[20:23]
    v_mfma_f32_16x16x32_bf16 a[48:51], v[94:97], v[70:73], a[48:51]
    ds_read_b128 v[54:57], v30 offset:2048
    v_mfma_f32_16x16x32_bf16 a[76:79], v[94:97], v[74:77], a[76:79]
    v_mfma_f32_16x16x32_bf16 a[104:107], v[94:97], v[78:81], a[104:107]
    ds_read_b128 v[58:61], v30 offset:3072
    v_mfma_f32_16x16x32_bf16 v[108:111], v[94:97], v[82:85], v[108:111]
    ds_read_b64_tr_b16 v[94:95], v25
    ds_read_b64_tr_b16 v[96:97], v25 offset:2304
    v_mfma_f32_16x16x32_bf16 a[24:27], v[98:101], v[66:69], a[24:27]
    v_mfma_f32_16x16x32_bf16 a[52:55], v[98:101], v[70:73], a[52:55]
    ds_read_b128 v[62:65], v30 offset:4096
    v_mfma_f32_16x16x32_bf16 a[80:83], v[98:101], v[74:77], a[80:83]
    v_mfma_f32_16x16x32_bf16 a[108:111], v[98:101], v[78:81], a[108:111]
    v_mfma_f32_16x16x32_bf16 v[112:115], v[98:101], v[82:85], v[112:115]
    ds_read_b64_tr_b16 v[98:99], v26
    ds_read_b64_tr_b16 v[100:101], v26 offset:2304
    s_waitcnt lgkmcnt(2)
    v_mfma_f32_16x16x32_bf16 a[0:3], v[86:89], v[46:49], a[0:3]
    v_mfma_f32_16x16x32_bf16 a[28:31], v[86:89], v[50:53], a[28:31]
    v_mfma_f32_16x16x32_bf16 a[56:59], v[86:89], v[54:57], a[56:59]
    v_mfma_f32_16x16x32_bf16 a[84:87], v[86:89], v[58:61], a[84:87]
    v_mfma_f32_16x16x32_bf16 a[112:115], v[86:89], v[62:65], a[112:115]
    ds_read_b64_tr_b16 v[86:87], v27
    ds_read_b64_tr_b16 v[88:89], v27 offset:2304
    v_mfma_f32_16x16x32_bf16 a[4:7], v[90:93], v[46:49], a[4:7]
    v_mfma_f32_16x16x32_bf16 a[32:35], v[90:93], v[50:53], a[32:35]
    v_mfma_f32_16x16x32_bf16 a[60:63], v[90:93], v[54:57], a[60:63]
    v_mfma_f32_16x16x32_bf16 a[88:91], v[90:93], v[58:61], a[88:91]
    v_mfma_f32_16x16x32_bf16 a[116:119], v[90:93], v[62:65], a[116:119]
    ds_read_b64_tr_b16 v[90:91], v28
    ds_read_b64_tr_b16 v[92:93], v28 offset:2304
    v_mfma_f32_16x16x32_bf16 a[8:11], v[94:97], v[46:49], a[8:11]
    v_mfma_f32_16x16x32_bf16 a[36:39], v[94:97], v[50:53], a[36:39]
    v_mfma_f32_16x16x32_bf16 a[64:67], v[94:97], v[54:57], a[64:67]
    v_mfma_f32_16x16x32_bf16 a[92:95], v[94:97], v[58:61], a[92:95]
    v_mfma_f32_16x16x32_bf16 a[120:123], v[94:97], v[62:65], a[120:123]
    ds_read_b64_tr_b16 v[94:95], v29
    ds_read_b64_tr_b16 v[96:97], v29 offset:2304
    s_waitcnt lgkmcnt(6)
    v_mfma_f32_16x16x32_bf16 a[12:15], v[98:101], v[46:49], a[12:15]
    v_mfma_f32_16x16x32_bf16 a[40:43], v[98:101], v[50:53], a[40:43]
    v_mfma_f32_16x16x32_bf16 a[68:71], v[98:101], v[54:57], a[68:71]
    v_mfma_f32_16x16x32_bf16 a[96:99], v[98:101], v[58:61], a[96:99]
    v_mfma_f32_16x16x32_bf16 a[124:127], v[98:101], v[62:65], a[124:127]
    s_waitcnt lgkmcnt(0)
    s_waitcnt vmcnt(0)
    s_barrier
    v_add_u32 v30, 64512, v45
    v_add_u32 v23, 36864, v15
    v_add_u32 v24, 36864, v16
    v_add_u32 v25, 36864, v17
    v_add_u32 v26, 36864, v18
    v_add_u32 v27, 36864, v19
    v_add_u32 v28, 36864, v20
    v_add_u32 v29, 36864, v21
    ds_read_b64_tr_b16 v[98:99], v23
    ds_read_b64_tr_b16 v[100:101], v23 offset:2304
    v_mfma_f32_16x16x32_bf16 a[16:19], v[86:89], v[46:49], a[16:19]
    v_mfma_f32_16x16x32_bf16 a[44:47], v[86:89], v[50:53], a[44:47]
    ds_read_b128 v[66:69], v30 offset:0
    v_mfma_f32_16x16x32_bf16 a[72:75], v[86:89], v[54:57], a[72:75]
    v_mfma_f32_16x16x32_bf16 a[100:103], v[86:89], v[58:61], a[100:103]
    ds_read_b128 v[70:73], v30 offset:1024
    v_mfma_f32_16x16x32_bf16 v[104:107], v[86:89], v[62:65], v[104:107]
    ds_read_b64_tr_b16 v[86:87], v24
    ds_read_b64_tr_b16 v[88:89], v24 offset:2304
    v_mfma_f32_16x16x32_bf16 a[20:23], v[90:93], v[46:49], a[20:23]
    v_mfma_f32_16x16x32_bf16 a[48:51], v[90:93], v[50:53], a[48:51]
    ds_read_b128 v[74:77], v30 offset:2048
    v_mfma_f32_16x16x32_bf16 a[76:79], v[90:93], v[54:57], a[76:79]
    v_mfma_f32_16x16x32_bf16 a[104:107], v[90:93], v[58:61], a[104:107]
    ds_read_b128 v[78:81], v30 offset:3072
    v_mfma_f32_16x16x32_bf16 v[108:111], v[90:93], v[62:65], v[108:111]
    ds_read_b64_tr_b16 v[90:91], v25
    ds_read_b64_tr_b16 v[92:93], v25 offset:2304
    v_mfma_f32_16x16x32_bf16 a[24:27], v[94:97], v[46:49], a[24:27]
    v_mfma_f32_16x16x32_bf16 a[52:55], v[94:97], v[50:53], a[52:55]
    ds_read_b128 v[82:85], v30 offset:4096
    v_mfma_f32_16x16x32_bf16 a[80:83], v[94:97], v[54:57], a[80:83]
    v_mfma_f32_16x16x32_bf16 a[108:111], v[94:97], v[58:61], a[108:111]
    v_mfma_f32_16x16x32_bf16 v[112:115], v[94:97], v[62:65], v[112:115]
    ds_read_b64_tr_b16 v[94:95], v26
    ds_read_b64_tr_b16 v[96:97], v26 offset:2304
    s_waitcnt lgkmcnt(2)
    v_mfma_f32_16x16x32_bf16 a[0:3], v[98:101], v[66:69], a[0:3]
    v_mfma_f32_16x16x32_bf16 a[28:31], v[98:101], v[70:73], a[28:31]
    v_mfma_f32_16x16x32_bf16 a[56:59], v[98:101], v[74:77], a[56:59]
    v_mfma_f32_16x16x32_bf16 a[84:87], v[98:101], v[78:81], a[84:87]
    v_mfma_f32_16x16x32_bf16 a[112:115], v[98:101], v[82:85], a[112:115]
    ds_read_b64_tr_b16 v[98:99], v27
    ds_read_b64_tr_b16 v[100:101], v27 offset:2304
    v_mfma_f32_16x16x32_bf16 a[4:7], v[86:89], v[66:69], a[4:7]
    v_mfma_f32_16x16x32_bf16 a[32:35], v[86:89], v[70:73], a[32:35]
    v_mfma_f32_16x16x32_bf16 a[60:63], v[86:89], v[74:77], a[60:63]
    v_mfma_f32_16x16x32_bf16 a[88:91], v[86:89], v[78:81], a[88:91]
    v_mfma_f32_16x16x32_bf16 a[116:119], v[86:89], v[82:85], a[116:119]
    ds_read_b64_tr_b16 v[86:87], v28
    ds_read_b64_tr_b16 v[88:89], v28 offset:2304
    v_mfma_f32_16x16x32_bf16 a[8:11], v[90:93], v[66:69], a[8:11]
    v_mfma_f32_16x16x32_bf16 a[36:39], v[90:93], v[70:73], a[36:39]
    v_mfma_f32_16x16x32_bf16 a[64:67], v[90:93], v[74:77], a[64:67]
    v_mfma_f32_16x16x32_bf16 a[92:95], v[90:93], v[78:81], a[92:95]
    v_mfma_f32_16x16x32_bf16 a[120:123], v[90:93], v[82:85], a[120:123]
    ds_read_b64_tr_b16 v[90:91], v29
    ds_read_b64_tr_b16 v[92:93], v29 offset:2304
    s_waitcnt lgkmcnt(6)
    v_mfma_f32_16x16x32_bf16 a[12:15], v[94:97], v[66:69], a[12:15]
    v_mfma_f32_16x16x32_bf16 a[40:43], v[94:97], v[70:73], a[40:43]
    v_mfma_f32_16x16x32_bf16 a[68:71], v[94:97], v[74:77], a[68:71]
    v_mfma_f32_16x16x32_bf16 a[96:99], v[94:97], v[78:81], a[96:99]
    v_mfma_f32_16x16x32_bf16 a[124:127], v[94:97], v[82:85], a[124:127]
    s_waitcnt lgkmcnt(4)
    v_mfma_f32_16x16x32_bf16 a[16:19], v[98:101], v[66:69], a[16:19]
    v_mfma_f32_16x16x32_bf16 a[44:47], v[98:101], v[70:73], a[44:47]
    v_mfma_f32_16x16x32_bf16 a[72:75], v[98:101], v[74:77], a[72:75]
    v_mfma_f32_16x16x32_bf16 a[100:103], v[98:101], v[78:81], a[100:103]
    v_mfma_f32_16x16x32_bf16 v[104:107], v[98:101], v[82:85], v[104:107]
    s_waitcnt lgkmcnt(2)
    v_mfma_f32_16x16x32_bf16 a[20:23], v[86:89], v[66:69], a[20:23]
    v_mfma_f32_16x16x32_bf16 a[48:51], v[86:89], v[70:73], a[48:51]
    v_mfma_f32_16x16x32_bf16 a[76:79], v[86:89], v[74:77], a[76:79]
    v_mfma_f32_16x16x32_bf16 a[104:107], v[86:89], v[78:81], a[104:107]
    v_mfma_f32_16x16x32_bf16 v[108:111], v[86:89], v[82:85], v[108:111]
    s_waitcnt lgkmcnt(0)
    v_mfma_f32_16x16x32_bf16 a[24:27], v[90:93], v[66:69], a[24:27]
    v_mfma_f32_16x16x32_bf16 a[52:55], v[90:93], v[70:73], a[52:55]
    v_mfma_f32_16x16x32_bf16 a[80:83], v[90:93], v[74:77], a[80:83]
    v_mfma_f32_16x16x32_bf16 a[108:111], v[90:93], v[78:81], a[108:111]
    v_mfma_f32_16x16x32_bf16 v[112:115], v[90:93], v[82:85], v[112:115]
    s_waitcnt vmcnt(0) lgkmcnt(0)
    s_nop 7
    s_barrier
    v_accvgpr_read_b32 v46, a0
    v_accvgpr_read_b32 v47, a1
    v_accvgpr_read_b32 v48, a2
    v_accvgpr_read_b32 v49, a3
    v_cvt_pk_bf16_f32 v50, v46, v47
    v_cvt_pk_bf16_f32 v51, v48, v49
    ds_write_b32 v31, v50 offset:0
    ds_write_b32 v32, v51 offset:0
    v_accvgpr_read_b32 v52, a4
    v_accvgpr_read_b32 v53, a5
    v_accvgpr_read_b32 v54, a6
    v_accvgpr_read_b32 v55, a7
    v_cvt_pk_bf16_f32 v56, v52, v53
    v_cvt_pk_bf16_f32 v57, v54, v55
    ds_write_b32 v33, v56 offset:0
    ds_write_b32 v34, v57 offset:0
    v_accvgpr_read_b32 v58, a8
    v_accvgpr_read_b32 v59, a9
    v_accvgpr_read_b32 v60, a10
    v_accvgpr_read_b32 v61, a11
    v_cvt_pk_bf16_f32 v62, v58, v59
    v_cvt_pk_bf16_f32 v63, v60, v61
    ds_write_b32 v35, v62 offset:0
    ds_write_b32 v36, v63 offset:0
    v_accvgpr_read_b32 v64, a12
    v_accvgpr_read_b32 v65, a13
    v_accvgpr_read_b32 v66, a14
    v_accvgpr_read_b32 v67, a15
    v_cvt_pk_bf16_f32 v68, v64, v65
    v_cvt_pk_bf16_f32 v69, v66, v67
    ds_write_b32 v37, v68 offset:0
    ds_write_b32 v38, v69 offset:0
    v_accvgpr_read_b32 v70, a16
    v_accvgpr_read_b32 v71, a17
    v_accvgpr_read_b32 v72, a18
    v_accvgpr_read_b32 v73, a19
    v_cvt_pk_bf16_f32 v74, v70, v71
    v_cvt_pk_bf16_f32 v75, v72, v73
    ds_write_b32 v39, v74 offset:0
    ds_write_b32 v40, v75 offset:0
    v_accvgpr_read_b32 v76, a20
    v_accvgpr_read_b32 v77, a21
    v_accvgpr_read_b32 v78, a22
    v_accvgpr_read_b32 v79, a23
    v_cvt_pk_bf16_f32 v80, v76, v77
    v_cvt_pk_bf16_f32 v81, v78, v79
    ds_write_b32 v41, v80 offset:0
    ds_write_b32 v42, v81 offset:0
    v_accvgpr_read_b32 v82, a24
    v_accvgpr_read_b32 v83, a25
    v_accvgpr_read_b32 v84, a26
    v_accvgpr_read_b32 v85, a27
    v_cvt_pk_bf16_f32 v86, v82, v83
    v_cvt_pk_bf16_f32 v87, v84, v85
    ds_write_b32 v43, v86 offset:0
    ds_write_b32 v44, v87 offset:0
    v_accvgpr_read_b32 v88, a28
    v_accvgpr_read_b32 v89, a29
    v_accvgpr_read_b32 v90, a30
    v_accvgpr_read_b32 v91, a31
    v_cvt_pk_bf16_f32 v92, v88, v89
    v_cvt_pk_bf16_f32 v93, v90, v91
    ds_write_b32 v31, v92 offset:15488
    ds_write_b32 v32, v93 offset:15488
    v_accvgpr_read_b32 v46, a32
    v_accvgpr_read_b32 v47, a33
    v_accvgpr_read_b32 v48, a34
    v_accvgpr_read_b32 v49, a35
    v_cvt_pk_bf16_f32 v50, v46, v47
    v_cvt_pk_bf16_f32 v51, v48, v49
    ds_write_b32 v33, v50 offset:15488
    ds_write_b32 v34, v51 offset:15488
    v_accvgpr_read_b32 v52, a36
    v_accvgpr_read_b32 v53, a37
    v_accvgpr_read_b32 v54, a38
    v_accvgpr_read_b32 v55, a39
    v_cvt_pk_bf16_f32 v56, v52, v53
    v_cvt_pk_bf16_f32 v57, v54, v55
    ds_write_b32 v35, v56 offset:15488
    ds_write_b32 v36, v57 offset:15488
    v_accvgpr_read_b32 v58, a40
    v_accvgpr_read_b32 v59, a41
    v_accvgpr_read_b32 v60, a42
    v_accvgpr_read_b32 v61, a43
    v_cvt_pk_bf16_f32 v62, v58, v59
    v_cvt_pk_bf16_f32 v63, v60, v61
    ds_write_b32 v37, v62 offset:15488
    ds_write_b32 v38, v63 offset:15488
    v_accvgpr_read_b32 v64, a44
    v_accvgpr_read_b32 v65, a45
    v_accvgpr_read_b32 v66, a46
    v_accvgpr_read_b32 v67, a47
    v_cvt_pk_bf16_f32 v68, v64, v65
    v_cvt_pk_bf16_f32 v69, v66, v67
    ds_write_b32 v39, v68 offset:15488
    ds_write_b32 v40, v69 offset:15488
    v_accvgpr_read_b32 v70, a48
    v_accvgpr_read_b32 v71, a49
    v_accvgpr_read_b32 v72, a50
    v_accvgpr_read_b32 v73, a51
    v_cvt_pk_bf16_f32 v74, v70, v71
    v_cvt_pk_bf16_f32 v75, v72, v73
    ds_write_b32 v41, v74 offset:15488
    ds_write_b32 v42, v75 offset:15488
    v_accvgpr_read_b32 v76, a52
    v_accvgpr_read_b32 v77, a53
    v_accvgpr_read_b32 v78, a54
    v_accvgpr_read_b32 v79, a55
    v_cvt_pk_bf16_f32 v80, v76, v77
    v_cvt_pk_bf16_f32 v81, v78, v79
    ds_write_b32 v43, v80 offset:15488
    ds_write_b32 v44, v81 offset:15488
    v_accvgpr_read_b32 v82, a56
    v_accvgpr_read_b32 v83, a57
    v_accvgpr_read_b32 v84, a58
    v_accvgpr_read_b32 v85, a59
    v_cvt_pk_bf16_f32 v86, v82, v83
    v_cvt_pk_bf16_f32 v87, v84, v85
    ds_write_b32 v31, v86 offset:30976
    ds_write_b32 v32, v87 offset:30976
    v_accvgpr_read_b32 v88, a60
    v_accvgpr_read_b32 v89, a61
    v_accvgpr_read_b32 v90, a62
    v_accvgpr_read_b32 v91, a63
    v_cvt_pk_bf16_f32 v92, v88, v89
    v_cvt_pk_bf16_f32 v93, v90, v91
    ds_write_b32 v33, v92 offset:30976
    ds_write_b32 v34, v93 offset:30976
    v_accvgpr_read_b32 v46, a64
    v_accvgpr_read_b32 v47, a65
    v_accvgpr_read_b32 v48, a66
    v_accvgpr_read_b32 v49, a67
    v_cvt_pk_bf16_f32 v50, v46, v47
    v_cvt_pk_bf16_f32 v51, v48, v49
    ds_write_b32 v35, v50 offset:30976
    ds_write_b32 v36, v51 offset:30976
    v_accvgpr_read_b32 v52, a68
    v_accvgpr_read_b32 v53, a69
    v_accvgpr_read_b32 v54, a70
    v_accvgpr_read_b32 v55, a71
    v_cvt_pk_bf16_f32 v56, v52, v53
    v_cvt_pk_bf16_f32 v57, v54, v55
    ds_write_b32 v37, v56 offset:30976
    ds_write_b32 v38, v57 offset:30976
    v_accvgpr_read_b32 v58, a72
    v_accvgpr_read_b32 v59, a73
    v_accvgpr_read_b32 v60, a74
    v_accvgpr_read_b32 v61, a75
    v_cvt_pk_bf16_f32 v62, v58, v59
    v_cvt_pk_bf16_f32 v63, v60, v61
    ds_write_b32 v39, v62 offset:30976
    ds_write_b32 v40, v63 offset:30976
    v_accvgpr_read_b32 v64, a76
    v_accvgpr_read_b32 v65, a77
    v_accvgpr_read_b32 v66, a78
    v_accvgpr_read_b32 v67, a79
    v_cvt_pk_bf16_f32 v68, v64, v65
    v_cvt_pk_bf16_f32 v69, v66, v67
    ds_write_b32 v41, v68 offset:30976
    ds_write_b32 v42, v69 offset:30976
    v_accvgpr_read_b32 v70, a80
    v_accvgpr_read_b32 v71, a81
    v_accvgpr_read_b32 v72, a82
    v_accvgpr_read_b32 v73, a83
    v_cvt_pk_bf16_f32 v74, v70, v71
    v_cvt_pk_bf16_f32 v75, v72, v73
    ds_write_b32 v43, v74 offset:30976
    ds_write_b32 v44, v75 offset:30976
    v_accvgpr_read_b32 v76, a84
    v_accvgpr_read_b32 v77, a85
    v_accvgpr_read_b32 v78, a86
    v_accvgpr_read_b32 v79, a87
    v_cvt_pk_bf16_f32 v80, v76, v77
    v_cvt_pk_bf16_f32 v81, v78, v79
    ds_write_b32 v31, v80 offset:46464
    ds_write_b32 v32, v81 offset:46464
    v_accvgpr_read_b32 v82, a88
    v_accvgpr_read_b32 v83, a89
    v_accvgpr_read_b32 v84, a90
    v_accvgpr_read_b32 v85, a91
    v_cvt_pk_bf16_f32 v86, v82, v83
    v_cvt_pk_bf16_f32 v87, v84, v85
    ds_write_b32 v33, v86 offset:46464
    ds_write_b32 v34, v87 offset:46464
    v_accvgpr_read_b32 v88, a92
    v_accvgpr_read_b32 v89, a93
    v_accvgpr_read_b32 v90, a94
    v_accvgpr_read_b32 v91, a95
    v_cvt_pk_bf16_f32 v92, v88, v89
    v_cvt_pk_bf16_f32 v93, v90, v91
    ds_write_b32 v35, v92 offset:46464
    ds_write_b32 v36, v93 offset:46464
    v_accvgpr_read_b32 v46, a96
    v_accvgpr_read_b32 v47, a97
    v_accvgpr_read_b32 v48, a98
    v_accvgpr_read_b32 v49, a99
    v_cvt_pk_bf16_f32 v50, v46, v47
    v_cvt_pk_bf16_f32 v51, v48, v49
    ds_write_b32 v37, v50 offset:46464
    ds_write_b32 v38, v51 offset:46464
    v_accvgpr_read_b32 v52, a100
    v_accvgpr_read_b32 v53, a101
    v_accvgpr_read_b32 v54, a102
    v_accvgpr_read_b32 v55, a103
    v_cvt_pk_bf16_f32 v56, v52, v53
    v_cvt_pk_bf16_f32 v57, v54, v55
    ds_write_b32 v39, v56 offset:46464
    ds_write_b32 v40, v57 offset:46464
    v_accvgpr_read_b32 v58, a104
    v_accvgpr_read_b32 v59, a105
    v_accvgpr_read_b32 v60, a106
    v_accvgpr_read_b32 v61, a107
    v_cvt_pk_bf16_f32 v62, v58, v59
    v_cvt_pk_bf16_f32 v63, v60, v61
    ds_write_b32 v41, v62 offset:46464
    ds_write_b32 v42, v63 offset:46464
    v_accvgpr_read_b32 v64, a108
    v_accvgpr_read_b32 v65, a109
    v_accvgpr_read_b32 v66, a110
    v_accvgpr_read_b32 v67, a111
    v_cvt_pk_bf16_f32 v68, v64, v65
    v_cvt_pk_bf16_f32 v69, v66, v67
    ds_write_b32 v43, v68 offset:46464
    ds_write_b32 v44, v69 offset:46464
    v_accvgpr_read_b32 v70, a112
    v_accvgpr_read_b32 v71, a113
    v_accvgpr_read_b32 v72, a114
    v_accvgpr_read_b32 v73, a115
    v_cvt_pk_bf16_f32 v74, v70, v71
    v_cvt_pk_bf16_f32 v75, v72, v73
    ds_write_b32 v31, v74 offset:61952
    ds_write_b32 v32, v75 offset:61952
    v_accvgpr_read_b32 v76, a116
    v_accvgpr_read_b32 v77, a117
    v_accvgpr_read_b32 v78, a118
    v_accvgpr_read_b32 v79, a119
    v_cvt_pk_bf16_f32 v80, v76, v77
    v_cvt_pk_bf16_f32 v81, v78, v79
    ds_write_b32 v33, v80 offset:61952
    ds_write_b32 v34, v81 offset:61952
    v_accvgpr_read_b32 v82, a120
    v_accvgpr_read_b32 v83, a121
    v_accvgpr_read_b32 v84, a122
    v_accvgpr_read_b32 v85, a123
    v_cvt_pk_bf16_f32 v86, v82, v83
    v_cvt_pk_bf16_f32 v87, v84, v85
    ds_write_b32 v35, v86 offset:61952
    ds_write_b32 v36, v87 offset:61952
    v_accvgpr_read_b32 v88, a124
    v_accvgpr_read_b32 v89, a125
    v_accvgpr_read_b32 v90, a126
    v_accvgpr_read_b32 v91, a127
    v_cvt_pk_bf16_f32 v92, v88, v89
    v_cvt_pk_bf16_f32 v93, v90, v91
    ds_write_b32 v37, v92 offset:61952
    ds_write_b32 v38, v93 offset:61952
    v_cvt_pk_bf16_f32 v50, v104, v105
    v_cvt_pk_bf16_f32 v51, v106, v107
    ds_write_b32 v39, v50 offset:61952
    ds_write_b32 v40, v51 offset:61952
    v_cvt_pk_bf16_f32 v56, v108, v109
    v_cvt_pk_bf16_f32 v57, v110, v111
    ds_write_b32 v41, v56 offset:61952
    ds_write_b32 v42, v57 offset:61952
    v_cvt_pk_bf16_f32 v62, v112, v113
    v_cvt_pk_bf16_f32 v63, v114, v115
    ds_write_b32 v43, v62 offset:61952
    ds_write_b32 v44, v63 offset:61952
    s_waitcnt lgkmcnt(0)
    s_barrier
    v_and_b32 v4, 7, v1
    v_lshrrev_b32 v5, 3, v1
    s_lshl_b32 s23, s20, 3
    v_add_u32 v5, s23, v5
    v_and_b32 v6, 1, v5
    v_lshrrev_b32 v5, 1, v5
    v_lshl_add_u32 v5, v5, 2, v6
    v_mul_u32_u24 v2, 968, v5
    v_mul_u32_u24 v6, 40, v4
    v_add_u32 v2, v2, v6
    ds_read_b64 v[10:11], v2 offset:15488
    ds_read_b64 v[12:13], v2 offset:15496
    ds_read_b64 v[14:15], v2 offset:15504
    ds_read_b64 v[16:17], v2 offset:15512
    ds_read_b32 v18, v2 offset:15520
    ds_read_b64 v[20:21], v2 offset:17424
    ds_read_b64 v[22:23], v2 offset:17432
    ds_read_b64 v[24:25], v2 offset:17440
    ds_read_b64 v[26:27], v2 offset:17448
    ds_read_b32 v28, v2 offset:17456
    ds_read_b64 v[30:31], v2 offset:2256
    ds_read_b64 v[32:33], v2 offset:2264
    ds_read_b64 v[34:35], v2 offset:2272
    ds_read_b64 v[36:37], v2 offset:2280
    ds_read_b32 v38, v2 offset:2288
    s_waitcnt lgkmcnt(0)
    ds_read_b64 v[40:41], v2 offset:4192
    ds_read_b64 v[42:43], v2 offset:4200
    ds_read_b64 v[44:45], v2 offset:4208
    ds_read_b64 v[46:47], v2 offset:4216
    ds_read_b32 v48, v2 offset:4224
    v_dot2_f32_bf16 v75, v10, v30, 0
    v_dot2_f32_bf16 v75, v11, v31, v75
    v_dot2_f32_bf16 v75, v12, v32, v75
    v_dot2_f32_bf16 v75, v13, v33, v75
    v_dot2_f32_bf16 v75, v14, v34, v75
    v_dot2_f32_bf16 v75, v15, v35, v75
    v_dot2_f32_bf16 v75, v16, v36, v75
    v_dot2_f32_bf16 v75, v17, v37, v75
    v_dot2_f32_bf16 v75, v18, v38, v75
    s_waitcnt lgkmcnt(0)
    ds_read_b64 v[30:31], v2 offset:6128
    ds_read_b64 v[32:33], v2 offset:6136
    ds_read_b64 v[34:35], v2 offset:6144
    ds_read_b64 v[36:37], v2 offset:6152
    ds_read_b32 v38, v2 offset:6160
    v_dot2_f32_bf16 v74, v10, v40, 0
    v_dot2_f32_bf16 v74, v11, v41, v74
    v_dot2_f32_bf16 v74, v12, v42, v74
    v_dot2_f32_bf16 v74, v13, v43, v74
    v_dot2_f32_bf16 v74, v14, v44, v74
    v_dot2_f32_bf16 v74, v15, v45, v74
    v_dot2_f32_bf16 v74, v16, v46, v74
    v_dot2_f32_bf16 v74, v17, v47, v74
    v_dot2_f32_bf16 v74, v18, v48, v74
    v_dot2_f32_bf16 v83, v20, v40, 0
    v_dot2_f32_bf16 v83, v21, v41, v83
    v_dot2_f32_bf16 v83, v22, v42, v83
    v_dot2_f32_bf16 v83, v23, v43, v83
    v_dot2_f32_bf16 v83, v24, v44, v83
    v_dot2_f32_bf16 v83, v25, v45, v83
    v_dot2_f32_bf16 v83, v26, v46, v83
    v_dot2_f32_bf16 v83, v27, v47, v83
    v_dot2_f32_bf16 v83, v28, v48, v83
    s_waitcnt lgkmcnt(0)
    ds_read_b64 v[40:41], v2 offset:8064
    ds_read_b64 v[42:43], v2 offset:8072
    ds_read_b64 v[44:45], v2 offset:8080
    ds_read_b64 v[46:47], v2 offset:8088
    ds_read_b32 v48, v2 offset:8096
    v_dot2_f32_bf16 v73, v10, v30, 0
    v_dot2_f32_bf16 v73, v11, v31, v73
    v_dot2_f32_bf16 v73, v12, v32, v73
    v_dot2_f32_bf16 v73, v13, v33, v73
    v_dot2_f32_bf16 v73, v14, v34, v73
    v_dot2_f32_bf16 v73, v15, v35, v73
    v_dot2_f32_bf16 v73, v16, v36, v73
    v_dot2_f32_bf16 v73, v17, v37, v73
    v_dot2_f32_bf16 v73, v18, v38, v73
    v_dot2_f32_bf16 v82, v20, v30, 0
    v_dot2_f32_bf16 v82, v21, v31, v82
    v_dot2_f32_bf16 v82, v22, v32, v82
    v_dot2_f32_bf16 v82, v23, v33, v82
    v_dot2_f32_bf16 v82, v24, v34, v82
    v_dot2_f32_bf16 v82, v25, v35, v82
    v_dot2_f32_bf16 v82, v26, v36, v82
    v_dot2_f32_bf16 v82, v27, v37, v82
    v_dot2_f32_bf16 v82, v28, v38, v82
    s_waitcnt lgkmcnt(0)
    ds_read_b64 v[30:31], v2 offset:10000
    ds_read_b64 v[32:33], v2 offset:10008
    ds_read_b64 v[34:35], v2 offset:10016
    ds_read_b64 v[36:37], v2 offset:10024
    ds_read_b32 v38, v2 offset:10032
    v_dot2_f32_bf16 v72, v10, v40, 0
    v_dot2_f32_bf16 v72, v11, v41, v72
    v_dot2_f32_bf16 v72, v12, v42, v72
    v_dot2_f32_bf16 v72, v13, v43, v72
    v_dot2_f32_bf16 v72, v14, v44, v72
    v_dot2_f32_bf16 v72, v15, v45, v72
    v_dot2_f32_bf16 v72, v16, v46, v72
    v_dot2_f32_bf16 v72, v17, v47, v72
    v_dot2_f32_bf16 v72, v18, v48, v72
    v_dot2_f32_bf16 v81, v20, v40, 0
    v_dot2_f32_bf16 v81, v21, v41, v81
    v_dot2_f32_bf16 v81, v22, v42, v81
    v_dot2_f32_bf16 v81, v23, v43, v81
    v_dot2_f32_bf16 v81, v24, v44, v81
    v_dot2_f32_bf16 v81, v25, v45, v81
    v_dot2_f32_bf16 v81, v26, v46, v81
    v_dot2_f32_bf16 v81, v27, v47, v81
    v_dot2_f32_bf16 v81, v28, v48, v81
    s_waitcnt lgkmcnt(0)
    ds_read_b64 v[40:41], v2 offset:11936
    ds_read_b64 v[42:43], v2 offset:11944
    ds_read_b64 v[44:45], v2 offset:11952
    ds_read_b64 v[46:47], v2 offset:11960
    ds_read_b32 v48, v2 offset:11968
    v_dot2_f32_bf16 v71, v10, v30, 0
    v_dot2_f32_bf16 v71, v11, v31, v71
    v_dot2_f32_bf16 v71, v12, v32, v71
    v_dot2_f32_bf16 v71, v13, v33, v71
    v_dot2_f32_bf16 v71, v14, v34, v71
    v_dot2_f32_bf16 v71, v15, v35, v71
    v_dot2_f32_bf16 v71, v16, v36, v71
    v_dot2_f32_bf16 v71, v17, v37, v71
    v_dot2_f32_bf16 v71, v18, v38, v71
    v_dot2_f32_bf16 v80, v20, v30, 0
    v_dot2_f32_bf16 v80, v21, v31, v80
    v_dot2_f32_bf16 v80, v22, v32, v80
    v_dot2_f32_bf16 v80, v23, v33, v80
    v_dot2_f32_bf16 v80, v24, v34, v80
    v_dot2_f32_bf16 v80, v25, v35, v80
    v_dot2_f32_bf16 v80, v26, v36, v80
    v_dot2_f32_bf16 v80, v27, v37, v80
    v_dot2_f32_bf16 v80, v28, v38, v80
    s_waitcnt lgkmcnt(0)
    ds_read_b64 v[30:31], v2 offset:13872
    ds_read_b64 v[32:33], v2 offset:13880
    ds_read_b64 v[34:35], v2 offset:13888
    ds_read_b64 v[36:37], v2 offset:13896
    ds_read_b32 v38, v2 offset:13904
    v_dot2_f32_bf16 v70, v10, v40, 0
    v_dot2_f32_bf16 v70, v11, v41, v70
    v_dot2_f32_bf16 v70, v12, v42, v70
    v_dot2_f32_bf16 v70, v13, v43, v70
    v_dot2_f32_bf16 v70, v14, v44, v70
    v_dot2_f32_bf16 v70, v15, v45, v70
    v_dot2_f32_bf16 v70, v16, v46, v70
    v_dot2_f32_bf16 v70, v17, v47, v70
    v_dot2_f32_bf16 v70, v18, v48, v70
    v_dot2_f32_bf16 v79, v20, v40, 0
    v_dot2_f32_bf16 v79, v21, v41, v79
    v_dot2_f32_bf16 v79, v22, v42, v79
    v_dot2_f32_bf16 v79, v23, v43, v79
    v_dot2_f32_bf16 v79, v24, v44, v79
    v_dot2_f32_bf16 v79, v25, v45, v79
    v_dot2_f32_bf16 v79, v26, v46, v79
    v_dot2_f32_bf16 v79, v27, v47, v79
    v_dot2_f32_bf16 v79, v28, v48, v79
    s_waitcnt lgkmcnt(0)
    ds_read_b64 v[40:41], v2 offset:15808
    ds_read_b64 v[42:43], v2 offset:15816
    ds_read_b64 v[44:45], v2 offset:15824
    ds_read_b64 v[46:47], v2 offset:15832
    ds_read_b32 v48, v2 offset:15840
    v_dot2_f32_bf16 v69, v10, v30, 0
    v_dot2_f32_bf16 v69, v11, v31, v69
    v_dot2_f32_bf16 v69, v12, v32, v69
    v_dot2_f32_bf16 v69, v13, v33, v69
    v_dot2_f32_bf16 v69, v14, v34, v69
    v_dot2_f32_bf16 v69, v15, v35, v69
    v_dot2_f32_bf16 v69, v16, v36, v69
    v_dot2_f32_bf16 v69, v17, v37, v69
    v_dot2_f32_bf16 v69, v18, v38, v69
    v_dot2_f32_bf16 v78, v20, v30, 0
    v_dot2_f32_bf16 v78, v21, v31, v78
    v_dot2_f32_bf16 v78, v22, v32, v78
    v_dot2_f32_bf16 v78, v23, v33, v78
    v_dot2_f32_bf16 v78, v24, v34, v78
    v_dot2_f32_bf16 v78, v25, v35, v78
    v_dot2_f32_bf16 v78, v26, v36, v78
    v_dot2_f32_bf16 v78, v27, v37, v78
    v_dot2_f32_bf16 v78, v28, v38, v78
    s_waitcnt lgkmcnt(0)
    ds_read_b64 v[30:31], v2 offset:17744
    ds_read_b64 v[32:33], v2 offset:17752
    ds_read_b64 v[34:35], v2 offset:17760
    ds_read_b64 v[36:37], v2 offset:17768
    ds_read_b32 v38, v2 offset:17776
    v_dot2_f32_bf16 v68, v10, v40, 0
    v_dot2_f32_bf16 v68, v11, v41, v68
    v_dot2_f32_bf16 v68, v12, v42, v68
    v_dot2_f32_bf16 v68, v13, v43, v68
    v_dot2_f32_bf16 v68, v14, v44, v68
    v_dot2_f32_bf16 v68, v15, v45, v68
    v_dot2_f32_bf16 v68, v16, v46, v68
    v_dot2_f32_bf16 v68, v17, v47, v68
    v_dot2_f32_bf16 v68, v18, v48, v68
    v_dot2_f32_bf16 v77, v20, v40, 0
    v_dot2_f32_bf16 v77, v21, v41, v77
    v_dot2_f32_bf16 v77, v22, v42, v77
    v_dot2_f32_bf16 v77, v23, v43, v77
    v_dot2_f32_bf16 v77, v24, v44, v77
    v_dot2_f32_bf16 v77, v25, v45, v77
    v_dot2_f32_bf16 v77, v26, v46, v77
    v_dot2_f32_bf16 v77, v27, v47, v77
    v_dot2_f32_bf16 v77, v28, v48, v77
    s_waitcnt lgkmcnt(0)
    ds_read_b64 v[40:41], v2 offset:2576
    ds_read_b64 v[42:43], v2 offset:2584
    ds_read_b64 v[44:45], v2 offset:2592
    ds_read_b64 v[46:47], v2 offset:2600
    ds_read_b32 v48, v2 offset:2608
    v_dot2_f32_bf16 v76, v20, v30, 0
    v_dot2_f32_bf16 v76, v21, v31, v76
    v_dot2_f32_bf16 v76, v22, v32, v76
    v_dot2_f32_bf16 v76, v23, v33, v76
    v_dot2_f32_bf16 v76, v24, v34, v76
    v_dot2_f32_bf16 v76, v25, v35, v76
    v_dot2_f32_bf16 v76, v26, v36, v76
    v_dot2_f32_bf16 v76, v27, v37, v76
    v_dot2_f32_bf16 v76, v28, v38, v76
    s_nop 2
    s_lshl_b32 s23, s22, 7
    v_add_u32 v7, s23, v5
    v_mov_b32 v8, 0xce6e6b28
    v_cvt_pk_bf16_f32 v3, v68, v68
    v_lshlrev_b32 v68, 16, v3
    v_mul_f32 v68, 0x3e715bef, v68
    v_cvt_pk_bf16_f32 v3, v68, v68
    v_lshlrev_b32 v68, 16, v3
    v_cvt_pk_bf16_f32 v3, v69, v69
    v_lshlrev_b32 v69, 16, v3
    v_mul_f32 v69, 0x3e715bef, v69
    v_cvt_pk_bf16_f32 v3, v69, v69
    v_lshlrev_b32 v69, 16, v3
    v_cvt_pk_bf16_f32 v3, v70, v70
    v_lshlrev_b32 v70, 16, v3
    v_mul_f32 v70, 0x3e715bef, v70
    v_cvt_pk_bf16_f32 v3, v70, v70
    v_lshlrev_b32 v70, 16, v3
    v_cvt_pk_bf16_f32 v3, v71, v71
    v_lshlrev_b32 v71, 16, v3
    v_mul_f32 v71, 0x3e715bef, v71
    v_cvt_pk_bf16_f32 v3, v71, v71
    v_lshlrev_b32 v71, 16, v3
    v_cvt_pk_bf16_f32 v3, v72, v72
    v_lshlrev_b32 v72, 16, v3
    v_mul_f32 v72, 0x3e715bef, v72
    v_cvt_pk_bf16_f32 v3, v72, v72
    v_lshlrev_b32 v72, 16, v3
    v_cvt_pk_bf16_f32 v3, v73, v73
    v_lshlrev_b32 v73, 16, v3
    v_mul_f32 v73, 0x3e715bef, v73
    v_cvt_pk_bf16_f32 v3, v73, v73
    v_lshlrev_b32 v73, 16, v3
    v_cvt_pk_bf16_f32 v3, v74, v74
    v_lshlrev_b32 v74, 16, v3
    v_mul_f32 v74, 0x3e715bef, v74
    v_cvt_pk_bf16_f32 v3, v74, v74
    v_lshlrev_b32 v74, 16, v3
    v_cvt_pk_bf16_f32 v3, v75, v75
    v_lshlrev_b32 v75, 16, v3
    v_mul_f32 v75, 0x3e715bef, v75
    v_cvt_pk_bf16_f32 v3, v75, v75
    v_lshlrev_b32 v75, 16, v3
    v_cmp_le_u32 vcc, 2, v7
    s_nop 1
    v_cndmask_b32 v69, v8, v69, vcc
    v_cmp_le_u32 vcc, 4, v7
    s_nop 1
    v_cndmask_b32 v70, v8, v70, vcc
    v_cmp_le_u32 vcc, 6, v7
    s_nop 1
    v_cndmask_b32 v71, v8, v71, vcc
    v_cmp_le_u32 vcc, 8, v7
    s_nop 1
    v_cndmask_b32 v72, v8, v72, vcc
    v_cmp_le_u32 vcc, 10, v7
    s_nop 1
    v_cndmask_b32 v73, v8, v73, vcc
    v_cmp_le_u32 vcc, 12, v7
    s_nop 1
    v_cndmask_b32 v74, v8, v74, vcc
    v_cmp_le_u32 vcc, 14, v7
    s_nop 1
    v_cndmask_b32 v75, v8, v75, vcc
    v_max_f32 v6, v68, v69
    v_max_f32 v6, v6, v70
    v_max_f32 v6, v6, v71
    v_max_f32 v6, v6, v72
    v_max_f32 v6, v6, v73
    v_max_f32 v6, v6, v74
    v_max_f32 v6, v6, v75
    v_sub_f32 v68, v68, v6
    v_mul_f32 v68, 0x3fb8aa3b, v68
    v_exp_f32 v68, v68
    v_sub_f32 v69, v69, v6
    v_mul_f32 v69, 0x3fb8aa3b, v69
    v_exp_f32 v69, v69
    v_sub_f32 v70, v70, v6
    v_mul_f32 v70, 0x3fb8aa3b, v70
    v_exp_f32 v70, v70
    v_sub_f32 v71, v71, v6
    v_mul_f32 v71, 0x3fb8aa3b, v71
    v_exp_f32 v71, v71
    v_sub_f32 v72, v72, v6
    v_mul_f32 v72, 0x3fb8aa3b, v72
    v_exp_f32 v72, v72
    v_sub_f32 v73, v73, v6
    v_mul_f32 v73, 0x3fb8aa3b, v73
    v_exp_f32 v73, v73
    v_sub_f32 v74, v74, v6
    v_mul_f32 v74, 0x3fb8aa3b, v74
    v_exp_f32 v74, v74
    v_sub_f32 v75, v75, v6
    v_mul_f32 v75, 0x3fb8aa3b, v75
    v_exp_f32 v75, v75
    s_nop 0
    v_add_f32 v9, v68, v69
    v_add_f32 v9, v9, v70
    v_add_f32 v9, v9, v71
    v_add_f32 v9, v9, v72
    v_add_f32 v9, v9, v73
    v_add_f32 v9, v9, v74
    v_add_f32 v9, v9, v75
    v_rcp_f32 v9, v9
    s_nop 0
    v_mul_f32 v68, v68, v9
    v_cvt_pk_bf16_f32 v3, v68, v68
    v_lshlrev_b32 v68, 16, v3
    v_mul_f32 v69, v69, v9
    v_cvt_pk_bf16_f32 v3, v69, v69
    v_lshlrev_b32 v69, 16, v3
    v_mul_f32 v70, v70, v9
    v_cvt_pk_bf16_f32 v3, v70, v70
    v_lshlrev_b32 v70, 16, v3
    v_mul_f32 v71, v71, v9
    v_cvt_pk_bf16_f32 v3, v71, v71
    v_lshlrev_b32 v71, 16, v3
    v_mul_f32 v72, v72, v9
    v_cvt_pk_bf16_f32 v3, v72, v72
    v_lshlrev_b32 v72, 16, v3
    v_mul_f32 v73, v73, v9
    v_cvt_pk_bf16_f32 v3, v73, v73
    v_lshlrev_b32 v73, 16, v3
    v_mul_f32 v74, v74, v9
    v_cvt_pk_bf16_f32 v3, v74, v74
    v_lshlrev_b32 v74, 16, v3
    v_mul_f32 v75, v75, v9
    v_cvt_pk_bf16_f32 v3, v75, v75
    v_lshlrev_b32 v75, 16, v3
    v_cvt_pk_bf16_f32 v3, v76, v76
    v_lshlrev_b32 v76, 16, v3
    v_mul_f32 v76, 0x3e715bef, v76
    v_cvt_pk_bf16_f32 v3, v76, v76
    v_lshlrev_b32 v76, 16, v3
    v_cvt_pk_bf16_f32 v3, v77, v77
    v_lshlrev_b32 v77, 16, v3
    v_mul_f32 v77, 0x3e715bef, v77
    v_cvt_pk_bf16_f32 v3, v77, v77
    v_lshlrev_b32 v77, 16, v3
    v_cvt_pk_bf16_f32 v3, v78, v78
    v_lshlrev_b32 v78, 16, v3
    v_mul_f32 v78, 0x3e715bef, v78
    v_cvt_pk_bf16_f32 v3, v78, v78
    v_lshlrev_b32 v78, 16, v3
    v_cvt_pk_bf16_f32 v3, v79, v79
    v_lshlrev_b32 v79, 16, v3
    v_mul_f32 v79, 0x3e715bef, v79
    v_cvt_pk_bf16_f32 v3, v79, v79
    v_lshlrev_b32 v79, 16, v3
    v_cvt_pk_bf16_f32 v3, v80, v80
    v_lshlrev_b32 v80, 16, v3
    v_mul_f32 v80, 0x3e715bef, v80
    v_cvt_pk_bf16_f32 v3, v80, v80
    v_lshlrev_b32 v80, 16, v3
    v_cvt_pk_bf16_f32 v3, v81, v81
    v_lshlrev_b32 v81, 16, v3
    v_mul_f32 v81, 0x3e715bef, v81
    v_cvt_pk_bf16_f32 v3, v81, v81
    v_lshlrev_b32 v81, 16, v3
    v_cvt_pk_bf16_f32 v3, v82, v82
    v_lshlrev_b32 v82, 16, v3
    v_mul_f32 v82, 0x3e715bef, v82
    v_cvt_pk_bf16_f32 v3, v82, v82
    v_lshlrev_b32 v82, 16, v3
    v_cvt_pk_bf16_f32 v3, v83, v83
    v_lshlrev_b32 v83, 16, v3
    v_mul_f32 v83, 0x3e715bef, v83
    v_cvt_pk_bf16_f32 v3, v83, v83
    v_lshlrev_b32 v83, 16, v3
    v_cmp_le_u32 vcc, 2, v7
    s_nop 1
    v_cndmask_b32 v78, v8, v78, vcc
    v_cmp_le_u32 vcc, 4, v7
    s_nop 1
    v_cndmask_b32 v79, v8, v79, vcc
    v_cmp_le_u32 vcc, 6, v7
    s_nop 1
    v_cndmask_b32 v80, v8, v80, vcc
    v_cmp_le_u32 vcc, 8, v7
    s_nop 1
    v_cndmask_b32 v81, v8, v81, vcc
    v_cmp_le_u32 vcc, 10, v7
    s_nop 1
    v_cndmask_b32 v82, v8, v82, vcc
    v_cmp_le_u32 vcc, 12, v7
    s_nop 1
    v_cndmask_b32 v83, v8, v83, vcc
    v_max_f32 v6, v76, v77
    v_max_f32 v6, v6, v78
    v_max_f32 v6, v6, v79
    v_max_f32 v6, v6, v80
    v_max_f32 v6, v6, v81
    v_max_f32 v6, v6, v82
    v_max_f32 v6, v6, v83
    v_sub_f32 v76, v76, v6
    v_mul_f32 v76, 0x3fb8aa3b, v76
    v_exp_f32 v76, v76
    v_sub_f32 v77, v77, v6
    v_mul_f32 v77, 0x3fb8aa3b, v77
    v_exp_f32 v77, v77
    v_sub_f32 v78, v78, v6
    v_mul_f32 v78, 0x3fb8aa3b, v78
    v_exp_f32 v78, v78
    v_sub_f32 v79, v79, v6
    v_mul_f32 v79, 0x3fb8aa3b, v79
    v_exp_f32 v79, v79
    v_sub_f32 v80, v80, v6
    v_mul_f32 v80, 0x3fb8aa3b, v80
    v_exp_f32 v80, v80
    v_sub_f32 v81, v81, v6
    v_mul_f32 v81, 0x3fb8aa3b, v81
    v_exp_f32 v81, v81
    v_sub_f32 v82, v82, v6
    v_mul_f32 v82, 0x3fb8aa3b, v82
    v_exp_f32 v82, v82
    v_sub_f32 v83, v83, v6
    v_mul_f32 v83, 0x3fb8aa3b, v83
    v_exp_f32 v83, v83
    s_nop 0
    v_add_f32 v9, v76, v77
    v_add_f32 v9, v9, v78
    v_add_f32 v9, v9, v79
    v_add_f32 v9, v9, v80
    v_add_f32 v9, v9, v81
    v_add_f32 v9, v9, v82
    v_add_f32 v9, v9, v83
    v_rcp_f32 v9, v9
    s_nop 0
    v_mul_f32 v76, v76, v9
    v_cvt_pk_bf16_f32 v3, v76, v76
    v_lshlrev_b32 v76, 16, v3
    v_mul_f32 v77, v77, v9
    v_cvt_pk_bf16_f32 v3, v77, v77
    v_lshlrev_b32 v77, 16, v3
    v_mul_f32 v78, v78, v9
    v_cvt_pk_bf16_f32 v3, v78, v78
    v_lshlrev_b32 v78, 16, v3
    v_mul_f32 v79, v79, v9
    v_cvt_pk_bf16_f32 v3, v79, v79
    v_lshlrev_b32 v79, 16, v3
    v_mul_f32 v80, v80, v9
    v_cvt_pk_bf16_f32 v3, v80, v80
    v_lshlrev_b32 v80, 16, v3
    v_mul_f32 v81, v81, v9
    v_cvt_pk_bf16_f32 v3, v81, v81
    v_lshlrev_b32 v81, 16, v3
    v_mul_f32 v82, v82, v9
    v_cvt_pk_bf16_f32 v3, v82, v82
    v_lshlrev_b32 v82, 16, v3
    v_mul_f32 v83, v83, v9
    v_cvt_pk_bf16_f32 v3, v83, v83
    v_lshlrev_b32 v83, 16, v3
    s_waitcnt lgkmcnt(0)
    v_lshlrev_b32 v50, 16, v40
    v_and_b32 v51, 0xffff0000, v40
    v_lshlrev_b32 v52, 16, v41
    v_and_b32 v53, 0xffff0000, v41
    v_lshlrev_b32 v54, 16, v42
    v_and_b32 v55, 0xffff0000, v42
    v_lshlrev_b32 v56, 16, v43
    v_and_b32 v57, 0xffff0000, v43
    v_lshlrev_b32 v58, 16, v44
    v_and_b32 v59, 0xffff0000, v44
    v_lshlrev_b32 v60, 16, v45
    v_and_b32 v61, 0xffff0000, v45
    v_lshlrev_b32 v62, 16, v46
    v_and_b32 v63, 0xffff0000, v46
    v_lshlrev_b32 v64, 16, v47
    v_and_b32 v65, 0xffff0000, v47
    v_lshlrev_b32 v66, 16, v48
    v_and_b32 v67, 0xffff0000, v48
    ds_read_b64 v[30:31], v2 offset:4512
    ds_read_b64 v[32:33], v2 offset:4520
    ds_read_b64 v[34:35], v2 offset:4528
    ds_read_b64 v[36:37], v2 offset:4536
    ds_read_b32 v38, v2 offset:4544
    v_mul_f32 v84, v75, v50
    v_mul_f32 v85, v75, v51
    v_mul_f32 v86, v75, v52
    v_mul_f32 v87, v75, v53
    v_mul_f32 v88, v75, v54
    v_mul_f32 v89, v75, v55
    v_mul_f32 v90, v75, v56
    v_mul_f32 v91, v75, v57
    v_mul_f32 v92, v75, v58
    v_mul_f32 v93, v75, v59
    v_mul_f32 v94, v75, v60
    v_mul_f32 v95, v75, v61
    v_mul_f32 v96, v75, v62
    v_mul_f32 v97, v75, v63
    v_mul_f32 v98, v75, v64
    v_mul_f32 v99, v75, v65
    v_mul_f32 v100, v75, v66
    v_mul_f32 v101, v75, v67
    s_waitcnt lgkmcnt(0)
    v_lshlrev_b32 v50, 16, v30
    v_and_b32 v51, 0xffff0000, v30
    v_lshlrev_b32 v52, 16, v31
    v_and_b32 v53, 0xffff0000, v31
    v_lshlrev_b32 v54, 16, v32
    v_and_b32 v55, 0xffff0000, v32
    v_lshlrev_b32 v56, 16, v33
    v_and_b32 v57, 0xffff0000, v33
    v_lshlrev_b32 v58, 16, v34
    v_and_b32 v59, 0xffff0000, v34
    v_lshlrev_b32 v60, 16, v35
    v_and_b32 v61, 0xffff0000, v35
    v_lshlrev_b32 v62, 16, v36
    v_and_b32 v63, 0xffff0000, v36
    v_lshlrev_b32 v64, 16, v37
    v_and_b32 v65, 0xffff0000, v37
    v_lshlrev_b32 v66, 16, v38
    v_and_b32 v67, 0xffff0000, v38
    ds_read_b64 v[40:41], v2 offset:6448
    ds_read_b64 v[42:43], v2 offset:6456
    ds_read_b64 v[44:45], v2 offset:6464
    ds_read_b64 v[46:47], v2 offset:6472
    ds_read_b32 v48, v2 offset:6480
    v_fmac_f32 v84, v74, v50
    v_fmac_f32 v85, v74, v51
    v_fmac_f32 v86, v74, v52
    v_fmac_f32 v87, v74, v53
    v_fmac_f32 v88, v74, v54
    v_fmac_f32 v89, v74, v55
    v_fmac_f32 v90, v74, v56
    v_fmac_f32 v91, v74, v57
    v_fmac_f32 v92, v74, v58
    v_fmac_f32 v93, v74, v59
    v_fmac_f32 v94, v74, v60
    v_fmac_f32 v95, v74, v61
    v_fmac_f32 v96, v74, v62
    v_fmac_f32 v97, v74, v63
    v_fmac_f32 v98, v74, v64
    v_fmac_f32 v99, v74, v65
    v_fmac_f32 v100, v74, v66
    v_fmac_f32 v101, v74, v67
    v_mul_f32 v102, v83, v50
    v_mul_f32 v103, v83, v51
    v_mul_f32 v104, v83, v52
    v_mul_f32 v105, v83, v53
    v_mul_f32 v106, v83, v54
    v_mul_f32 v107, v83, v55
    v_mul_f32 v108, v83, v56
    v_mul_f32 v109, v83, v57
    v_mul_f32 v110, v83, v58
    v_mul_f32 v111, v83, v59
    v_mul_f32 v112, v83, v60
    v_mul_f32 v113, v83, v61
    v_mul_f32 v114, v83, v62
    v_mul_f32 v115, v83, v63
    v_mul_f32 v116, v83, v64
    v_mul_f32 v117, v83, v65
    v_mul_f32 v118, v83, v66
    v_mul_f32 v119, v83, v67
    s_waitcnt lgkmcnt(0)
    v_lshlrev_b32 v50, 16, v40
    v_and_b32 v51, 0xffff0000, v40
    v_lshlrev_b32 v52, 16, v41
    v_and_b32 v53, 0xffff0000, v41
    v_lshlrev_b32 v54, 16, v42
    v_and_b32 v55, 0xffff0000, v42
    v_lshlrev_b32 v56, 16, v43
    v_and_b32 v57, 0xffff0000, v43
    v_lshlrev_b32 v58, 16, v44
    v_and_b32 v59, 0xffff0000, v44
    v_lshlrev_b32 v60, 16, v45
    v_and_b32 v61, 0xffff0000, v45
    v_lshlrev_b32 v62, 16, v46
    v_and_b32 v63, 0xffff0000, v46
    v_lshlrev_b32 v64, 16, v47
    v_and_b32 v65, 0xffff0000, v47
    v_lshlrev_b32 v66, 16, v48
    v_and_b32 v67, 0xffff0000, v48
    ds_read_b64 v[30:31], v2 offset:8384
    ds_read_b64 v[32:33], v2 offset:8392
    ds_read_b64 v[34:35], v2 offset:8400
    ds_read_b64 v[36:37], v2 offset:8408
    ds_read_b32 v38, v2 offset:8416
    v_fmac_f32 v84, v73, v50
    v_fmac_f32 v85, v73, v51
    v_fmac_f32 v86, v73, v52
    v_fmac_f32 v87, v73, v53
    v_fmac_f32 v88, v73, v54
    v_fmac_f32 v89, v73, v55
    v_fmac_f32 v90, v73, v56
    v_fmac_f32 v91, v73, v57
    v_fmac_f32 v92, v73, v58
    v_fmac_f32 v93, v73, v59
    v_fmac_f32 v94, v73, v60
    v_fmac_f32 v95, v73, v61
    v_fmac_f32 v96, v73, v62
    v_fmac_f32 v97, v73, v63
    v_fmac_f32 v98, v73, v64
    v_fmac_f32 v99, v73, v65
    v_fmac_f32 v100, v73, v66
    v_fmac_f32 v101, v73, v67
    v_fmac_f32 v102, v82, v50
    v_fmac_f32 v103, v82, v51
    v_fmac_f32 v104, v82, v52
    v_fmac_f32 v105, v82, v53
    v_fmac_f32 v106, v82, v54
    v_fmac_f32 v107, v82, v55
    v_fmac_f32 v108, v82, v56
    v_fmac_f32 v109, v82, v57
    v_fmac_f32 v110, v82, v58
    v_fmac_f32 v111, v82, v59
    v_fmac_f32 v112, v82, v60
    v_fmac_f32 v113, v82, v61
    v_fmac_f32 v114, v82, v62
    v_fmac_f32 v115, v82, v63
    v_fmac_f32 v116, v82, v64
    v_fmac_f32 v117, v82, v65
    v_fmac_f32 v118, v82, v66
    v_fmac_f32 v119, v82, v67
    s_waitcnt lgkmcnt(0)
    v_lshlrev_b32 v50, 16, v30
    v_and_b32 v51, 0xffff0000, v30
    v_lshlrev_b32 v52, 16, v31
    v_and_b32 v53, 0xffff0000, v31
    v_lshlrev_b32 v54, 16, v32
    v_and_b32 v55, 0xffff0000, v32
    v_lshlrev_b32 v56, 16, v33
    v_and_b32 v57, 0xffff0000, v33
    v_lshlrev_b32 v58, 16, v34
    v_and_b32 v59, 0xffff0000, v34
    v_lshlrev_b32 v60, 16, v35
    v_and_b32 v61, 0xffff0000, v35
    v_lshlrev_b32 v62, 16, v36
    v_and_b32 v63, 0xffff0000, v36
    v_lshlrev_b32 v64, 16, v37
    v_and_b32 v65, 0xffff0000, v37
    v_lshlrev_b32 v66, 16, v38
    v_and_b32 v67, 0xffff0000, v38
    ds_read_b64 v[40:41], v2 offset:10320
    ds_read_b64 v[42:43], v2 offset:10328
    ds_read_b64 v[44:45], v2 offset:10336
    ds_read_b64 v[46:47], v2 offset:10344
    ds_read_b32 v48, v2 offset:10352
    v_fmac_f32 v84, v72, v50
    v_fmac_f32 v85, v72, v51
    v_fmac_f32 v86, v72, v52
    v_fmac_f32 v87, v72, v53
    v_fmac_f32 v88, v72, v54
    v_fmac_f32 v89, v72, v55
    v_fmac_f32 v90, v72, v56
    v_fmac_f32 v91, v72, v57
    v_fmac_f32 v92, v72, v58
    v_fmac_f32 v93, v72, v59
    v_fmac_f32 v94, v72, v60
    v_fmac_f32 v95, v72, v61
    v_fmac_f32 v96, v72, v62
    v_fmac_f32 v97, v72, v63
    v_fmac_f32 v98, v72, v64
    v_fmac_f32 v99, v72, v65
    v_fmac_f32 v100, v72, v66
    v_fmac_f32 v101, v72, v67
    v_fmac_f32 v102, v81, v50
    v_fmac_f32 v103, v81, v51
    v_fmac_f32 v104, v81, v52
    v_fmac_f32 v105, v81, v53
    v_fmac_f32 v106, v81, v54
    v_fmac_f32 v107, v81, v55
    v_fmac_f32 v108, v81, v56
    v_fmac_f32 v109, v81, v57
    v_fmac_f32 v110, v81, v58
    v_fmac_f32 v111, v81, v59
    v_fmac_f32 v112, v81, v60
    v_fmac_f32 v113, v81, v61
    v_fmac_f32 v114, v81, v62
    v_fmac_f32 v115, v81, v63
    v_fmac_f32 v116, v81, v64
    v_fmac_f32 v117, v81, v65
    v_fmac_f32 v118, v81, v66
    v_fmac_f32 v119, v81, v67
    s_waitcnt lgkmcnt(0)
    v_lshlrev_b32 v50, 16, v40
    v_and_b32 v51, 0xffff0000, v40
    v_lshlrev_b32 v52, 16, v41
    v_and_b32 v53, 0xffff0000, v41
    v_lshlrev_b32 v54, 16, v42
    v_and_b32 v55, 0xffff0000, v42
    v_lshlrev_b32 v56, 16, v43
    v_and_b32 v57, 0xffff0000, v43
    v_lshlrev_b32 v58, 16, v44
    v_and_b32 v59, 0xffff0000, v44
    v_lshlrev_b32 v60, 16, v45
    v_and_b32 v61, 0xffff0000, v45
    v_lshlrev_b32 v62, 16, v46
    v_and_b32 v63, 0xffff0000, v46
    v_lshlrev_b32 v64, 16, v47
    v_and_b32 v65, 0xffff0000, v47
    v_lshlrev_b32 v66, 16, v48
    v_and_b32 v67, 0xffff0000, v48
    ds_read_b64 v[30:31], v2 offset:12256
    ds_read_b64 v[32:33], v2 offset:12264
    ds_read_b64 v[34:35], v2 offset:12272
    ds_read_b64 v[36:37], v2 offset:12280
    ds_read_b32 v38, v2 offset:12288
    v_fmac_f32 v84, v71, v50
    v_fmac_f32 v85, v71, v51
    v_fmac_f32 v86, v71, v52
    v_fmac_f32 v87, v71, v53
    v_fmac_f32 v88, v71, v54
    v_fmac_f32 v89, v71, v55
    v_fmac_f32 v90, v71, v56
    v_fmac_f32 v91, v71, v57
    v_fmac_f32 v92, v71, v58
    v_fmac_f32 v93, v71, v59
    v_fmac_f32 v94, v71, v60
    v_fmac_f32 v95, v71, v61
    v_fmac_f32 v96, v71, v62
    v_fmac_f32 v97, v71, v63
    v_fmac_f32 v98, v71, v64
    v_fmac_f32 v99, v71, v65
    v_fmac_f32 v100, v71, v66
    v_fmac_f32 v101, v71, v67
    v_fmac_f32 v102, v80, v50
    v_fmac_f32 v103, v80, v51
    v_fmac_f32 v104, v80, v52
    v_fmac_f32 v105, v80, v53
    v_fmac_f32 v106, v80, v54
    v_fmac_f32 v107, v80, v55
    v_fmac_f32 v108, v80, v56
    v_fmac_f32 v109, v80, v57
    v_fmac_f32 v110, v80, v58
    v_fmac_f32 v111, v80, v59
    v_fmac_f32 v112, v80, v60
    v_fmac_f32 v113, v80, v61
    v_fmac_f32 v114, v80, v62
    v_fmac_f32 v115, v80, v63
    v_fmac_f32 v116, v80, v64
    v_fmac_f32 v117, v80, v65
    v_fmac_f32 v118, v80, v66
    v_fmac_f32 v119, v80, v67
    s_waitcnt lgkmcnt(0)
    v_lshlrev_b32 v50, 16, v30
    v_and_b32 v51, 0xffff0000, v30
    v_lshlrev_b32 v52, 16, v31
    v_and_b32 v53, 0xffff0000, v31
    v_lshlrev_b32 v54, 16, v32
    v_and_b32 v55, 0xffff0000, v32
    v_lshlrev_b32 v56, 16, v33
    v_and_b32 v57, 0xffff0000, v33
    v_lshlrev_b32 v58, 16, v34
    v_and_b32 v59, 0xffff0000, v34
    v_lshlrev_b32 v60, 16, v35
    v_and_b32 v61, 0xffff0000, v35
    v_lshlrev_b32 v62, 16, v36
    v_and_b32 v63, 0xffff0000, v36
    v_lshlrev_b32 v64, 16, v37
    v_and_b32 v65, 0xffff0000, v37
    v_lshlrev_b32 v66, 16, v38
    v_and_b32 v67, 0xffff0000, v38
    ds_read_b64 v[40:41], v2 offset:14192
    ds_read_b64 v[42:43], v2 offset:14200
    ds_read_b64 v[44:45], v2 offset:14208
    ds_read_b64 v[46:47], v2 offset:14216
    ds_read_b32 v48, v2 offset:14224
    v_fmac_f32 v84, v70, v50
    v_fmac_f32 v85, v70, v51
    v_fmac_f32 v86, v70, v52
    v_fmac_f32 v87, v70, v53
    v_fmac_f32 v88, v70, v54
    v_fmac_f32 v89, v70, v55
    v_fmac_f32 v90, v70, v56
    v_fmac_f32 v91, v70, v57
    v_fmac_f32 v92, v70, v58
    v_fmac_f32 v93, v70, v59
    v_fmac_f32 v94, v70, v60
    v_fmac_f32 v95, v70, v61
    v_fmac_f32 v96, v70, v62
    v_fmac_f32 v97, v70, v63
    v_fmac_f32 v98, v70, v64
    v_fmac_f32 v99, v70, v65
    v_fmac_f32 v100, v70, v66
    v_fmac_f32 v101, v70, v67
    v_fmac_f32 v102, v79, v50
    v_fmac_f32 v103, v79, v51
    v_fmac_f32 v104, v79, v52
    v_fmac_f32 v105, v79, v53
    v_fmac_f32 v106, v79, v54
    v_fmac_f32 v107, v79, v55
    v_fmac_f32 v108, v79, v56
    v_fmac_f32 v109, v79, v57
    v_fmac_f32 v110, v79, v58
    v_fmac_f32 v111, v79, v59
    v_fmac_f32 v112, v79, v60
    v_fmac_f32 v113, v79, v61
    v_fmac_f32 v114, v79, v62
    v_fmac_f32 v115, v79, v63
    v_fmac_f32 v116, v79, v64
    v_fmac_f32 v117, v79, v65
    v_fmac_f32 v118, v79, v66
    v_fmac_f32 v119, v79, v67
    s_waitcnt lgkmcnt(0)
    v_lshlrev_b32 v50, 16, v40
    v_and_b32 v51, 0xffff0000, v40
    v_lshlrev_b32 v52, 16, v41
    v_and_b32 v53, 0xffff0000, v41
    v_lshlrev_b32 v54, 16, v42
    v_and_b32 v55, 0xffff0000, v42
    v_lshlrev_b32 v56, 16, v43
    v_and_b32 v57, 0xffff0000, v43
    v_lshlrev_b32 v58, 16, v44
    v_and_b32 v59, 0xffff0000, v44
    v_lshlrev_b32 v60, 16, v45
    v_and_b32 v61, 0xffff0000, v45
    v_lshlrev_b32 v62, 16, v46
    v_and_b32 v63, 0xffff0000, v46
    v_lshlrev_b32 v64, 16, v47
    v_and_b32 v65, 0xffff0000, v47
    v_lshlrev_b32 v66, 16, v48
    v_and_b32 v67, 0xffff0000, v48
    ds_read_b64 v[30:31], v2 offset:16128
    ds_read_b64 v[32:33], v2 offset:16136
    ds_read_b64 v[34:35], v2 offset:16144
    ds_read_b64 v[36:37], v2 offset:16152
    ds_read_b32 v38, v2 offset:16160
    v_fmac_f32 v84, v69, v50
    v_fmac_f32 v85, v69, v51
    v_fmac_f32 v86, v69, v52
    v_fmac_f32 v87, v69, v53
    v_fmac_f32 v88, v69, v54
    v_fmac_f32 v89, v69, v55
    v_fmac_f32 v90, v69, v56
    v_fmac_f32 v91, v69, v57
    v_fmac_f32 v92, v69, v58
    v_fmac_f32 v93, v69, v59
    v_fmac_f32 v94, v69, v60
    v_fmac_f32 v95, v69, v61
    v_fmac_f32 v96, v69, v62
    v_fmac_f32 v97, v69, v63
    v_fmac_f32 v98, v69, v64
    v_fmac_f32 v99, v69, v65
    v_fmac_f32 v100, v69, v66
    v_fmac_f32 v101, v69, v67
    v_fmac_f32 v102, v78, v50
    v_fmac_f32 v103, v78, v51
    v_fmac_f32 v104, v78, v52
    v_fmac_f32 v105, v78, v53
    v_fmac_f32 v106, v78, v54
    v_fmac_f32 v107, v78, v55
    v_fmac_f32 v108, v78, v56
    v_fmac_f32 v109, v78, v57
    v_fmac_f32 v110, v78, v58
    v_fmac_f32 v111, v78, v59
    v_fmac_f32 v112, v78, v60
    v_fmac_f32 v113, v78, v61
    v_fmac_f32 v114, v78, v62
    v_fmac_f32 v115, v78, v63
    v_fmac_f32 v116, v78, v64
    v_fmac_f32 v117, v78, v65
    v_fmac_f32 v118, v78, v66
    v_fmac_f32 v119, v78, v67
    s_waitcnt lgkmcnt(0)
    v_lshlrev_b32 v50, 16, v30
    v_and_b32 v51, 0xffff0000, v30
    v_lshlrev_b32 v52, 16, v31
    v_and_b32 v53, 0xffff0000, v31
    v_lshlrev_b32 v54, 16, v32
    v_and_b32 v55, 0xffff0000, v32
    v_lshlrev_b32 v56, 16, v33
    v_and_b32 v57, 0xffff0000, v33
    v_lshlrev_b32 v58, 16, v34
    v_and_b32 v59, 0xffff0000, v34
    v_lshlrev_b32 v60, 16, v35
    v_and_b32 v61, 0xffff0000, v35
    v_lshlrev_b32 v62, 16, v36
    v_and_b32 v63, 0xffff0000, v36
    v_lshlrev_b32 v64, 16, v37
    v_and_b32 v65, 0xffff0000, v37
    v_lshlrev_b32 v66, 16, v38
    v_and_b32 v67, 0xffff0000, v38
    ds_read_b64 v[40:41], v2 offset:18064
    ds_read_b64 v[42:43], v2 offset:18072
    ds_read_b64 v[44:45], v2 offset:18080
    ds_read_b64 v[46:47], v2 offset:18088
    ds_read_b32 v48, v2 offset:18096
    v_fmac_f32 v84, v68, v50
    v_fmac_f32 v85, v68, v51
    v_fmac_f32 v86, v68, v52
    v_fmac_f32 v87, v68, v53
    v_fmac_f32 v88, v68, v54
    v_fmac_f32 v89, v68, v55
    v_fmac_f32 v90, v68, v56
    v_fmac_f32 v91, v68, v57
    v_fmac_f32 v92, v68, v58
    v_fmac_f32 v93, v68, v59
    v_fmac_f32 v94, v68, v60
    v_fmac_f32 v95, v68, v61
    v_fmac_f32 v96, v68, v62
    v_fmac_f32 v97, v68, v63
    v_fmac_f32 v98, v68, v64
    v_fmac_f32 v99, v68, v65
    v_fmac_f32 v100, v68, v66
    v_fmac_f32 v101, v68, v67
    v_fmac_f32 v102, v77, v50
    v_fmac_f32 v103, v77, v51
    v_fmac_f32 v104, v77, v52
    v_fmac_f32 v105, v77, v53
    v_fmac_f32 v106, v77, v54
    v_fmac_f32 v107, v77, v55
    v_fmac_f32 v108, v77, v56
    v_fmac_f32 v109, v77, v57
    v_fmac_f32 v110, v77, v58
    v_fmac_f32 v111, v77, v59
    v_fmac_f32 v112, v77, v60
    v_fmac_f32 v113, v77, v61
    v_fmac_f32 v114, v77, v62
    v_fmac_f32 v115, v77, v63
    v_fmac_f32 v116, v77, v64
    v_fmac_f32 v117, v77, v65
    v_fmac_f32 v118, v77, v66
    v_fmac_f32 v119, v77, v67
    s_waitcnt lgkmcnt(0)
    v_lshlrev_b32 v50, 16, v40
    v_and_b32 v51, 0xffff0000, v40
    v_lshlrev_b32 v52, 16, v41
    v_and_b32 v53, 0xffff0000, v41
    v_lshlrev_b32 v54, 16, v42
    v_and_b32 v55, 0xffff0000, v42
    v_lshlrev_b32 v56, 16, v43
    v_and_b32 v57, 0xffff0000, v43
    v_lshlrev_b32 v58, 16, v44
    v_and_b32 v59, 0xffff0000, v44
    v_lshlrev_b32 v60, 16, v45
    v_and_b32 v61, 0xffff0000, v45
    v_lshlrev_b32 v62, 16, v46
    v_and_b32 v63, 0xffff0000, v46
    v_lshlrev_b32 v64, 16, v47
    v_and_b32 v65, 0xffff0000, v47
    v_lshlrev_b32 v66, 16, v48
    v_and_b32 v67, 0xffff0000, v48
    v_fmac_f32 v102, v76, v50
    v_fmac_f32 v103, v76, v51
    v_fmac_f32 v104, v76, v52
    v_fmac_f32 v105, v76, v53
    v_fmac_f32 v106, v76, v54
    v_fmac_f32 v107, v76, v55
    v_fmac_f32 v108, v76, v56
    v_fmac_f32 v109, v76, v57
    v_fmac_f32 v110, v76, v58
    v_fmac_f32 v111, v76, v59
    v_fmac_f32 v112, v76, v60
    v_fmac_f32 v113, v76, v61
    v_fmac_f32 v114, v76, v62
    v_fmac_f32 v115, v76, v63
    v_fmac_f32 v116, v76, v64
    v_fmac_f32 v117, v76, v65
    v_fmac_f32 v118, v76, v66
    v_fmac_f32 v119, v76, v67
    s_mul_i32 s23, s21, 144
    v_mul_u32_u24 v6, 18, v4
    v_add_u32 v6, s23, v6
    v_add_u32 v3, 0, v6
    v_lshrrev_b32 v8, 5, v3
    v_add_u32 v8, 144, v8
    v_lshlrev_b32 v8, 10, v8
    v_bfe_u32 v9, v3, 2, 2
    v_lshl_add_u32 v8, v9, 8, v8
    v_bfe_u32 v9, v3, 4, 1
    v_lshl_add_u32 v8, v9, 3, v8
    v_and_b32 v9, 2, v3
    v_lshl_add_u32 v10, v9, 1, v8
    v_add_u32 v3, 2, v6
    v_lshrrev_b32 v8, 5, v3
    v_add_u32 v8, 144, v8
    v_lshlrev_b32 v8, 10, v8
    v_bfe_u32 v9, v3, 2, 2
    v_lshl_add_u32 v8, v9, 8, v8
    v_bfe_u32 v9, v3, 4, 1
    v_lshl_add_u32 v8, v9, 3, v8
    v_and_b32 v9, 2, v3
    v_lshl_add_u32 v11, v9, 1, v8
    v_add_u32 v3, 4, v6
    v_lshrrev_b32 v8, 5, v3
    v_add_u32 v8, 144, v8
    v_lshlrev_b32 v8, 10, v8
    v_bfe_u32 v9, v3, 2, 2
    v_lshl_add_u32 v8, v9, 8, v8
    v_bfe_u32 v9, v3, 4, 1
    v_lshl_add_u32 v8, v9, 3, v8
    v_and_b32 v9, 2, v3
    v_lshl_add_u32 v12, v9, 1, v8
    v_add_u32 v3, 6, v6
    v_lshrrev_b32 v8, 5, v3
    v_add_u32 v8, 144, v8
    v_lshlrev_b32 v8, 10, v8
    v_bfe_u32 v9, v3, 2, 2
    v_lshl_add_u32 v8, v9, 8, v8
    v_bfe_u32 v9, v3, 4, 1
    v_lshl_add_u32 v8, v9, 3, v8
    v_and_b32 v9, 2, v3
    v_lshl_add_u32 v13, v9, 1, v8
    v_add_u32 v3, 8, v6
    v_lshrrev_b32 v8, 5, v3
    v_add_u32 v8, 144, v8
    v_lshlrev_b32 v8, 10, v8
    v_bfe_u32 v9, v3, 2, 2
    v_lshl_add_u32 v8, v9, 8, v8
    v_bfe_u32 v9, v3, 4, 1
    v_lshl_add_u32 v8, v9, 3, v8
    v_and_b32 v9, 2, v3
    v_lshl_add_u32 v14, v9, 1, v8
    v_add_u32 v3, 10, v6
    v_lshrrev_b32 v8, 5, v3
    v_add_u32 v8, 144, v8
    v_lshlrev_b32 v8, 10, v8
    v_bfe_u32 v9, v3, 2, 2
    v_lshl_add_u32 v8, v9, 8, v8
    v_bfe_u32 v9, v3, 4, 1
    v_lshl_add_u32 v8, v9, 3, v8
    v_and_b32 v9, 2, v3
    v_lshl_add_u32 v15, v9, 1, v8
    v_add_u32 v3, 12, v6
    v_lshrrev_b32 v8, 5, v3
    v_add_u32 v8, 144, v8
    v_lshlrev_b32 v8, 10, v8
    v_bfe_u32 v9, v3, 2, 2
    v_lshl_add_u32 v8, v9, 8, v8
    v_bfe_u32 v9, v3, 4, 1
    v_lshl_add_u32 v8, v9, 3, v8
    v_and_b32 v9, 2, v3
    v_lshl_add_u32 v16, v9, 1, v8
    v_add_u32 v3, 14, v6
    v_lshrrev_b32 v8, 5, v3
    v_add_u32 v8, 144, v8
    v_lshlrev_b32 v8, 10, v8
    v_bfe_u32 v9, v3, 2, 2
    v_lshl_add_u32 v8, v9, 8, v8
    v_bfe_u32 v9, v3, 4, 1
    v_lshl_add_u32 v8, v9, 3, v8
    v_and_b32 v9, 2, v3
    v_lshl_add_u32 v17, v9, 1, v8
    v_add_u32 v3, 16, v6
    v_lshrrev_b32 v8, 5, v3
    v_add_u32 v8, 144, v8
    v_lshlrev_b32 v8, 10, v8
    v_bfe_u32 v9, v3, 2, 2
    v_lshl_add_u32 v8, v9, 8, v8
    v_bfe_u32 v9, v3, 4, 1
    v_lshl_add_u32 v8, v9, 3, v8
    v_and_b32 v9, 2, v3
    v_lshl_add_u32 v18, v9, 1, v8
    s_mov_b32 s23, 162*1024
    v_add_u32 v3, 0, v7
    v_lshrrev_b32 v8, 4, v3
    v_mul_lo_u32 v8, v8, s23
    v_and_b32 v9, 15, v3
    v_lshl_add_u32 v8, v9, 4, v8
    v_add_u32 v30, v8, v10
    v_cvt_pk_bf16_f32 v50, v84, v85
    buffer_store_dword v50, v30, s[16:19], 0 offen
    v_add_u32 v31, v8, v11
    v_cvt_pk_bf16_f32 v51, v86, v87
    buffer_store_dword v51, v31, s[16:19], 0 offen
    v_add_u32 v32, v8, v12
    v_cvt_pk_bf16_f32 v52, v88, v89
    buffer_store_dword v52, v32, s[16:19], 0 offen
    v_add_u32 v33, v8, v13
    v_cvt_pk_bf16_f32 v53, v90, v91
    buffer_store_dword v53, v33, s[16:19], 0 offen
    v_add_u32 v34, v8, v14
    v_cvt_pk_bf16_f32 v54, v92, v93
    buffer_store_dword v54, v34, s[16:19], 0 offen
    v_add_u32 v35, v8, v15
    v_cvt_pk_bf16_f32 v55, v94, v95
    buffer_store_dword v55, v35, s[16:19], 0 offen
    v_add_u32 v36, v8, v16
    v_cvt_pk_bf16_f32 v56, v96, v97
    buffer_store_dword v56, v36, s[16:19], 0 offen
    v_add_u32 v37, v8, v17
    v_cvt_pk_bf16_f32 v57, v98, v99
    buffer_store_dword v57, v37, s[16:19], 0 offen
    v_add_u32 v38, v8, v18
    v_cvt_pk_bf16_f32 v58, v100, v101
    buffer_store_dword v58, v38, s[16:19], 0 offen
    v_add_u32 v3, 2, v7
    v_lshrrev_b32 v8, 4, v3
    v_mul_lo_u32 v8, v8, s23
    v_and_b32 v9, 15, v3
    v_lshl_add_u32 v8, v9, 4, v8
    v_add_u32 v40, v8, v10
    v_cvt_pk_bf16_f32 v60, v102, v103
    buffer_store_dword v60, v40, s[16:19], 0 offen
    v_add_u32 v41, v8, v11
    v_cvt_pk_bf16_f32 v61, v104, v105
    buffer_store_dword v61, v41, s[16:19], 0 offen
    v_add_u32 v42, v8, v12
    v_cvt_pk_bf16_f32 v62, v106, v107
    buffer_store_dword v62, v42, s[16:19], 0 offen
    v_add_u32 v43, v8, v13
    v_cvt_pk_bf16_f32 v63, v108, v109
    buffer_store_dword v63, v43, s[16:19], 0 offen
    v_add_u32 v44, v8, v14
    v_cvt_pk_bf16_f32 v64, v110, v111
    buffer_store_dword v64, v44, s[16:19], 0 offen
    v_add_u32 v45, v8, v15
    v_cvt_pk_bf16_f32 v65, v112, v113
    buffer_store_dword v65, v45, s[16:19], 0 offen
    v_add_u32 v46, v8, v16
    v_cvt_pk_bf16_f32 v66, v114, v115
    buffer_store_dword v66, v46, s[16:19], 0 offen
    v_add_u32 v47, v8, v17
    v_cvt_pk_bf16_f32 v67, v116, v117
    buffer_store_dword v67, v47, s[16:19], 0 offen
    v_add_u32 v48, v8, v18
    v_cvt_pk_bf16_f32 v68, v118, v119
    buffer_store_dword v68, v48, s[16:19], 0 offen
L_ka_end:
    s_endpgm
.section .rodata,"a"
.p2align 6
.amdhsa_kernel ka_kernel
  .amdhsa_next_free_vgpr 256
  .amdhsa_next_free_sgpr 64
  .amdhsa_accum_offset 128
  .amdhsa_group_segment_fixed_size 0
  .amdhsa_kernarg_size 80
  .amdhsa_user_sgpr_count 2
  .amdhsa_user_sgpr_kernarg_segment_ptr 1
  .amdhsa_system_sgpr_workgroup_id_x 1
.end_amdhsa_kernel
.text

.globl gemm2_kernel
.p2align 8
.type gemm2_kernel,@function
gemm2_kernel:
    s_cmp_ge_u32 s2, 256
    s_cbranch_scc1 L_g2_end
    s_load_dwordx2 s[4:5], s[0:1], 48
    s_load_dwordx2 s[6:7], s[0:1], 16
    s_load_dwordx2 s[26:27], s[0:1], 72
    s_load_dwordx2 s[40:41], s[0:1], 0
    s_load_dwordx4 s[44:47], s[0:1], 56
    v_and_b32 v1, 63, v0
    v_lshrrev_b32 v2, 6, v0
    s_nop 0
    v_readfirstlane_b32 s20, v2
    s_and_b32 s23, s2, 7
    s_lshr_b32 s24, s2, 3
    s_lshr_b32 s21, s23, 1
    s_and_b32 s23, s23, 1
    s_lshl_b32 s23, s23, 3
    s_lshr_b32 s22, s24, 2
    s_add_u32 s22, s22, s23
    s_and_b32 s34, s24, 3
    s_and_b32 s38, s20, 3
    s_lshr_b32 s39, s20, 2
    v_lshlrev_b32 v18, 4, v1
    s_lshl_b32 s23, s22, 3
    s_lshl_b32 s24, s38, 1
    s_add_u32 s28, s23, s24
    s_mul_i32 s23, s28, 162*1024
    s_add_u32 s24, s23, 0
    v_add_u32 v13, s24, v18
    s_add_u32 s24, s23, 165888
    v_add_u32 v14, s24, v18
    s_mul_i32 s23, s20, 144
    s_mul_i32 s25, s34, 288
    s_add_u32 s24, s23, 0
    v_add_u32 v2, s24, v1
    s_mov_b32 s24, 1821
    v_mul_u32_u24 v3, s24, v2
    v_lshrrev_b32 v3, 15, v3
    v_mul_u32_u24 v4, 18, v3
    v_sub_u32 v4, v2, v4
    v_min_u32 v3, 63, v3
    v_mul_u32_u24 v5, 1152, v3
    v_lshl_add_u32 v5, v4, 4, v5
    v_add_u32 v10, s25, v5
    s_add_u32 s24, s23, 64
    v_add_u32 v2, s24, v1
    s_mov_b32 s24, 1821
    v_mul_u32_u24 v3, s24, v2
    v_lshrrev_b32 v3, 15, v3
    v_mul_u32_u24 v4, 18, v3
    v_sub_u32 v4, v2, v4
    v_min_u32 v3, 63, v3
    v_mul_u32_u24 v5, 1152, v3
    v_lshl_add_u32 v5, v4, 4, v5
    v_add_u32 v11, s25, v5
    s_add_u32 s24, s23, 128
    v_add_u32 v2, s24, v1
    s_mov_b32 s24, 1821
    v_mul_u32_u24 v3, s24, v2
    v_lshrrev_b32 v3, 15, v3
    v_mul_u32_u24 v4, 18, v3
    v_sub_u32 v4, v2, v4
    v_min_u32 v3, 63, v3
    v_mul_u32_u24 v5, 1152, v3
    v_lshl_add_u32 v5, v4, 4, v5
    v_add_u32 v12, s25, v5
    v_lshrrev_b32 v2, 4, v1
    v_lshlrev_b32 v2, 2, v2
    v_bfe_u32 v3, v1, 2, 2
    v_add_u32 v2, v2, v3
    v_mul_u32_u24 v2, 288, v2
    v_and_b32 v3, 3, v1
    v_lshl_add_u32 v2, v3, 3, v2
    s_mul_i32 s23, s39, 9216
    v_add_u32 v2, s23, v2
    v_add_u32 v15, 0, v2
    v_add_u32 v16, 55296, v2
    v_add_u32 v17, 110592, v2
    s_mul_i32 s29, s20, 2304
    s_mul_i32 s35, s21, 21
    s_waitcnt lgkmcnt(0)
    s_and_b32 s5, s5, 0xffff
    s_and_b32 s7, s7, 0xffff
    s_mov_b32 s15, 0x00020000
    s_mov_b32 s36, 5308416
    s_mov_b32 s37, 663552
    s_add_u32 s8, s26, 4194304
    s_addc_u32 s9, s27, 0
    s_and_b32 s9, s9, 0xffff
    s_mov_b32 s10, 21233664
    s_mov_b32 s11, 0x00020000
    s_add_u32 s16, s26, 33554432
    s_addc_u32 s17, s27, 0
    s_and_b32 s17, s17, 0xffff
    s_mov_b32 s18, 18874368
    s_mov_b32 s19, 0x00020000
    s_add_u32 s30, s35, 0
    s_sub_u32 s33, s30, 72
    s_cmp_lt_u32 s30, 72
    s_cselect_b32 s12, s4, s6
    s_cselect_b32 s13, s5, s7
    s_cselect_b32 s14, s36, s37
    s_cselect_b32 s30, s30, s33
    s_mul_i32 s31, s30, 73728
    s_add_u32 m0, s29, 0
    s_nop 0
    buffer_load_dwordx4 v10, s[12:15], s31 offen lds
    s_add_u32 m0, s29, 1024
    s_nop 0
    buffer_load_dwordx4 v11, s[12:15], s31 offen lds
    s_add_u32 m0, s29, 2048
    s_mov_b64 exec, 0xffff
    buffer_load_dwordx4 v12, s[12:15], s31 offen lds
    s_mov_b64 exec, -1
    s_add_u32 s32, s35, 0
    s_lshl_b32 s32, s32, 1
    s_add_u32 s32, s32, s39
    s_cmp_lt_u32 s32, 162
    s_cselect_b32 s32, s32, 0x100000
    s_lshl_b32 s32, s32, 10
    buffer_load_dwordx4 v[24:27], v13, s[8:11], s32 offen
    buffer_load_dwordx4 v[28:31], v14, s[8:11], s32 offen
    s_add_u32 s30, s35, 1
    s_sub_u32 s33, s30, 72
    s_cmp_lt_u32 s30, 72
    s_cselect_b32 s12, s4, s6
    s_cselect_b32 s13, s5, s7
    s_cselect_b32 s14, s36, s37
    s_cselect_b32 s30, s30, s33
    s_mul_i32 s31, s30, 73728
    s_add_u32 m0, s29, 18432
    s_nop 0
    buffer_load_dwordx4 v10, s[12:15], s31 offen lds
    s_add_u32 m0, s29, 19456
    s_nop 0
    buffer_load_dwordx4 v11, s[12:15], s31 offen lds
    s_add_u32 m0, s29, 20480
    s_mov_b64 exec, 0xffff
    buffer_load_dwordx4 v12, s[12:15], s31 offen lds
    s_mov_b64 exec, -1
    s_add_u32 s32, s35, 1
    s_lshl_b32 s32, s32, 1
    s_add_u32 s32, s32, s39
    s_cmp_lt_u32 s32, 162
    s_cselect_b32 s32, s32, 0x100000
    s_lshl_b32 s32, s32, 10
    buffer_load_dwordx4 v[32:35], v13, s[8:11], s32 offen
    buffer_load_dwordx4 v[36:39], v14, s[8:11], s32 offen
    s_waitcnt vmcnt(7)
    s_barrier
    ds_read_b64_tr_b16 v[88:89], v15 offset:0
    ds_read_b64_tr_b16 v[90:91], v15 offset:4608
    ds_read_b64_tr_b16 v[92:93], v15 offset:32
    ds_read_b64_tr_b16 v[94:95], v15 offset:4640
    ds_read_b64_tr_b16 v[96:97], v15 offset:64
    ds_read_b64_tr_b16 v[98:99], v15 offset:4672
    ds_read_b64_tr_b16 v[100:101], v15 offset:96
    ds_read_b64_tr_b16 v[102:103], v15 offset:4704
    s_waitcnt vmcnt(5)
    s_waitcnt lgkmcnt(6)
    v_mfma_f32_16x16x32_bf16 v[108:111], v[88:91], v[24:27], 0
    s_add_u32 s30, s35, 2
    s_sub_u32 s33, s30, 72
    s_cmp_lt_u32 s30, 72
    s_cselect_b32 s12, s4, s6
    s_cselect_b32 s13, s5, s7
    s_cselect_b32 s14, s36, s37
    s_cselect_b32 s30, s30, s33
    s_mul_i32 s31, s30, 73728
    s_add_u32 m0, s29, 36864
    s_nop 0
    buffer_load_dwordx4 v10, s[12:15], s31 offen lds
    v_mfma_f32_16x16x32_bf16 v[144:147], v[88:91], v[28:31], 0
    s_add_u32 m0, s29, 37888
    s_nop 0
    buffer_load_dwordx4 v11, s[12:15], s31 offen lds
    ds_read_b64_tr_b16 v[104:105], v15 offset:128
    ds_read_b64_tr_b16 v[106:107], v15 offset:4736
    s_waitcnt lgkmcnt(6)
    v_mfma_f32_16x16x32_bf16 v[112:115], v[92:95], v[24:27], 0
    s_add_u32 m0, s29, 38912
    s_mov_b64 exec, 0xffff
    buffer_load_dwordx4 v12, s[12:15], s31 offen lds
    s_mov_b64 exec, -1
    v_mfma_f32_16x16x32_bf16 v[148:151], v[92:95], v[28:31], 0
    s_add_u32 s32, s35, 2
    s_lshl_b32 s32, s32, 1
    s_add_u32 s32, s32, s39
    s_cmp_lt_u32 s32, 162
    s_cselect_b32 s32, s32, 0x100000
    s_lshl_b32 s32, s32, 10
    buffer_load_dwordx4 v[40:43], v13, s[8:11], s32 offen
    ds_read_b64_tr_b16 v[88:89], v15 offset:160
    ds_read_b64_tr_b16 v[90:91], v15 offset:4768
    s_waitcnt lgkmcnt(6)
    v_mfma_f32_16x16x32_bf16 v[116:119], v[96:99], v[24:27], 0
    buffer_load_dwordx4 v[44:47], v14, s[8:11], s32 offen
    v_mfma_f32_16x16x32_bf16 v[152:155], v[96:99], v[28:31], 0
    s_add_u32 s30, s35, 3
    s_sub_u32 s33, s30, 72
    s_cmp_lt_u32 s30, 72
    s_cselect_b32 s12, s4, s6
    s_cselect_b32 s13, s5, s7
    s_cselect_b32 s14, s36, s37
    s_cselect_b32 s30, s30, s33
    s_mul_i32 s31, s30, 73728
    s_add_u32 m0, s29, 55296
    s_nop 0
    buffer_load_dwordx4 v10, s[12:15], s31 offen lds
    ds_read_b64_tr_b16 v[92:93], v15 offset:192
    ds_read_b64_tr_b16 v[94:95], v15 offset:4800
    s_waitcnt lgkmcnt(6)
    v_mfma_f32_16x16x32_bf16 v[120:123], v[100:103], v[24:27], 0
    s_add_u32 m0, s29, 56320
    s_nop 0
    buffer_load_dwordx4 v11, s[12:15], s31 offen lds
    v_mfma_f32_16x16x32_bf16 v[156:159], v[100:103], v[28:31], 0
    s_add_u32 m0, s29, 57344
    s_mov_b64 exec, 0xffff
    buffer_load_dwordx4 v12, s[12:15], s31 offen lds
    s_mov_b64 exec, -1
    ds_read_b64_tr_b16 v[96:97], v15 offset:224
    ds_read_b64_tr_b16 v[98:99], v15 offset:4832
    s_waitcnt lgkmcnt(6)
    v_mfma_f32_16x16x32_bf16 v[124:127], v[104:107], v[24:27], 0
    s_add_u32 s32, s35, 3
    s_lshl_b32 s32, s32, 1
    s_add_u32 s32, s32, s39
    s_cmp_lt_u32 s32, 162
    s_cselect_b32 s32, s32, 0x100000
    s_lshl_b32 s32, s32, 10
    buffer_load_dwordx4 v[48:51], v13, s[8:11], s32 offen
    v_mfma_f32_16x16x32_bf16 v[160:163], v[104:107], v[28:31], 0
    buffer_load_dwordx4 v[52:55], v14, s[8:11], s32 offen
    ds_read_b64_tr_b16 v[100:101], v15 offset:256
    ds_read_b64_tr_b16 v[102:103], v15 offset:4864
    s_waitcnt lgkmcnt(6)
    v_mfma_f32_16x16x32_bf16 v[128:131], v[88:91], v[24:27], 0
    v_mfma_f32_16x16x32_bf16 v[164:167], v[88:91], v[28:31], 0
    s_waitcnt vmcnt(12)
    s_barrier
    ds_read_b64_tr_b16 v[104:105], v15 offset:18432
    ds_read_b64_tr_b16 v[106:107], v15 offset:23040
    s_waitcnt lgkmcnt(6)
    v_mfma_f32_16x16x32_bf16 v[132:135], v[92:95], v[24:27], 0
    s_add_u32 s30, s35, 4
    s_sub_u32 s33, s30, 72
    s_cmp_lt_u32 s30, 72
    s_cselect_b32 s12, s4, s6
    s_cselect_b32 s13, s5, s7
    s_cselect_b32 s14, s36, s37
    s_cselect_b32 s30, s30, s33
    s_mul_i32 s31, s30, 73728
    s_add_u32 m0, s29, 73728
    s_nop 0
    buffer_load_dwordx4 v10, s[12:15], s31 offen lds
    v_mfma_f32_16x16x32_bf16 v[168:171], v[92:95], v[28:31], 0
    s_add_u32 m0, s29, 74752
    s_nop 0
    buffer_load_dwordx4 v11, s[12:15], s31 offen lds
    ds_read_b64_tr_b16 v[88:89], v15 offset:18464
    ds_read_b64_tr_b16 v[90:91], v15 offset:23072
    s_waitcnt lgkmcnt(6)
    v_mfma_f32_16x16x32_bf16 v[136:139], v[96:99], v[24:27], 0
    s_add_u32 m0, s29, 75776
    s_mov_b64 exec, 0xffff
    buffer_load_dwordx4 v12, s[12:15], s31 offen lds
    s_mov_b64 exec, -1
    v_mfma_f32_16x16x32_bf16 v[172:175], v[96:99], v[28:31], 0
    s_add_u32 s32, s35, 4
    s_lshl_b32 s32, s32, 1
    s_add_u32 s32, s32, s39
    s_cmp_lt_u32 s32, 162
    s_cselect_b32 s32, s32, 0x100000
    s_lshl_b32 s32, s32, 10
    buffer_load_dwordx4 v[56:59], v13, s[8:11], s32 offen
    ds_read_b64_tr_b16 v[92:93], v15 offset:18496
    ds_read_b64_tr_b16 v[94:95], v15 offset:23104
    s_waitcnt lgkmcnt(6)
    v_mfma_f32_16x16x32_bf16 v[140:143], v[100:103], v[24:27], 0
    buffer_load_dwordx4 v[60:63], v14, s[8:11], s32 offen
    v_mfma_f32_16x16x32_bf16 v[176:179], v[100:103], v[28:31], 0
    s_add_u32 s30, s35, 5
    s_sub_u32 s33, s30, 72
    s_cmp_lt_u32 s30, 72
    s_cselect_b32 s12, s4, s6
    s_cselect_b32 s13, s5, s7
    s_cselect_b32 s14, s36, s37
    s_cselect_b32 s30, s30, s33
    s_mul_i32 s31, s30, 73728
    s_add_u32 m0, s29, 92160
    s_nop 0
    buffer_load_dwordx4 v10, s[12:15], s31 offen lds
    ds_read_b64_tr_b16 v[96:97], v15 offset:18528
    ds_read_b64_tr_b16 v[98:99], v15 offset:23136
    s_waitcnt vmcnt(16)
    s_waitcnt lgkmcnt(6)
    v_mfma_f32_16x16x32_bf16 v[108:111], v[104:107], v[32:35], v[108:111]
    s_add_u32 m0, s29, 93184
    s_nop 0
    buffer_load_dwordx4 v11, s[12:15], s31 offen lds
    v_mfma_f32_16x16x32_bf16 v[144:147], v[104:107], v[36:39], v[144:147]
    s_add_u32 m0, s29, 94208
    s_mov_b64 exec, 0xffff
    buffer_load_dwordx4 v12, s[12:15], s31 offen lds
    s_mov_b64 exec, -1
    ds_read_b64_tr_b16 v[100:101], v15 offset:18560
    ds_read_b64_tr_b16 v[102:103], v15 offset:23168
    s_waitcnt lgkmcnt(6)
    v_mfma_f32_16x16x32_bf16 v[112:115], v[88:91], v[32:35], v[112:115]
    s_add_u32 s32, s35, 5
    s_lshl_b32 s32, s32, 1
    s_add_u32 s32, s32, s39
    s_cmp_lt_u32 s32, 162
    s_cselect_b32 s32, s32, 0x100000
    s_lshl_b32 s32, s32, 10
    buffer_load_dwordx4 v[64:67], v13, s[8:11], s32 offen
    v_mfma_f32_16x16x32_bf16 v[148:151], v[88:91], v[36:39], v[148:151]
    buffer_load_dwordx4 v[68:71], v14, s[8:11], s32 offen
    ds_read_b64_tr_b16 v[104:105], v15 offset:18592
    ds_read_b64_tr_b16 v[106:107], v15 offset:23200
    s_waitcnt lgkmcnt(6)
    v_mfma_f32_16x16x32_bf16 v[116:119], v[92:95], v[32:35], v[116:119]
    v_mfma_f32_16x16x32_bf16 v[152:155], v[92:95], v[36:39], v[152:155]
    ds_read_b64_tr_b16 v[88:89], v15 offset:18624
    ds_read_b64_tr_b16 v[90:91], v15 offset:23232
    s_waitcnt lgkmcnt(6)
    v_mfma_f32_16x16x32_bf16 v[120:123], v[96:99], v[32:35], v[120:123]
    v_mfma_f32_16x16x32_bf16 v[156:159], v[96:99], v[36:39], v[156:159]
    ds_read_b64_tr_b16 v[92:93], v15 offset:18656
    ds_read_b64_tr_b16 v[94:95], v15 offset:23264
    s_waitcnt lgkmcnt(6)
    v_mfma_f32_16x16x32_bf16 v[124:127], v[100:103], v[32:35], v[124:127]
    v_mfma_f32_16x16x32_bf16 v[160:163], v[100:103], v[36:39], v[160:163]
    ds_read_b64_tr_b16 v[96:97], v15 offset:18688
    ds_read_b64_tr_b16 v[98:99], v15 offset:23296
    s_waitcnt lgkmcnt(6)
    v_mfma_f32_16x16x32_bf16 v[128:131], v[104:107], v[32:35], v[128:131]
    v_mfma_f32_16x16x32_bf16 v[164:167], v[104:107], v[36:39], v[164:167]
    s_waitcnt vmcnt(17)
    s_barrier
    ds_read_b64_tr_b16 v[100:101], v15 offset:36864
    ds_read_b64_tr_b16 v[102:103], v15 offset:41472
    s_waitcnt lgkmcnt(6)
    v_mfma_f32_16x16x32_bf16 v[132:135], v[88:91], v[32:35], v[132:135]
    s_add_u32 s30, s35, 6
    s_sub_u32 s33, s30, 72
    s_cmp_lt_u32 s30, 72
    s_cselect_b32 s12, s4, s6
    s_cselect_b32 s13, s5, s7
    s_cselect_b32 s14, s36, s37
    s_cselect_b32 s30, s30, s33
    s_mul_i32 s31, s30, 73728
    s_add_u32 m0, s29, 110592
    s_nop 0
    buffer_load_dwordx4 v10, s[12:15], s31 offen lds
    v_mfma_f32_16x16x32_bf16 v[168:171], v[88:91], v[36:39], v[168:171]
    s_add_u32 m0, s29, 111616
    s_nop 0
    buffer_load_dwordx4 v11, s[12:15], s31 offen lds
    ds_read_b64_tr_b16 v[104:105], v15 offset:36896
    ds_read_b64_tr_b16 v[106:107], v15 offset:41504
    s_waitcnt lgkmcnt(6)
    v_mfma_f32_16x16x32_bf16 v[136:139], v[92:95], v[32:35], v[136:139]
    s_add_u32 m0, s29, 112640
    s_mov_b64 exec, 0xffff
    buffer_load_dwordx4 v12, s[12:15], s31 offen lds
    s_mov_b64 exec, -1
    v_mfma_f32_16x16x32_bf16 v[172:175], v[92:95], v[36:39], v[172:175]
    s_add_u32 s32, s35, 6
    s_lshl_b32 s32, s32, 1
    s_add_u32 s32, s32, s39
    s_cmp_lt_u32 s32, 162
    s_cselect_b32 s32, s32, 0x100000
    s_lshl_b32 s32, s32, 10
    buffer_load_dwordx4 v[72:75], v13, s[8:11], s32 offen
    ds_read_b64_tr_b16 v[88:89], v15 offset:36928
    ds_read_b64_tr_b16 v[90:91], v15 offset:41536
    s_waitcnt lgkmcnt(6)
    v_mfma_f32_16x16x32_bf16 v[140:143], v[96:99], v[32:35], v[140:143]
    buffer_load_dwordx4 v[76:79], v14, s[8:11], s32 offen
    v_mfma_f32_16x16x32_bf16 v[176:179], v[96:99], v[36:39], v[176:179]
    s_add_u32 s30, s35, 7
    s_sub_u32 s33, s30, 72
    s_cmp_lt_u32 s30, 72
    s_cselect_b32 s12, s4, s6
    s_cselect_b32 s13, s5, s7
    s_cselect_b32 s14, s36, s37
    s_cselect_b32 s30, s30, s33
    s_mul_i32 s31, s30, 73728
    s_add_u32 m0, s29, 129024
    s_nop 0
    buffer_load_dwordx4 v10, s[12:15], s31 offen lds
    ds_read_b64_tr_b16 v[92:93], v15 offset:36960
    ds_read_b64_tr_b16 v[94:95], v15 offset:41568
    s_waitcnt vmcnt(21)
    s_waitcnt lgkmcnt(6)
    v_mfma_f32_16x16x32_bf16 v[108:111], v[100:103], v[40:43], v[108:111]
    s_add_u32 m0, s29, 130048
    s_nop 0
    buffer_load_dwordx4 v11, s[12:15], s31 offen lds
    v_mfma_f32_16x16x32_bf16 v[144:147], v[100:103], v[44:47], v[144:147]
    s_add_u32 m0, s29, 131072
    s_mov_b64 exec, 0xffff
    buffer_load_dwordx4 v12, s[12:15], s31 offen lds
    s_mov_b64 exec, -1
    ds_read_b64_tr_b16 v[96:97], v15 offset:36992
    ds_read_b64_tr_b16 v[98:99], v15 offset:41600
    s_waitcnt lgkmcnt(6)
    v_mfma_f32_16x16x32_bf16 v[112:115], v[104:107], v[40:43], v[112:115]
    s_add_u32 s32, s35, 7
    s_lshl_b32 s32, s32, 1
    s_add_u32 s32, s32, s39
    s_cmp_lt_u32 s32, 162
    s_cselect_b32 s32, s32, 0x100000
    s_lshl_b32 s32, s32, 10
    buffer_load_dwordx4 v[80:83], v13, s[8:11], s32 offen
    v_mfma_f32_16x16x32_bf16 v[148:151], v[104:107], v[44:47], v[148:151]
    buffer_load_dwordx4 v[84:87], v14, s[8:11], s32 offen
    ds_read_b64_tr_b16 v[100:101], v15 offset:37024
    ds_read_b64_tr_b16 v[102:103], v15 offset:41632
    s_waitcnt lgkmcnt(6)
    v_mfma_f32_16x16x32_bf16 v[116:119], v[88:91], v[40:43], v[116:119]
    v_mfma_f32_16x16x32_bf16 v[152:155], v[88:91], v[44:47], v[152:155]
    ds_read_b64_tr_b16 v[104:105], v15 offset:37056
    ds_read_b64_tr_b16 v[106:107], v15 offset:41664
    s_waitcnt lgkmcnt(6)
    v_mfma_f32_16x16x32_bf16 v[120:123], v[92:95], v[40:43], v[120:123]
    v_mfma_f32_16x16x32_bf16 v[156:159], v[92:95], v[44:47], v[156:159]
    ds_read_b64_tr_b16 v[88:89], v15 offset:37088
    ds_read_b64_tr_b16 v[90:91], v15 offset:41696
    s_waitcnt lgkmcnt(6)
    v_mfma_f32_16x16x32_bf16 v[124:127], v[96:99], v[40:43], v[124:127]
    v_mfma_f32_16x16x32_bf16 v[160:163], v[96:99], v[44:47], v[160:163]
    ds_read_b64_tr_b16 v[92:93], v15 offset:37120
    ds_read_b64_tr_b16 v[94:95], v15 offset:41728
    s_waitcnt lgkmcnt(6)
    v_mfma_f32_16x16x32_bf16 v[128:131], v[100:103], v[40:43], v[128:131]
    v_mfma_f32_16x16x32_bf16 v[164:167], v[100:103], v[44:47], v[164:167]
    s_waitcnt vmcnt(22)
    s_barrier
    ds_read_b64_tr_b16 v[96:97], v16 offset:0
    ds_read_b64_tr_b16 v[98:99], v16 offset:4608
    s_waitcnt lgkmcnt(6)
    v_mfma_f32_16x16x32_bf16 v[132:135], v[104:107], v[40:43], v[132:135]
    s_add_u32 s30, s35, 8
    s_sub_u32 s33, s30, 72
    s_cmp_lt_u32 s30, 72
    s_cselect_b32 s12, s4, s6
    s_cselect_b32 s13, s5, s7
    s_cselect_b32 s14, s36, s37
    s_cselect_b32 s30, s30, s33
    s_mul_i32 s31, s30, 73728
    s_add_u32 m0, s29, 0
    s_nop 0
    buffer_load_dwordx4 v10, s[12:15], s31 offen lds
    v_mfma_f32_16x16x32_bf16 v[168:171], v[104:107], v[44:47], v[168:171]
    s_add_u32 m0, s29, 1024
    s_nop 0
    buffer_load_dwordx4 v11, s[12:15], s31 offen lds
    ds_read_b64_tr_b16 v[100:101], v16 offset:32
    ds_read_b64_tr_b16 v[102:103], v16 offset:4640
    s_waitcnt lgkmcnt(6)
    v_mfma_f32_16x16x32_bf16 v[136:139], v[88:91], v[40:43], v[136:139]
    s_add_u32 m0, s29, 2048
    s_mov_b64 exec, 0xffff
    buffer_load_dwordx4 v12, s[12:15], s31 offen lds
    s_mov_b64 exec, -1
    v_mfma_f32_16x16x32_bf16 v[172:175], v[88:91], v[44:47], v[172:175]
    s_add_u32 s32, s35, 8
    s_lshl_b32 s32, s32, 1
    s_add_u32 s32, s32, s39
    s_cmp_lt_u32 s32, 162
    s_cselect_b32 s32, s32, 0x100000
    s_lshl_b32 s32, s32, 10
    buffer_load_dwordx4 v[24:27], v13, s[8:11], s32 offen
    ds_read_b64_tr_b16 v[104:105], v16 offset:64
    ds_read_b64_tr_b16 v[106:107], v16 offset:4672
    s_waitcnt lgkmcnt(6)
    v_mfma_f32_16x16x32_bf16 v[140:143], v[92:95], v[40:43], v[140:143]
    buffer_load_dwordx4 v[28:31], v14, s[8:11], s32 offen
    v_mfma_f32_16x16x32_bf16 v[176:179], v[92:95], v[44:47], v[176:179]
    s_add_u32 s30, s35, 9
    s_sub_u32 s33, s30, 72
    s_cmp_lt_u32 s30, 72
    s_cselect_b32 s12, s4, s6
    s_cselect_b32 s13, s5, s7
    s_cselect_b32 s14, s36, s37
    s_cselect_b32 s30, s30, s33
    s_mul_i32 s31, s30, 73728
    s_add_u32 m0, s29, 18432
    s_nop 0
    buffer_load_dwordx4 v10, s[12:15], s31 offen lds
    ds_read_b64_tr_b16 v[88:89], v16 offset:96
    ds_read_b64_tr_b16 v[90:91], v16 offset:4704
    s_waitcnt vmcnt(26)
    s_waitcnt lgkmcnt(6)
    v_mfma_f32_16x16x32_bf16 v[108:111], v[96:99], v[48:51], v[108:111]
    s_add_u32 m0, s29, 19456
    s_nop 0
    buffer_load_dwordx4 v11, s[12:15], s31 offen lds
    v_mfma_f32_16x16x32_bf16 v[144:147], v[96:99], v[52:55], v[144:147]
    s_add_u32 m0, s29, 20480
    s_mov_b64 exec, 0xffff
    buffer_load_dwordx4 v12, s[12:15], s31 offen lds
    s_mov_b64 exec, -1
    ds_read_b64_tr_b16 v[92:93], v16 offset:128
    ds_read_b64_tr_b16 v[94:95], v16 offset:4736
    s_waitcnt lgkmcnt(6)
    v_mfma_f32_16x16x32_bf16 v[112:115], v[100:103], v[48:51], v[112:115]
    s_add_u32 s32, s35, 9
    s_lshl_b32 s32, s32, 1
    s_add_u32 s32, s32, s39
    s_cmp_lt_u32 s32, 162
    s_cselect_b32 s32, s32, 0x100000
    s_lshl_b32 s32, s32, 10
    buffer_load_dwordx4 v[32:35], v13, s[8:11], s32 offen
    v_mfma_f32_16x16x32_bf16 v[148:151], v[100:103], v[52:55], v[148:151]
    buffer_load_dwordx4 v[36:39], v14, s[8:11], s32 offen
    ds_read_b64_tr_b16 v[96:97], v16 offset:160
    ds_read_b64_tr_b16 v[98:99], v16 offset:4768
    s_waitcnt lgkmcnt(6)
    v_mfma_f32_16x16x32_bf16 v[116:119], v[104:107], v[48:51], v[116:119]
    v_mfma_f32_16x16x32_bf16 v[152:155], v[104:107], v[52:55], v[152:155]
    ds_read_b64_tr_b16 v[100:101], v16 offset:192
    ds_read_b64_tr_b16 v[102:103], v16 offset:4800
    s_waitcnt lgkmcnt(6)
    v_mfma_f32_16x16x32_bf16 v[120:123], v[88:91], v[48:51], v[120:123]
    v_mfma_f32_16x16x32_bf16 v[156:159], v[88:91], v[52:55], v[156:159]
    ds_read_b64_tr_b16 v[104:105], v16 offset:224
    ds_read_b64_tr_b16 v[106:107], v16 offset:4832
    s_waitcnt lgkmcnt(6)
    v_mfma_f32_16x16x32_bf16 v[124:127], v[92:95], v[48:51], v[124:127]
    v_mfma_f32_16x16x32_bf16 v[160:163], v[92:95], v[52:55], v[160:163]
    ds_read_b64_tr_b16 v[88:89], v16 offset:256
    ds_read_b64_tr_b16 v[90:91], v16 offset:4864
    s_waitcnt lgkmcnt(6)
    v_mfma_f32_16x16x32_bf16 v[128:131], v[96:99], v[48:51], v[128:131]
    v_mfma_f32_16x16x32_bf16 v[164:167], v[96:99], v[52:55], v[164:167]
    s_waitcnt vmcnt(27)
    s_barrier
    ds_read_b64_tr_b16 v[92:93], v16 offset:18432
    ds_read_b64_tr_b16 v[94:95], v16 offset:23040
    s_waitcnt lgkmcnt(6)
    v_mfma_f32_16x16x32_bf16 v[132:135], v[100:103], v[48:51], v[132:135]
    s_add_u32 s30, s35, 10
    s_sub_u32 s33, s30, 72
    s_cmp_lt_u32 s30, 72
    s_cselect_b32 s12, s4, s6
    s_cselect_b32 s13, s5, s7
    s_cselect_b32 s14, s36, s37
    s_cselect_b32 s30, s30, s33
    s_mul_i32 s31, s30, 73728
    s_add_u32 m0, s29, 36864
    s_nop 0
    buffer_load_dwordx4 v10, s[12:15], s31 offen lds
    v_mfma_f32_16x16x32_bf16 v[168:171], v[100:103], v[52:55], v[168:171]
    s_add_u32 m0, s29, 37888
    s_nop 0
    buffer_load_dwordx4 v11, s[12:15], s31 offen lds
    ds_read_b64_tr_b16 v[96:97], v16 offset:18464
    ds_read_b64_tr_b16 v[98:99], v16 offset:23072
    s_waitcnt lgkmcnt(6)
    v_mfma_f32_16x16x32_bf16 v[136:139], v[104:107], v[48:51], v[136:139]
    s_add_u32 m0, s29, 38912
    s_mov_b64 exec, 0xffff
    buffer_load_dwordx4 v12, s[12:15], s31 offen lds
    s_mov_b64 exec, -1
    v_mfma_f32_16x16x32_bf16 v[172:175], v[104:107], v[52:55], v[172:175]
    s_add_u32 s32, s35, 10
    s_lshl_b32 s32, s32, 1
    s_add_u32 s32, s32, s39
    s_cmp_lt_u32 s32, 162
    s_cselect_b32 s32, s32, 0x100000
    s_lshl_b32 s32, s32, 10
    buffer_load_dwordx4 v[40:43], v13, s[8:11], s32 offen
    ds_read_b64_tr_b16 v[100:101], v16 offset:18496
    ds_read_b64_tr_b16 v[102:103], v16 offset:23104
    s_waitcnt lgkmcnt(6)
    v_mfma_f32_16x16x32_bf16 v[140:143], v[88:91], v[48:51], v[140:143]
    buffer_load_dwordx4 v[44:47], v14, s[8:11], s32 offen
    v_mfma_f32_16x16x32_bf16 v[176:179], v[88:91], v[52:55], v[176:179]
    ds_read_b64_tr_b16 v[104:105], v16 offset:18528
    ds_read_b64_tr_b16 v[106:107], v16 offset:23136
    s_waitcnt vmcnt(30)
    s_waitcnt lgkmcnt(6)
    v_mfma_f32_16x16x32_bf16 v[108:111], v[92:95], v[56:59], v[108:111]
    v_mfma_f32_16x16x32_bf16 v[144:147], v[92:95], v[60:63], v[144:147]
    ds_read_b64_tr_b16 v[88:89], v16 offset:18560
    ds_read_b64_tr_b16 v[90:91], v16 offset:23168
    s_waitcnt lgkmcnt(6)
    v_mfma_f32_16x16x32_bf16 v[112:115], v[96:99], v[56:59], v[112:115]
    v_mfma_f32_16x16x32_bf16 v[148:151], v[96:99], v[60:63], v[148:151]
    ds_read_b64_tr_b16 v[92:93], v16 offset:18592
    ds_read_b64_tr_b16 v[94:95], v16 offset:23200
    s_waitcnt lgkmcnt(6)
    v_mfma_f32_16x16x32_bf16 v[116:119], v[100:103], v[56:59], v[116:119]
    v_mfma_f32_16x16x32_bf16 v[152:155], v[100:103], v[60:63], v[152:155]
    ds_read_b64_tr_b16 v[96:97], v16 offset:18624
    ds_read_b64_tr_b16 v[98:99], v16 offset:23232
    s_waitcnt lgkmcnt(6)
    v_mfma_f32_16x16x32_bf16 v[120:123], v[104:107], v[56:59], v[120:123]
    v_mfma_f32_16x16x32_bf16 v[156:159], v[104:107], v[60:63], v[156:159]
    ds_read_b64_tr_b16 v[100:101], v16 offset:18656
    ds_read_b64_tr_b16 v[102:103], v16 offset:23264
    s_waitcnt lgkmcnt(6)
    v_mfma_f32_16x16x32_bf16 v[124:127], v[88:91], v[56:59], v[124:127]
    v_mfma_f32_16x16x32_bf16 v[160:163], v[88:91], v[60:63], v[160:163]
    ds_read_b64_tr_b16 v[104:105], v16 offset:18688
    ds_read_b64_tr_b16 v[106:107], v16 offset:23296
    s_waitcnt lgkmcnt(6)
    v_mfma_f32_16x16x32_bf16 v[128:131], v[92:95], v[56:59], v[128:131]
    v_mfma_f32_16x16x32_bf16 v[164:167], v[92:95], v[60:63], v[164:167]
    s_waitcnt vmcnt(27)
    s_barrier
    ds_read_b64_tr_b16 v[88:89], v16 offset:36864
    ds_read_b64_tr_b16 v[90:91], v16 offset:41472
    s_waitcnt lgkmcnt(6)
    v_mfma_f32_16x16x32_bf16 v[132:135], v[96:99], v[56:59], v[132:135]
    s_add_u32 s30, s35, 11
    s_sub_u32 s33, s30, 72
    s_cmp_lt_u32 s30, 72
    s_cselect_b32 s12, s4, s6
    s_cselect_b32 s13, s5, s7
    s_cselect_b32 s14, s36, s37
    s_cselect_b32 s30, s30, s33
    s_mul_i32 s31, s30, 73728
    s_add_u32 m0, s29, 55296
    s_nop 0
    buffer_load_dwordx4 v10, s[12:15], s31 offen lds
    v_mfma_f32_16x16x32_bf16 v[168:171], v[96:99], v[60:63], v[168:171]
    s_add_u32 m0, s29, 56320
    s_nop 0
    buffer_load_dwordx4 v11, s[12:15], s31 offen lds
    ds_read_b64_tr_b16 v[92:93], v16 offset:36896
    ds_read_b64_tr_b16 v[94:95], v16 offset:41504
    s_waitcnt lgkmcnt(6)
    v_mfma_f32_16x16x32_bf16 v[136:139], v[100:103], v[56:59], v[136:139]
    s_add_u32 m0, s29, 57344
    s_mov_b64 exec, 0xffff
    buffer_load_dwordx4 v12, s[12:15], s31 offen lds
    s_mov_b64 exec, -1
    v_mfma_f32_16x16x32_bf16 v[172:175], v[100:103], v[60:63], v[172:175]
    s_add_u32 s32, s35, 11
    s_lshl_b32 s32, s32, 1
    s_add_u32 s32, s32, s39
    s_cmp_lt_u32 s32, 162
    s_cselect_b32 s32, s32, 0x100000
    s_lshl_b32 s32, s32, 10
    buffer_load_dwordx4 v[48:51], v13, s[8:11], s32 offen
    ds_read_b64_tr_b16 v[96:97], v16 offset:36928
    ds_read_b64_tr_b16 v[98:99], v16 offset:41536
    s_waitcnt lgkmcnt(6)
    v_mfma_f32_16x16x32_bf16 v[140:143], v[104:107], v[56:59], v[140:143]
    buffer_load_dwordx4 v[52:55], v14, s[8:11], s32 offen
    v_mfma_f32_16x16x32_bf16 v[176:179], v[104:107], v[60:63], v[176:179]
    ds_read_b64_tr_b16 v[100:101], v16 offset:36960
    ds_read_b64_tr_b16 v[102:103], v16 offset:41568
    s_waitcnt vmcnt(30)
    s_waitcnt lgkmcnt(6)
    v_mfma_f32_16x16x32_bf16 v[108:111], v[88:91], v[64:67], v[108:111]
    v_mfma_f32_16x16x32_bf16 v[144:147], v[88:91], v[68:71], v[144:147]
    ds_read_b64_tr_b16 v[104:105], v16 offset:36992
    ds_read_b64_tr_b16 v[106:107], v16 offset:41600
    s_waitcnt lgkmcnt(6)
    v_mfma_f32_16x16x32_bf16 v[112:115], v[92:95], v[64:67], v[112:115]
    v_mfma_f32_16x16x32_bf16 v[148:151], v[92:95], v[68:71], v[148:151]
    ds_read_b64_tr_b16 v[88:89], v16 offset:37024
    ds_read_b64_tr_b16 v[90:91], v16 offset:41632
    s_waitcnt lgkmcnt(6)
    v_mfma_f32_16x16x32_bf16 v[116:119], v[96:99], v[64:67], v[116:119]
    v_mfma_f32_16x16x32_bf16 v[152:155], v[96:99], v[68:71], v[152:155]
    ds_read_b64_tr_b16 v[92:93], v16 offset:37056
    ds_read_b64_tr_b16 v[94:95], v16 offset:41664
    s_waitcnt lgkmcnt(6)
    v_mfma_f32_16x16x32_bf16 v[120:123], v[100:103], v[64:67], v[120:123]
    v_mfma_f32_16x16x32_bf16 v[156:159], v[100:103], v[68:71], v[156:159]
    ds_read_b64_tr_b16 v[96:97], v16 offset:37088
    ds_read_b64_tr_b16 v[98:99], v16 offset:41696
    s_waitcnt lgkmcnt(6)
    v_mfma_f32_16x16x32_bf16 v[124:127], v[104:107], v[64:67], v[124:127]
    v_mfma_f32_16x16x32_bf16 v[160:163], v[104:107], v[68:71], v[160:163]
    ds_read_b64_tr_b16 v[100:101], v16 offset:37120
    ds_read_b64_tr_b16 v[102:103], v16 offset:41728
    s_waitcnt lgkmcnt(6)
    v_mfma_f32_16x16x32_bf16 v[128:131], v[88:91], v[64:67], v[128:131]
    v_mfma_f32_16x16x32_bf16 v[164:167], v[88:91], v[68:71], v[164:167]
    s_waitcnt vmcnt(27)
    s_barrier
    ds_read_b64_tr_b16 v[104:105], v17 offset:0
    ds_read_b64_tr_b16 v[106:107], v17 offset:4608
    s_waitcnt lgkmcnt(6)
    v_mfma_f32_16x16x32_bf16 v[132:135], v[92:95], v[64:67], v[132:135]
    s_add_u32 s30, s35, 12
    s_sub_u32 s33, s30, 72
    s_cmp_lt_u32 s30, 72
    s_cselect_b32 s12, s4, s6
    s_cselect_b32 s13, s5, s7
    s_cselect_b32 s14, s36, s37
    s_cselect_b32 s30, s30, s33
    s_mul_i32 s31, s30, 73728
    s_add_u32 m0, s29, 73728
    s_nop 0
    buffer_load_dwordx4 v10, s[12:15], s31 offen lds
    v_mfma_f32_16x16x32_bf16 v[168:171], v[92:95], v[68:71], v[168:171]
    s_add_u32 m0, s29, 74752
    s_nop 0
    buffer_load_dwordx4 v11, s[12:15], s31 offen lds
    ds_read_b64_tr_b16 v[88:89], v17 offset:32
    ds_read_b64_tr_b16 v[90:91], v17 offset:4640
    s_waitcnt lgkmcnt(6)
    v_mfma_f32_16x16x32_bf16 v[136:139], v[96:99], v[64:67], v[136:139]
    s_add_u32 m0, s29, 75776
    s_mov_b64 exec, 0xffff
    buffer_load_dwordx4 v12, s[12:15], s31 offen lds
    s_mov_b64 exec, -1
    v_mfma_f32_16x16x32_bf16 v[172:175], v[96:99], v[68:71], v[172:175]
    s_add_u32 s32, s35, 12
    s_lshl_b32 s32, s32, 1
    s_add_u32 s32, s32, s39
    s_cmp_lt_u32 s32, 162
    s_cselect_b32 s32, s32, 0x100000
    s_lshl_b32 s32, s32, 10
    buffer_load_dwordx4 v[56:59], v13, s[8:11], s32 offen
    ds_read_b64_tr_b16 v[92:93], v17 offset:64
    ds_read_b64_tr_b16 v[94:95], v17 offset:4672
    s_waitcnt lgkmcnt(6)
    v_mfma_f32_16x16x32_bf16 v[140:143], v[100:103], v[64:67], v[140:143]
    buffer_load_dwordx4 v[60:63], v14, s[8:11], s32 offen
    v_mfma_f32_16x16x32_bf16 v[176:179], v[100:103], v[68:71], v[176:179]
    ds_read_b64_tr_b16 v[96:97], v17 offset:96
    ds_read_b64_tr_b16 v[98:99], v17 offset:4704
    s_waitcnt vmcnt(30)
    s_waitcnt lgkmcnt(6)
    v_mfma_f32_16x16x32_bf16 v[108:111], v[104:107], v[72:75], v[108:111]
    v_mfma_f32_16x16x32_bf16 v[144:147], v[104:107], v[76:79], v[144:147]
    ds_read_b64_tr_b16 v[100:101], v17 offset:128
    ds_read_b64_tr_b16 v[102:103], v17 offset:4736
    s_waitcnt lgkmcnt(6)
    v_mfma_f32_16x16x32_bf16 v[112:115], v[88:91], v[72:75], v[112:115]
    v_mfma_f32_16x16x32_bf16 v[148:151], v[88:91], v[76:79], v[148:151]
    ds_read_b64_tr_b16 v[104:105], v17 offset:160
    ds_read_b64_tr_b16 v[106:107], v17 offset:4768
    s_waitcnt lgkmcnt(6)
    v_mfma_f32_16x16x32_bf16 v[116:119], v[92:95], v[72:75], v[116:119]
    v_mfma_f32_16x16x32_bf16 v[152:155], v[92:95], v[76:79], v[152:155]
    ds_read_b64_tr_b16 v[88:89], v17 offset:192
    ds_read_b64_tr_b16 v[90:91], v17 offset:4800
    s_waitcnt lgkmcnt(6)
    v_mfma_f32_16x16x32_bf16 v[120:123], v[96:99], v[72:75], v[120:123]
    v_mfma_f32_16x16x32_bf16 v[156:159], v[96:99], v[76:79], v[156:159]
    ds_read_b64_tr_b16 v[92:93], v17 offset:224
    ds_read_b64_tr_b16 v[94:95], v17 offset:4832
    s_waitcnt lgkmcnt(6)
    v_mfma_f32_16x16x32_bf16 v[124:127], v[100:103], v[72:75], v[124:127]
    v_mfma_f32_16x16x32_bf16 v[160:163], v[100:103], v[76:79], v[160:163]
    ds_read_b64_tr_b16 v[96:97], v17 offset:256
    ds_read_b64_tr_b16 v[98:99], v17 offset:4864
    s_waitcnt lgkmcnt(6)
    v_mfma_f32_16x16x32_bf16 v[128:131], v[104:107], v[72:75], v[128:131]
    v_mfma_f32_16x16x32_bf16 v[164:167], v[104:107], v[76:79], v[164:167]
    s_waitcnt vmcnt(27)
    s_barrier
    ds_read_b64_tr_b16 v[100:101], v17 offset:18432
    ds_read_b64_tr_b16 v[102:103], v17 offset:23040
    s_waitcnt lgkmcnt(6)
    v_mfma_f32_16x16x32_bf16 v[132:135], v[88:91], v[72:75], v[132:135]
    s_add_u32 s30, s35, 13
    s_sub_u32 s33, s30, 72
    s_cmp_lt_u32 s30, 72
    s_cselect_b32 s12, s4, s6
    s_cselect_b32 s13, s5, s7
    s_cselect_b32 s14, s36, s37
    s_cselect_b32 s30, s30, s33
    s_mul_i32 s31, s30, 73728
    s_add_u32 m0, s29, 92160
    s_nop 0
    buffer_load_dwordx4 v10, s[12:15], s31 offen lds
    v_mfma_f32_16x16x32_bf16 v[168:171], v[88:91], v[76:79], v[168:171]
    s_add_u32 m0, s29, 93184
    s_nop 0
    buffer_load_dwordx4 v11, s[12:15], s31 offen lds
    ds_read_b64_tr_b16 v[104:105], v17 offset:18464
    ds_read_b64_tr_b16 v[106:107], v17 offset:23072
    s_waitcnt lgkmcnt(6)
    v_mfma_f32_16x16x32_bf16 v[136:139], v[92:95], v[72:75], v[136:139]
    s_add_u32 m0, s29, 94208
    s_mov_b64 exec, 0xffff
    buffer_load_dwordx4 v12, s[12:15], s31 offen lds
    s_mov_b64 exec, -1
    v_mfma_f32_16x16x32_bf16 v[172:175], v[92:95], v[76:79], v[172:175]
    s_add_u32 s32, s35, 13
    s_lshl_b32 s32, s32, 1
    s_add_u32 s32, s32, s39
    s_cmp_lt_u32 s32, 162
    s_cselect_b32 s32, s32, 0x100000
    s_lshl_b32 s32, s32, 10
    buffer_load_dwordx4 v[64:67], v13, s[8:11], s32 offen
    ds_read_b64_tr_b16 v[88:89], v17 offset:18496
    ds_read_b64_tr_b16 v[90:91], v17 offset:23104
    s_waitcnt lgkmcnt(6)
    v_mfma_f32_16x16x32_bf16 v[140:143], v[96:99], v[72:75], v[140:143]
    buffer_load_dwordx4 v[68:71], v14, s[8:11], s32 offen
    v_mfma_f32_16x16x32_bf16 v[176:179], v[96:99], v[76:79], v[176:179]
    ds_read_b64_tr_b16 v[92:93], v17 offset:18528
    ds_read_b64_tr_b16 v[94:95], v17 offset:23136
    s_waitcnt vmcnt(30)
    s_waitcnt lgkmcnt(6)
    v_mfma_f32_16x16x32_bf16 v[108:111], v[100:103], v[80:83], v[108:111]
    v_mfma_f32_16x16x32_bf16 v[144:147], v[100:103], v[84:87], v[144:147]
    ds_read_b64_tr_b16 v[96:97], v17 offset:18560
    ds_read_b64_tr_b16 v[98:99], v17 offset:23168
    s_waitcnt lgkmcnt(6)
    v_mfma_f32_16x16x32_bf16 v[112:115], v[104:107], v[80:83], v[112:115]
    v_mfma_f32_16x16x32_bf16 v[148:151], v[104:107], v[84:87], v[148:151]
    ds_read_b64_tr_b16 v[100:101], v17 offset:18592
    ds_read_b64_tr_b16 v[102:103], v17 offset:23200
    s_waitcnt lgkmcnt(6)
    v_mfma_f32_16x16x32_bf16 v[116:119], v[88:91], v[80:83], v[116:119]
    v_mfma_f32_16x16x32_bf16 v[152:155], v[88:91], v[84:87], v[152:155]
    ds_read_b64_tr_b16 v[104:105], v17 offset:18624
    ds_read_b64_tr_b16 v[106:107], v17 offset:23232
    s_waitcnt lgkmcnt(6)
    v_mfma_f32_16x16x32_bf16 v[120:123], v[92:95], v[80:83], v[120:123]
    v_mfma_f32_16x16x32_bf16 v[156:159], v[92:95], v[84:87], v[156:159]
    ds_read_b64_tr_b16 v[88:89], v17 offset:18656
    ds_read_b64_tr_b16 v[90:91], v17 offset:23264
    s_waitcnt lgkmcnt(6)
    v_mfma_f32_16x16x32_bf16 v[124:127], v[96:99], v[80:83], v[124:127]
    v_mfma_f32_16x16x32_bf16 v[160:163], v[96:99], v[84:87], v[160:163]
    ds_read_b64_tr_b16 v[92:93], v17 offset:18688
    ds_read_b64_tr_b16 v[94:95], v17 offset:23296
    s_waitcnt lgkmcnt(6)
    v_mfma_f32_16x16x32_bf16 v[128:131], v[100:103], v[80:83], v[128:131]
    v_mfma_f32_16x16x32_bf16 v[164:167], v[100:103], v[84:87], v[164:167]
    s_waitcnt vmcnt(27)
    s_barrier
    ds_read_b64_tr_b16 v[96:97], v15 offset:0
    ds_read_b64_tr_b16 v[98:99], v15 offset:4608
    s_waitcnt lgkmcnt(6)
    v_mfma_f32_16x16x32_bf16 v[132:135], v[104:107], v[80:83], v[132:135]
    s_add_u32 s30, s35, 14
    s_sub_u32 s33, s30, 72
    s_cmp_lt_u32 s30, 72
    s_cselect_b32 s12, s4, s6
    s_cselect_b32 s13, s5, s7
    s_cselect_b32 s14, s36, s37
    s_cselect_b32 s30, s30, s33
    s_mul_i32 s31, s30, 73728
    s_add_u32 m0, s29, 110592
    s_nop 0
    buffer_load_dwordx4 v10, s[12:15], s31 offen lds
    v_mfma_f32_16x16x32_bf16 v[168:171], v[104:107], v[84:87], v[168:171]
    s_add_u32 m0, s29, 111616
    s_nop 0
    buffer_load_dwordx4 v11, s[12:15], s31 offen lds
    ds_read_b64_tr_b16 v[100:101], v15 offset:32
    ds_read_b64_tr_b16 v[102:103], v15 offset:4640
    s_waitcnt lgkmcnt(6)
    v_mfma_f32_16x16x32_bf16 v[136:139], v[88:91], v[80:83], v[136:139]
    s_add_u32 m0, s29, 112640
    s_mov_b64 exec, 0xffff
    buffer_load_dwordx4 v12, s[12:15], s31 offen lds
    s_mov_b64 exec, -1
    v_mfma_f32_16x16x32_bf16 v[172:175], v[88:91], v[84:87], v[172:175]
    s_add_u32 s32, s35, 14
    s_lshl_b32 s32, s32, 1
    s_add_u32 s32, s32, s39
    s_cmp_lt_u32 s32, 162
    s_cselect_b32 s32, s32, 0x100000
    s_lshl_b32 s32, s32, 10
    buffer_load_dwordx4 v[72:75], v13, s[8:11], s32 offen
    ds_read_b64_tr_b16 v[104:105], v15 offset:64
    ds_read_b64_tr_b16 v[106:107], v15 offset:4672
    s_waitcnt lgkmcnt(6)
    v_mfma_f32_16x16x32_bf16 v[140:143], v[92:95], v[80:83], v[140:143]
    buffer_load_dwordx4 v[76:79], v14, s[8:11], s32 offen
    v_mfma_f32_16x16x32_bf16 v[176:179], v[92:95], v[84:87], v[176:179]
    ds_read_b64_tr_b16 v[88:89], v15 offset:96
    ds_read_b64_tr_b16 v[90:91], v15 offset:4704
    s_waitcnt vmcnt(30)
    s_waitcnt lgkmcnt(6)
    v_mfma_f32_16x16x32_bf16 v[108:111], v[96:99], v[24:27], v[108:111]
    v_mfma_f32_16x16x32_bf16 v[144:147], v[96:99], v[28:31], v[144:147]
    ds_read_b64_tr_b16 v[92:93], v15 offset:128
    ds_read_b64_tr_b16 v[94:95], v15 offset:4736
    s_waitcnt lgkmcnt(6)
    v_mfma_f32_16x16x32_bf16 v[112:115], v[100:103], v[24:27], v[112:115]
    v_mfma_f32_16x16x32_bf16 v[148:151], v[100:103], v[28:31], v[148:151]
    ds_read_b64_tr_b16 v[96:97], v15 offset:160
    ds_read_b64_tr_b16 v[98:99], v15 offset:4768
    s_waitcnt lgkmcnt(6)
    v_mfma_f32_16x16x32_bf16 v[116:119], v[104:107], v[24:27], v[116:119]
    v_mfma_f32_16x16x32_bf16 v[152:155], v[104:107], v[28:31], v[152:155]
    ds_read_b64_tr_b16 v[100:101], v15 offset:192
    ds_read_b64_tr_b16 v[102:103], v15 offset:4800
    s_waitcnt lgkmcnt(6)
    v_mfma_f32_16x16x32_bf16 v[120:123], v[88:91], v[24:27], v[120:123]
    v_mfma_f32_16x16x32_bf16 v[156:159], v[88:91], v[28:31], v[156:159]
    ds_read_b64_tr_b16 v[104:105], v15 offset:224
    ds_read_b64_tr_b16 v[106:107], v15 offset:4832
    s_waitcnt lgkmcnt(6)
    v_mfma_f32_16x16x32_bf16 v[124:127], v[92:95], v[24:27], v[124:127]
    v_mfma_f32_16x16x32_bf16 v[160:163], v[92:95], v[28:31], v[160:163]
    ds_read_b64_tr_b16 v[88:89], v15 offset:256
    ds_read_b64_tr_b16 v[90:91], v15 offset:4864
    s_waitcnt lgkmcnt(6)
    v_mfma_f32_16x16x32_bf16 v[128:131], v[96:99], v[24:27], v[128:131]
    v_mfma_f32_16x16x32_bf16 v[164:167], v[96:99], v[28:31], v[164:167]
    s_waitcnt vmcnt(27)
    s_barrier
    ds_read_b64_tr_b16 v[92:93], v15 offset:18432
    ds_read_b64_tr_b16 v[94:95], v15 offset:23040
    s_waitcnt lgkmcnt(6)
    v_mfma_f32_16x16x32_bf16 v[132:135], v[100:103], v[24:27], v[132:135]
    s_add_u32 s30, s35, 15
    s_sub_u32 s33, s30, 72
    s_cmp_lt_u32 s30, 72
    s_cselect_b32 s12, s4, s6
    s_cselect_b32 s13, s5, s7
    s_cselect_b32 s14, s36, s37
    s_cselect_b32 s30, s30, s33
    s_mul_i32 s31, s30, 73728
    s_add_u32 m0, s29, 129024
    s_nop 0
    buffer_load_dwordx4 v10, s[12:15], s31 offen lds
    v_mfma_f32_16x16x32_bf16 v[168:171], v[100:103], v[28:31], v[168:171]
    s_add_u32 m0, s29, 130048
    s_nop 0
    buffer_load_dwordx4 v11, s[12:15], s31 offen lds
    ds_read_b64_tr_b16 v[96:97], v15 offset:18464
    ds_read_b64_tr_b16 v[98:99], v15 offset:23072
    s_waitcnt lgkmcnt(6)
    v_mfma_f32_16x16x32_bf16 v[136:139], v[104:107], v[24:27], v[136:139]
    s_add_u32 m0, s29, 131072
    s_mov_b64 exec, 0xffff
    buffer_load_dwordx4 v12, s[12:15], s31 offen lds
    s_mov_b64 exec, -1
    v_mfma_f32_16x16x32_bf16 v[172:175], v[104:107], v[28:31], v[172:175]
    s_add_u32 s32, s35, 15
    s_lshl_b32 s32, s32, 1
    s_add_u32 s32, s32, s39
    s_cmp_lt_u32 s32, 162
    s_cselect_b32 s32, s32, 0x100000
    s_lshl_b32 s32, s32, 10
    buffer_load_dwordx4 v[80:83], v13, s[8:11], s32 offen
    ds_read_b64_tr_b16 v[100:101], v15 offset:18496
    ds_read_b64_tr_b16 v[102:103], v15 offset:23104
    s_waitcnt lgkmcnt(6)
    v_mfma_f32_16x16x32_bf16 v[140:143], v[88:91], v[24:27], v[140:143]
    buffer_load_dwordx4 v[84:87], v14, s[8:11], s32 offen
    v_mfma_f32_16x16x32_bf16 v[176:179], v[88:91], v[28:31], v[176:179]
    ds_read_b64_tr_b16 v[104:105], v15 offset:18528
    ds_read_b64_tr_b16 v[106:107], v15 offset:23136
    s_waitcnt vmcnt(30)
    s_waitcnt lgkmcnt(6)
    v_mfma_f32_16x16x32_bf16 v[108:111], v[92:95], v[32:35], v[108:111]
    v_mfma_f32_16x16x32_bf16 v[144:147], v[92:95], v[36:39], v[144:147]
    ds_read_b64_tr_b16 v[88:89], v15 offset:18560
    ds_read_b64_tr_b16 v[90:91], v15 offset:23168
    s_waitcnt lgkmcnt(6)
    v_mfma_f32_16x16x32_bf16 v[112:115], v[96:99], v[32:35], v[112:115]
    v_mfma_f32_16x16x32_bf16 v[148:151], v[96:99], v[36:39], v[148:151]
    ds_read_b64_tr_b16 v[92:93], v15 offset:18592
    ds_read_b64_tr_b16 v[94:95], v15 offset:23200
    s_waitcnt lgkmcnt(6)
    v_mfma_f32_16x16x32_bf16 v[116:119], v[100:103], v[32:35], v[116:119]
    v_mfma_f32_16x16x32_bf16 v[152:155], v[100:103], v[36:39], v[152:155]
    ds_read_b64_tr_b16 v[96:97], v15 offset:18624
    ds_read_b64_tr_b16 v[98:99], v15 offset:23232
    s_waitcnt lgkmcnt(6)
    v_mfma_f32_16x16x32_bf16 v[120:123], v[104:107], v[32:35], v[120:123]
    v_mfma_f32_16x16x32_bf16 v[156:159], v[104:107], v[36:39], v[156:159]
    ds_read_b64_tr_b16 v[100:101], v15 offset:18656
    ds_read_b64_tr_b16 v[102:103], v15 offset:23264
    s_waitcnt lgkmcnt(6)
    v_mfma_f32_16x16x32_bf16 v[124:127], v[88:91], v[32:35], v[124:127]
    v_mfma_f32_16x16x32_bf16 v[160:163], v[88:91], v[36:39], v[160:163]
    ds_read_b64_tr_b16 v[104:105], v15 offset:18688
    ds_read_b64_tr_b16 v[106:107], v15 offset:23296
    s_waitcnt lgkmcnt(6)
    v_mfma_f32_16x16x32_bf16 v[128:131], v[92:95], v[32:35], v[128:131]
    v_mfma_f32_16x16x32_bf16 v[164:167], v[92:95], v[36:39], v[164:167]
    s_waitcnt vmcnt(27)
    s_barrier
    ds_read_b64_tr_b16 v[88:89], v15 offset:36864
    ds_read_b64_tr_b16 v[90:91], v15 offset:41472
    s_waitcnt lgkmcnt(6)
    v_mfma_f32_16x16x32_bf16 v[132:135], v[96:99], v[32:35], v[132:135]
    s_add_u32 s30, s35, 16
    s_sub_u32 s33, s30, 72
    s_cmp_lt_u32 s30, 72
    s_cselect_b32 s12, s4, s6
    s_cselect_b32 s13, s5, s7
    s_cselect_b32 s14, s36, s37
    s_cselect_b32 s30, s30, s33
    s_mul_i32 s31, s30, 73728
    s_add_u32 m0, s29, 0
    s_nop 0
    buffer_load_dwordx4 v10, s[12:15], s31 offen lds
    v_mfma_f32_16x16x32_bf16 v[168:171], v[96:99], v[36:39], v[168:171]
    s_add_u32 m0, s29, 1024
    s_nop 0
    buffer_load_dwordx4 v11, s[12:15], s31 offen lds
    ds_read_b64_tr_b16 v[92:93], v15 offset:36896
    ds_read_b64_tr_b16 v[94:95], v15 offset:41504
    s_waitcnt lgkmcnt(6)
    v_mfma_f32_16x16x32_bf16 v[136:139], v[100:103], v[32:35], v[136:139]
    s_add_u32 m0, s29, 2048
    s_mov_b64 exec, 0xffff
    buffer_load_dwordx4 v12, s[12:15], s31 offen lds
    s_mov_b64 exec, -1
    v_mfma_f32_16x16x32_bf16 v[172:175], v[100:103], v[36:39], v[172:175]
    s_add_u32 s32, s35, 16
    s_lshl_b32 s32, s32, 1
    s_add_u32 s32, s32, s39
    s_cmp_lt_u32 s32, 162
    s_cselect_b32 s32, s32, 0x100000
    s_lshl_b32 s32, s32, 10
    buffer_load_dwordx4 v[24:27], v13, s[8:11], s32 offen
    ds_read_b64_tr_b16 v[96:97], v15 offset:36928
    ds_read_b64_tr_b16 v[98:99], v15 offset:41536
    s_waitcnt lgkmcnt(6)
    v_mfma_f32_16x16x32_bf16 v[140:143], v[104:107], v[32:35], v[140:143]
    buffer_load_dwordx4 v[28:31], v14, s[8:11], s32 offen
    v_mfma_f32_16x16x32_bf16 v[176:179], v[104:107], v[36:39], v[176:179]
    ds_read_b64_tr_b16 v[100:101], v15 offset:36960
    ds_read_b64_tr_b16 v[102:103], v15 offset:41568
    s_waitcnt vmcnt(30)
    s_waitcnt lgkmcnt(6)
    v_mfma_f32_16x16x32_bf16 v[108:111], v[88:91], v[40:43], v[108:111]
    v_mfma_f32_16x16x32_bf16 v[144:147], v[88:91], v[44:47], v[144:147]
    ds_read_b64_tr_b16 v[104:105], v15 offset:36992
    ds_read_b64_tr_b16 v[106:107], v15 offset:41600
    s_waitcnt lgkmcnt(6)
    v_mfma_f32_16x16x32_bf16 v[112:115], v[92:95], v[40:43], v[112:115]
    v_mfma_f32_16x16x32_bf16 v[148:151], v[92:95], v[44:47], v[148:151]
    ds_read_b64_tr_b16 v[88:89], v15 offset:37024
    ds_read_b64_tr_b16 v[90:91], v15 offset:41632
    s_waitcnt lgkmcnt(6)
    v_mfma_f32_16x16x32_bf16 v[116:119], v[96:99], v[40:43], v[116:119]
    v_mfma_f32_16x16x32_bf16 v[152:155], v[96:99], v[44:47], v[152:155]
    ds_read_b64_tr_b16 v[92:93], v15 offset:37056
    ds_read_b64_tr_b16 v[94:95], v15 offset:41664
    s_waitcnt lgkmcnt(6)
    v_mfma_f32_16x16x32_bf16 v[120:123], v[100:103], v[40:43], v[120:123]
    v_mfma_f32_16x16x32_bf16 v[156:159], v[100:103], v[44:47], v[156:159]
    ds_read_b64_tr_b16 v[96:97], v15 offset:37088
    ds_read_b64_tr_b16 v[98:99], v15 offset:41696
    s_waitcnt lgkmcnt(6)
    v_mfma_f32_16x16x32_bf16 v[124:127], v[104:107], v[40:43], v[124:127]
    v_mfma_f32_16x16x32_bf16 v[160:163], v[104:107], v[44:47], v[160:163]
    ds_read_b64_tr_b16 v[100:101], v15 offset:37120
    ds_read_b64_tr_b16 v[102:103], v15 offset:41728
    s_waitcnt lgkmcnt(6)
    v_mfma_f32_16x16x32_bf16 v[128:131], v[88:91], v[40:43], v[128:131]
    v_mfma_f32_16x16x32_bf16 v[164:167], v[88:91], v[44:47], v[164:167]
    s_waitcnt vmcnt(27)
    s_barrier
    ds_read_b64_tr_b16 v[104:105], v16 offset:0
    ds_read_b64_tr_b16 v[106:107], v16 offset:4608
    s_waitcnt lgkmcnt(6)
    v_mfma_f32_16x16x32_bf16 v[132:135], v[92:95], v[40:43], v[132:135]
    s_add_u32 s30, s35, 17
    s_sub_u32 s33, s30, 72
    s_cmp_lt_u32 s30, 72
    s_cselect_b32 s12, s4, s6
    s_cselect_b32 s13, s5, s7
    s_cselect_b32 s14, s36, s37
    s_cselect_b32 s30, s30, s33
    s_mul_i32 s31, s30, 73728
    s_add_u32 m0, s29, 18432
    s_nop 0
    buffer_load_dwordx4 v10, s[12:15], s31 offen lds
    v_mfma_f32_16x16x32_bf16 v[168:171], v[92:95], v[44:47], v[168:171]
    s_add_u32 m0, s29, 19456
    s_nop 0
    buffer_load_dwordx4 v11, s[12:15], s31 offen lds
    ds_read_b64_tr_b16 v[88:89], v16 offset:32
    ds_read_b64_tr_b16 v[90:91], v16 offset:4640
    s_waitcnt lgkmcnt(6)
    v_mfma_f32_16x16x32_bf16 v[136:139], v[96:99], v[40:43], v[136:139]
    s_add_u32 m0, s29, 20480
    s_mov_b64 exec, 0xffff
    buffer_load_dwordx4 v12, s[12:15], s31 offen lds
    s_mov_b64 exec, -1
    v_mfma_f32_16x16x32_bf16 v[172:175], v[96:99], v[44:47], v[172:175]
    s_add_u32 s32, s35, 17
    s_lshl_b32 s32, s32, 1
    s_add_u32 s32, s32, s39
    s_cmp_lt_u32 s32, 162
    s_cselect_b32 s32, s32, 0x100000
    s_lshl_b32 s32, s32, 10
    buffer_load_dwordx4 v[32:35], v13, s[8:11], s32 offen
    ds_read_b64_tr_b16 v[92:93], v16 offset:64
    ds_read_b64_tr_b16 v[94:95], v16 offset:4672
    s_waitcnt lgkmcnt(6)
    v_mfma_f32_16x16x32_bf16 v[140:143], v[100:103], v[40:43], v[140:143]
    buffer_load_dwordx4 v[36:39], v14, s[8:11], s32 offen
    v_mfma_f32_16x16x32_bf16 v[176:179], v[100:103], v[44:47], v[176:179]
    ds_read_b64_tr_b16 v[96:97], v16 offset:96
    ds_read_b64_tr_b16 v[98:99], v16 offset:4704
    s_waitcnt vmcnt(30)
    s_waitcnt lgkmcnt(6)
    v_mfma_f32_16x16x32_bf16 v[108:111], v[104:107], v[48:51], v[108:111]
    v_mfma_f32_16x16x32_bf16 v[144:147], v[104:107], v[52:55], v[144:147]
    ds_read_b64_tr_b16 v[100:101], v16 offset:128
    ds_read_b64_tr_b16 v[102:103], v16 offset:4736
    s_waitcnt lgkmcnt(6)
    v_mfma_f32_16x16x32_bf16 v[112:115], v[88:91], v[48:51], v[112:115]
    v_mfma_f32_16x16x32_bf16 v[148:151], v[88:91], v[52:55], v[148:151]
    ds_read_b64_tr_b16 v[104:105], v16 offset:160
    ds_read_b64_tr_b16 v[106:107], v16 offset:4768
    s_waitcnt lgkmcnt(6)
    v_mfma_f32_16x16x32_bf16 v[116:119], v[92:95], v[48:51], v[116:119]
    v_mfma_f32_16x16x32_bf16 v[152:155], v[92:95], v[52:55], v[152:155]
    ds_read_b64_tr_b16 v[88:89], v16 offset:192
    ds_read_b64_tr_b16 v[90:91], v16 offset:4800
    s_waitcnt lgkmcnt(6)
    v_mfma_f32_16x16x32_bf16 v[120:123], v[96:99], v[48:51], v[120:123]
    v_mfma_f32_16x16x32_bf16 v[156:159], v[96:99], v[52:55], v[156:159]
    ds_read_b64_tr_b16 v[92:93], v16 offset:224
    ds_read_b64_tr_b16 v[94:95], v16 offset:4832
    s_waitcnt lgkmcnt(6)
    v_mfma_f32_16x16x32_bf16 v[124:127], v[100:103], v[48:51], v[124:127]
    v_mfma_f32_16x16x32_bf16 v[160:163], v[100:103], v[52:55], v[160:163]
    ds_read_b64_tr_b16 v[96:97], v16 offset:256
    ds_read_b64_tr_b16 v[98:99], v16 offset:4864
    s_waitcnt lgkmcnt(6)
    v_mfma_f32_16x16x32_bf16 v[128:131], v[104:107], v[48:51], v[128:131]
    v_mfma_f32_16x16x32_bf16 v[164:167], v[104:107], v[52:55], v[164:167]
    s_waitcnt vmcnt(27)
    s_barrier
    ds_read_b64_tr_b16 v[100:101], v16 offset:18432
    ds_read_b64_tr_b16 v[102:103], v16 offset:23040
    s_waitcnt lgkmcnt(6)
    v_mfma_f32_16x16x32_bf16 v[132:135], v[88:91], v[48:51], v[132:135]
    s_add_u32 s30, s35, 18
    s_sub_u32 s33, s30, 72
    s_cmp_lt_u32 s30, 72
    s_cselect_b32 s12, s4, s6
    s_cselect_b32 s13, s5, s7
    s_cselect_b32 s14, s36, s37
    s_cselect_b32 s30, s30, s33
    s_mul_i32 s31, s30, 73728
    s_add_u32 m0, s29, 36864
    s_nop 0
    buffer_load_dwordx4 v10, s[12:15], s31 offen lds
    v_mfma_f32_16x16x32_bf16 v[168:171], v[88:91], v[52:55], v[168:171]
    s_add_u32 m0, s29, 37888
    s_nop 0
    buffer_load_dwordx4 v11, s[12:15], s31 offen lds
    ds_read_b64_tr_b16 v[104:105], v16 offset:18464
    ds_read_b64_tr_b16 v[106:107], v16 offset:23072
    s_waitcnt lgkmcnt(6)
    v_mfma_f32_16x16x32_bf16 v[136:139], v[92:95], v[48:51], v[136:139]
    s_add_u32 m0, s29, 38912
    s_mov_b64 exec, 0xffff
    buffer_load_dwordx4 v12, s[12:15], s31 offen lds
    s_mov_b64 exec, -1
    v_mfma_f32_16x16x32_bf16 v[172:175], v[92:95], v[52:55], v[172:175]
    s_add_u32 s32, s35, 18
    s_lshl_b32 s32, s32, 1
    s_add_u32 s32, s32, s39
    s_cmp_lt_u32 s32, 162
    s_cselect_b32 s32, s32, 0x100000
    s_lshl_b32 s32, s32, 10
    buffer_load_dwordx4 v[40:43], v13, s[8:11], s32 offen
    ds_read_b64_tr_b16 v[88:89], v16 offset:18496
    ds_read_b64_tr_b16 v[90:91], v16 offset:23104
    s_waitcnt lgkmcnt(6)
    v_mfma_f32_16x16x32_bf16 v[140:143], v[96:99], v[48:51], v[140:143]
    buffer_load_dwordx4 v[44:47], v14, s[8:11], s32 offen
    v_mfma_f32_16x16x32_bf16 v[176:179], v[96:99], v[52:55], v[176:179]
    ds_read_b64_tr_b16 v[92:93], v16 offset:18528
    ds_read_b64_tr_b16 v[94:95], v16 offset:23136
    s_waitcnt vmcnt(30)
    s_waitcnt lgkmcnt(6)
    v_mfma_f32_16x16x32_bf16 v[108:111], v[100:103], v[56:59], v[108:111]
    v_mfma_f32_16x16x32_bf16 v[144:147], v[100:103], v[60:63], v[144:147]
    ds_read_b64_tr_b16 v[96:97], v16 offset:18560
    ds_read_b64_tr_b16 v[98:99], v16 offset:23168
    s_waitcnt lgkmcnt(6)
    v_mfma_f32_16x16x32_bf16 v[112:115], v[104:107], v[56:59], v[112:115]
    v_mfma_f32_16x16x32_bf16 v[148:151], v[104:107], v[60:63], v[148:151]
    ds_read_b64_tr_b16 v[100:101], v16 offset:18592
    ds_read_b64_tr_b16 v[102:103], v16 offset:23200
    s_waitcnt lgkmcnt(6)
    v_mfma_f32_16x16x32_bf16 v[116:119], v[88:91], v[56:59], v[116:119]
    v_mfma_f32_16x16x32_bf16 v[152:155], v[88:91], v[60:63], v[152:155]
    ds_read_b64_tr_b16 v[104:105], v16 offset:18624
    ds_read_b64_tr_b16 v[106:107], v16 offset:23232
    s_waitcnt lgkmcnt(6)
    v_mfma_f32_16x16x32_bf16 v[120:123], v[92:95], v[56:59], v[120:123]
    v_mfma_f32_16x16x32_bf16 v[156:159], v[92:95], v[60:63], v[156:159]
    ds_read_b64_tr_b16 v[88:89], v16 offset:18656
    ds_read_b64_tr_b16 v[90:91], v16 offset:23264
    s_waitcnt lgkmcnt(6)
    v_mfma_f32_16x16x32_bf16 v[124:127], v[96:99], v[56:59], v[124:127]
    v_mfma_f32_16x16x32_bf16 v[160:163], v[96:99], v[60:63], v[160:163]
    ds_read_b64_tr_b16 v[92:93], v16 offset:18688
    ds_read_b64_tr_b16 v[94:95], v16 offset:23296
    s_waitcnt lgkmcnt(6)
    v_mfma_f32_16x16x32_bf16 v[128:131], v[100:103], v[56:59], v[128:131]
    v_mfma_f32_16x16x32_bf16 v[164:167], v[100:103], v[60:63], v[164:167]
    s_waitcnt vmcnt(27)
    s_barrier
    ds_read_b64_tr_b16 v[96:97], v16 offset:36864
    ds_read_b64_tr_b16 v[98:99], v16 offset:41472
    s_waitcnt lgkmcnt(6)
    v_mfma_f32_16x16x32_bf16 v[132:135], v[104:107], v[56:59], v[132:135]
    s_add_u32 s30, s35, 19
    s_sub_u32 s33, s30, 72
    s_cmp_lt_u32 s30, 72
    s_cselect_b32 s12, s4, s6
    s_cselect_b32 s13, s5, s7
    s_cselect_b32 s14, s36, s37
    s_cselect_b32 s30, s30, s33
    s_mul_i32 s31, s30, 73728
    s_add_u32 m0, s29, 55296
    s_nop 0
    buffer_load_dwordx4 v10, s[12:15], s31 offen lds
    v_mfma_f32_16x16x32_bf16 v[168:171], v[104:107], v[60:63], v[168:171]
    s_add_u32 m0, s29, 56320
    s_nop 0
    buffer_load_dwordx4 v11, s[12:15], s31 offen lds
    ds_read_b64_tr_b16 v[100:101], v16 offset:36896
    ds_read_b64_tr_b16 v[102:103], v16 offset:41504
    s_waitcnt lgkmcnt(6)
    v_mfma_f32_16x16x32_bf16 v[136:139], v[88:91], v[56:59], v[136:139]
    s_add_u32 m0, s29, 57344
    s_mov_b64 exec, 0xffff
    buffer_load_dwordx4 v12, s[12:15], s31 offen lds
    s_mov_b64 exec, -1
    v_mfma_f32_16x16x32_bf16 v[172:175], v[88:91], v[60:63], v[172:175]
    s_add_u32 s32, s35, 19
    s_lshl_b32 s32, s32, 1
    s_add_u32 s32, s32, s39
    s_cmp_lt_u32 s32, 162
    s_cselect_b32 s32, s32, 0x100000
    s_lshl_b32 s32, s32, 10
    buffer_load_dwordx4 v[48:51], v13, s[8:11], s32 offen
    ds_read_b64_tr_b16 v[104:105], v16 offset:36928
    ds_read_b64_tr_b16 v[106:107], v16 offset:41536
    s_waitcnt lgkmcnt(6)
    v_mfma_f32_16x16x32_bf16 v[140:143], v[92:95], v[56:59], v[140:143]
    buffer_load_dwordx4 v[52:55], v14, s[8:11], s32 offen
    v_mfma_f32_16x16x32_bf16 v[176:179], v[92:95], v[60:63], v[176:179]
    ds_read_b64_tr_b16 v[88:89], v16 offset:36960
    ds_read_b64_tr_b16 v[90:91], v16 offset:41568
    s_waitcnt vmcnt(30)
    s_waitcnt lgkmcnt(6)
    v_mfma_f32_16x16x32_bf16 v[108:111], v[96:99], v[64:67], v[108:111]
    v_mfma_f32_16x16x32_bf16 v[144:147], v[96:99], v[68:71], v[144:147]
    ds_read_b64_tr_b16 v[92:93], v16 offset:36992
    ds_read_b64_tr_b16 v[94:95], v16 offset:41600
    s_waitcnt lgkmcnt(6)
    v_mfma_f32_16x16x32_bf16 v[112:115], v[100:103], v[64:67], v[112:115]
    v_mfma_f32_16x16x32_bf16 v[148:151], v[100:103], v[68:71], v[148:151]
    ds_read_b64_tr_b16 v[96:97], v16 offset:37024
    ds_read_b64_tr_b16 v[98:99], v16 offset:41632
    s_waitcnt lgkmcnt(6)
    v_mfma_f32_16x16x32_bf16 v[116:119], v[104:107], v[64:67], v[116:119]
    v_mfma_f32_16x16x32_bf16 v[152:155], v[104:107], v[68:71], v[152:155]
    ds_read_b64_tr_b16 v[100:101], v16 offset:37056
    ds_read_b64_tr_b16 v[102:103], v16 offset:41664
    s_waitcnt lgkmcnt(6)
    v_mfma_f32_16x16x32_bf16 v[120:123], v[88:91], v[64:67], v[120:123]
    v_mfma_f32_16x16x32_bf16 v[156:159], v[88:91], v[68:71], v[156:159]
    ds_read_b64_tr_b16 v[104:105], v16 offset:37088
    ds_read_b64_tr_b16 v[106:107], v16 offset:41696
    s_waitcnt lgkmcnt(6)
    v_mfma_f32_16x16x32_bf16 v[124:127], v[92:95], v[64:67], v[124:127]
    v_mfma_f32_16x16x32_bf16 v[160:163], v[92:95], v[68:71], v[160:163]
    ds_read_b64_tr_b16 v[88:89], v16 offset:37120
    ds_read_b64_tr_b16 v[90:91], v16 offset:41728
    s_waitcnt lgkmcnt(6)
    v_mfma_f32_16x16x32_bf16 v[128:131], v[96:99], v[64:67], v[128:131]
    v_mfma_f32_16x16x32_bf16 v[164:167], v[96:99], v[68:71], v[164:167]
    s_waitcnt vmcnt(27)
    s_barrier
    ds_read_b64_tr_b16 v[92:93], v17 offset:0
    ds_read_b64_tr_b16 v[94:95], v17 offset:4608
    s_waitcnt lgkmcnt(6)
    v_mfma_f32_16x16x32_bf16 v[132:135], v[100:103], v[64:67], v[132:135]
    s_add_u32 s30, s35, 20
    s_sub_u32 s33, s30, 72
    s_cmp_lt_u32 s30, 72
    s_cselect_b32 s12, s4, s6
    s_cselect_b32 s13, s5, s7
    s_cselect_b32 s14, s36, s37
    s_cselect_b32 s30, s30, s33
    s_mul_i32 s31, s30, 73728
    s_add_u32 m0, s29, 73728
    s_nop 0
    buffer_load_dwordx4 v10, s[12:15], s31 offen lds
    v_mfma_f32_16x16x32_bf16 v[168:171], v[100:103], v[68:71], v[168:171]
    s_add_u32 m0, s29, 74752
    s_nop 0
    buffer_load_dwordx4 v11, s[12:15], s31 offen lds
    ds_read_b64_tr_b16 v[96:97], v17 offset:32
    ds_read_b64_tr_b16 v[98:99], v17 offset:4640
    s_waitcnt lgkmcnt(6)
    v_mfma_f32_16x16x32_bf16 v[136:139], v[104:107], v[64:67], v[136:139]
    s_add_u32 m0, s29, 75776
    s_mov_b64 exec, 0xffff
    buffer_load_dwordx4 v12, s[12:15], s31 offen lds
    s_mov_b64 exec, -1
    v_mfma_f32_16x16x32_bf16 v[172:175], v[104:107], v[68:71], v[172:175]
    s_add_u32 s32, s35, 20
    s_lshl_b32 s32, s32, 1
    s_add_u32 s32, s32, s39
    s_cmp_lt_u32 s32, 162
    s_cselect_b32 s32, s32, 0x100000
    s_lshl_b32 s32, s32, 10
    buffer_load_dwordx4 v[56:59], v13, s[8:11], s32 offen
    ds_read_b64_tr_b16 v[100:101], v17 offset:64
    ds_read_b64_tr_b16 v[102:103], v17 offset:4672
    s_waitcnt lgkmcnt(6)
    v_mfma_f32_16x16x32_bf16 v[140:143], v[88:91], v[64:67], v[140:143]
    buffer_load_dwordx4 v[60:63], v14, s[8:11], s32 offen
    v_mfma_f32_16x16x32_bf16 v[176:179], v[88:91], v[68:71], v[176:179]
    ds_read_b64_tr_b16 v[104:105], v17 offset:96
    ds_read_b64_tr_b16 v[106:107], v17 offset:4704
    s_waitcnt vmcnt(30)
    s_waitcnt lgkmcnt(6)
    v_mfma_f32_16x16x32_bf16 v[108:111], v[92:95], v[72:75], v[108:111]
    v_mfma_f32_16x16x32_bf16 v[144:147], v[92:95], v[76:79], v[144:147]
    ds_read_b64_tr_b16 v[88:89], v17 offset:128
    ds_read_b64_tr_b16 v[90:91], v17 offset:4736
    s_waitcnt lgkmcnt(6)
    v_mfma_f32_16x16x32_bf16 v[112:115], v[96:99], v[72:75], v[112:115]
    v_mfma_f32_16x16x32_bf16 v[148:151], v[96:99], v[76:79], v[148:151]
    ds_read_b64_tr_b16 v[92:93], v17 offset:160
    ds_read_b64_tr_b16 v[94:95], v17 offset:4768
    s_waitcnt lgkmcnt(6)
    v_mfma_f32_16x16x32_bf16 v[116:119], v[100:103], v[72:75], v[116:119]
    v_mfma_f32_16x16x32_bf16 v[152:155], v[100:103], v[76:79], v[152:155]
    ds_read_b64_tr_b16 v[96:97], v17 offset:192
    ds_read_b64_tr_b16 v[98:99], v17 offset:4800
    s_waitcnt lgkmcnt(6)
    v_mfma_f32_16x16x32_bf16 v[120:123], v[104:107], v[72:75], v[120:123]
    v_mfma_f32_16x16x32_bf16 v[156:159], v[104:107], v[76:79], v[156:159]
    ds_read_b64_tr_b16 v[100:101], v17 offset:224
    ds_read_b64_tr_b16 v[102:103], v17 offset:4832
    s_waitcnt lgkmcnt(6)
    v_mfma_f32_16x16x32_bf16 v[124:127], v[88:91], v[72:75], v[124:127]
    v_mfma_f32_16x16x32_bf16 v[160:163], v[88:91], v[76:79], v[160:163]
    ds_read_b64_tr_b16 v[104:105], v17 offset:256
    ds_read_b64_tr_b16 v[106:107], v17 offset:4864
    s_waitcnt lgkmcnt(6)
    v_mfma_f32_16x16x32_bf16 v[128:131], v[92:95], v[72:75], v[128:131]
    v_mfma_f32_16x16x32_bf16 v[164:167], v[92:95], v[76:79], v[164:167]
    s_waitcnt vmcnt(27)
    s_barrier
    ds_read_b64_tr_b16 v[88:89], v17 offset:18432
    ds_read_b64_tr_b16 v[90:91], v17 offset:23040
    s_waitcnt lgkmcnt(6)
    v_mfma_f32_16x16x32_bf16 v[132:135], v[96:99], v[72:75], v[132:135]
    v_mfma_f32_16x16x32_bf16 v[168:171], v[96:99], v[76:79], v[168:171]
    ds_read_b64_tr_b16 v[92:93], v17 offset:18464
    ds_read_b64_tr_b16 v[94:95], v17 offset:23072
    s_waitcnt lgkmcnt(6)
    v_mfma_f32_16x16x32_bf16 v[136:139], v[100:103], v[72:75], v[136:139]
    v_mfma_f32_16x16x32_bf16 v[172:175], v[100:103], v[76:79], v[172:175]
    ds_read_b64_tr_b16 v[96:97], v17 offset:18496
    ds_read_b64_tr_b16 v[98:99], v17 offset:23104
    s_waitcnt lgkmcnt(6)
    v_mfma_f32_16x16x32_bf16 v[140:143], v[104:107], v[72:75], v[140:143]
    v_mfma_f32_16x16x32_bf16 v[176:179], v[104:107], v[76:79], v[176:179]
    ds_read_b64_tr_b16 v[100:101], v17 offset:18528
    ds_read_b64_tr_b16 v[102:103], v17 offset:23136
    s_waitcnt vmcnt(25)
    s_waitcnt lgkmcnt(6)
    v_mfma_f32_16x16x32_bf16 v[108:111], v[88:91], v[80:83], v[108:111]
    v_mfma_f32_16x16x32_bf16 v[144:147], v[88:91], v[84:87], v[144:147]
    ds_read_b64_tr_b16 v[104:105], v17 offset:18560
    ds_read_b64_tr_b16 v[106:107], v17 offset:23168
    s_waitcnt lgkmcnt(6)
    v_mfma_f32_16x16x32_bf16 v[112:115], v[92:95], v[80:83], v[112:115]
    v_mfma_f32_16x16x32_bf16 v[148:151], v[92:95], v[84:87], v[148:151]
    ds_read_b64_tr_b16 v[88:89], v17 offset:18592
    ds_read_b64_tr_b16 v[90:91], v17 offset:23200
    s_waitcnt lgkmcnt(6)
    v_mfma_f32_16x16x32_bf16 v[116:119], v[96:99], v[80:83], v[116:119]
    v_mfma_f32_16x16x32_bf16 v[152:155], v[96:99], v[84:87], v[152:155]
    ds_read_b64_tr_b16 v[92:93], v17 offset:18624
    ds_read_b64_tr_b16 v[94:95], v17 offset:23232
    s_waitcnt lgkmcnt(6)
    v_mfma_f32_16x16x32_bf16 v[120:123], v[100:103], v[80:83], v[120:123]
    v_mfma_f32_16x16x32_bf16 v[156:159], v[100:103], v[84:87], v[156:159]
    ds_read_b64_tr_b16 v[96:97], v17 offset:18656
    ds_read_b64_tr_b16 v[98:99], v17 offset:23264
    s_waitcnt lgkmcnt(6)
    v_mfma_f32_16x16x32_bf16 v[124:127], v[104:107], v[80:83], v[124:127]
    v_mfma_f32_16x16x32_bf16 v[160:163], v[104:107], v[84:87], v[160:163]
    ds_read_b64_tr_b16 v[100:101], v17 offset:18688
    ds_read_b64_tr_b16 v[102:103], v17 offset:23296
    s_waitcnt lgkmcnt(6)
    v_mfma_f32_16x16x32_bf16 v[128:131], v[88:91], v[80:83], v[128:131]
    v_mfma_f32_16x16x32_bf16 v[164:167], v[88:91], v[84:87], v[164:167]
    s_waitcnt vmcnt(22)
    s_barrier
    ds_read_b64_tr_b16 v[104:105], v15 offset:0
    ds_read_b64_tr_b16 v[106:107], v15 offset:4608
    s_waitcnt lgkmcnt(6)
    v_mfma_f32_16x16x32_bf16 v[132:135], v[92:95], v[80:83], v[132:135]
    v_mfma_f32_16x16x32_bf16 v[168:171], v[92:95], v[84:87], v[168:171]
    ds_read_b64_tr_b16 v[88:89], v15 offset:32
    ds_read_b64_tr_b16 v[90:91], v15 offset:4640
    s_waitcnt lgkmcnt(6)
    v_mfma_f32_16x16x32_bf16 v[136:139], v[96:99], v[80:83], v[136:139]
    v_mfma_f32_16x16x32_bf16 v[172:175], v[96:99], v[84:87], v[172:175]
    ds_read_b64_tr_b16 v[92:93], v15 offset:64
    ds_read_b64_tr_b16 v[94:95], v15 offset:4672
    s_waitcnt lgkmcnt(6)
    v_mfma_f32_16x16x32_bf16 v[140:143], v[100:103], v[80:83], v[140:143]
    v_mfma_f32_16x16x32_bf16 v[176:179], v[100:103], v[84:87], v[176:179]
    ds_read_b64_tr_b16 v[96:97], v15 offset:96
    ds_read_b64_tr_b16 v[98:99], v15 offset:4704
    s_waitcnt vmcnt(20)
    s_waitcnt lgkmcnt(6)
    v_mfma_f32_16x16x32_bf16 v[108:111], v[104:107], v[24:27], v[108:111]
    v_mfma_f32_16x16x32_bf16 v[144:147], v[104:107], v[28:31], v[144:147]
    ds_read_b64_tr_b16 v[100:101], v15 offset:128
    ds_read_b64_tr_b16 v[102:103], v15 offset:4736
    s_waitcnt lgkmcnt(6)
    v_mfma_f32_16x16x32_bf16 v[112:115], v[88:91], v[24:27], v[112:115]
    v_mfma_f32_16x16x32_bf16 v[148:151], v[88:91], v[28:31], v[148:151]
    ds_read_b64_tr_b16 v[104:105], v15 offset:160
    ds_read_b64_tr_b16 v[106:107], v15 offset:4768
    s_waitcnt lgkmcnt(6)
    v_mfma_f32_16x16x32_bf16 v[116:119], v[92:95], v[24:27], v[116:119]
    v_mfma_f32_16x16x32_bf16 v[152:155], v[92:95], v[28:31], v[152:155]
    ds_read_b64_tr_b16 v[88:89], v15 offset:192
    ds_read_b64_tr_b16 v[90:91], v15 offset:4800
    s_waitcnt lgkmcnt(6)
    v_mfma_f32_16x16x32_bf16 v[120:123], v[96:99], v[24:27], v[120:123]
    v_mfma_f32_16x16x32_bf16 v[156:159], v[96:99], v[28:31], v[156:159]
    ds_read_b64_tr_b16 v[92:93], v15 offset:224
    ds_read_b64_tr_b16 v[94:95], v15 offset:4832
    s_waitcnt lgkmcnt(6)
    v_mfma_f32_16x16x32_bf16 v[124:127], v[100:103], v[24:27], v[124:127]
    v_mfma_f32_16x16x32_bf16 v[160:163], v[100:103], v[28:31], v[160:163]
    ds_read_b64_tr_b16 v[96:97], v15 offset:256
    ds_read_b64_tr_b16 v[98:99], v15 offset:4864
    s_waitcnt lgkmcnt(6)
    v_mfma_f32_16x16x32_bf16 v[128:131], v[104:107], v[24:27], v[128:131]
    v_mfma_f32_16x16x32_bf16 v[164:167], v[104:107], v[28:31], v[164:167]
    s_waitcnt vmcnt(17)
    s_barrier
    ds_read_b64_tr_b16 v[100:101], v15 offset:18432
    ds_read_b64_tr_b16 v[102:103], v15 offset:23040
    s_waitcnt lgkmcnt(6)
    v_mfma_f32_16x16x32_bf16 v[132:135], v[88:91], v[24:27], v[132:135]
    v_mfma_f32_16x16x32_bf16 v[168:171], v[88:91], v[28:31], v[168:171]
    ds_read_b64_tr_b16 v[104:105], v15 offset:18464
    ds_read_b64_tr_b16 v[106:107], v15 offset:23072
    s_waitcnt lgkmcnt(6)
    v_mfma_f32_16x16x32_bf16 v[136:139], v[92:95], v[24:27], v[136:139]
    v_mfma_f32_16x16x32_bf16 v[172:175], v[92:95], v[28:31], v[172:175]
    ds_read_b64_tr_b16 v[88:89], v15 offset:18496
    ds_read_b64_tr_b16 v[90:91], v15 offset:23104
    s_waitcnt lgkmcnt(6)
    v_mfma_f32_16x16x32_bf16 v[140:143], v[96:99], v[24:27], v[140:143]
    v_mfma_f32_16x16x32_bf16 v[176:179], v[96:99], v[28:31], v[176:179]
    ds_read_b64_tr_b16 v[92:93], v15 offset:18528
    ds_read_b64_tr_b16 v[94:95], v15 offset:23136
    s_waitcnt vmcnt(15)
    s_waitcnt lgkmcnt(6)
    v_mfma_f32_16x16x32_bf16 v[108:111], v[100:103], v[32:35], v[108:111]
    v_mfma_f32_16x16x32_bf16 v[144:147], v[100:103], v[36:39], v[144:147]
    ds_read_b64_tr_b16 v[96:97], v15 offset:18560
    ds_read_b64_tr_b16 v[98:99], v15 offset:23168
    s_waitcnt lgkmcnt(6)
    v_mfma_f32_16x16x32_bf16 v[112:115], v[104:107], v[32:35], v[112:115]
    v_mfma_f32_16x16x32_bf16 v[148:151], v[104:107], v[36:39], v[148:151]
    ds_read_b64_tr_b16 v[100:101], v15 offset:18592
    ds_read_b64_tr_b16 v[102:103], v15 offset:23200
    s_waitcnt lgkmcnt(6)
    v_mfma_f32_16x16x32_bf16 v[116:119], v[88:91], v[32:35], v[116:119]
    v_mfma_f32_16x16x32_bf16 v[152:155], v[88:91], v[36:39], v[152:155]
    ds_read_b64_tr_b16 v[104:105], v15 offset:18624
    ds_read_b64_tr_b16 v[106:107], v15 offset:23232
    s_waitcnt lgkmcnt(6)
    v_mfma_f32_16x16x32_bf16 v[120:123], v[92:95], v[32:35], v[120:123]
    v_mfma_f32_16x16x32_bf16 v[156:159], v[92:95], v[36:39], v[156:159]
    ds_read_b64_tr_b16 v[88:89], v15 offset:18656
    ds_read_b64_tr_b16 v[90:91], v15 offset:23264
    s_waitcnt lgkmcnt(6)
    v_mfma_f32_16x16x32_bf16 v[124:127], v[96:99], v[32:35], v[124:127]
    v_mfma_f32_16x16x32_bf16 v[160:163], v[96:99], v[36:39], v[160:163]
    ds_read_b64_tr_b16 v[92:93], v15 offset:18688
    ds_read_b64_tr_b16 v[94:95], v15 offset:23296
    s_waitcnt lgkmcnt(6)
    v_mfma_f32_16x16x32_bf16 v[128:131], v[100:103], v[32:35], v[128:131]
    v_mfma_f32_16x16x32_bf16 v[164:167], v[100:103], v[36:39], v[164:167]
    s_waitcnt vmcnt(12)
    s_barrier
    ds_read_b64_tr_b16 v[96:97], v15 offset:36864
    ds_read_b64_tr_b16 v[98:99], v15 offset:41472
    s_waitcnt lgkmcnt(6)
    v_mfma_f32_16x16x32_bf16 v[132:135], v[104:107], v[32:35], v[132:135]
    v_mfma_f32_16x16x32_bf16 v[168:171], v[104:107], v[36:39], v[168:171]
    ds_read_b64_tr_b16 v[100:101], v15 offset:36896
    ds_read_b64_tr_b16 v[102:103], v15 offset:41504
    s_waitcnt lgkmcnt(6)
    v_mfma_f32_16x16x32_bf16 v[136:139], v[88:91], v[32:35], v[136:139]
    v_mfma_f32_16x16x32_bf16 v[172:175], v[88:91], v[36:39], v[172:175]
    ds_read_b64_tr_b16 v[104:105], v15 offset:36928
    ds_read_b64_tr_b16 v[106:107], v15 offset:41536
    s_waitcnt lgkmcnt(6)
    v_mfma_f32_16x16x32_bf16 v[140:143], v[92:95], v[32:35], v[140:143]
    v_mfma_f32_16x16x32_bf16 v[176:179], v[92:95], v[36:39], v[176:179]
    ds_read_b64_tr_b16 v[88:89], v15 offset:36960
    ds_read_b64_tr_b16 v[90:91], v15 offset:41568
    s_waitcnt vmcnt(10)
    s_waitcnt lgkmcnt(6)
    v_mfma_f32_16x16x32_bf16 v[108:111], v[96:99], v[40:43], v[108:111]
    v_mfma_f32_16x16x32_bf16 v[144:147], v[96:99], v[44:47], v[144:147]
    ds_read_b64_tr_b16 v[92:93], v15 offset:36992
    ds_read_b64_tr_b16 v[94:95], v15 offset:41600
    s_waitcnt lgkmcnt(6)
    v_mfma_f32_16x16x32_bf16 v[112:115], v[100:103], v[40:43], v[112:115]
    v_mfma_f32_16x16x32_bf16 v[148:151], v[100:103], v[44:47], v[148:151]
    ds_read_b64_tr_b16 v[96:97], v15 offset:37024
    ds_read_b64_tr_b16 v[98:99], v15 offset:41632
    s_waitcnt lgkmcnt(6)
    v_mfma_f32_16x16x32_bf16 v[116:119], v[104:107], v[40:43], v[116:119]
    v_mfma_f32_16x16x32_bf16 v[152:155], v[104:107], v[44:47], v[152:155]
    ds_read_b64_tr_b16 v[100:101], v15 offset:37056
    ds_read_b64_tr_b16 v[102:103], v15 offset:41664
    s_waitcnt lgkmcnt(6)
    v_mfma_f32_16x16x32_bf16 v[120:123], v[88:91], v[40:43], v[120:123]
    v_mfma_f32_16x16x32_bf16 v[156:159], v[88:91], v[44:47], v[156:159]
    ds_read_b64_tr_b16 v[104:105], v15 offset:37088
    ds_read_b64_tr_b16 v[106:107], v15 offset:41696
    s_waitcnt lgkmcnt(6)
    v_mfma_f32_16x16x32_bf16 v[124:127], v[92:95], v[40:43], v[124:127]
    v_mfma_f32_16x16x32_bf16 v[160:163], v[92:95], v[44:47], v[160:163]
    ds_read_b64_tr_b16 v[88:89], v15 offset:37120
    ds_read_b64_tr_b16 v[90:91], v15 offset:41728
    s_waitcnt lgkmcnt(6)
    v_mfma_f32_16x16x32_bf16 v[128:131], v[96:99], v[40:43], v[128:131]
    v_mfma_f32_16x16x32_bf16 v[164:167], v[96:99], v[44:47], v[164:167]
    s_waitcnt vmcnt(7)
    s_barrier
    ds_read_b64_tr_b16 v[92:93], v16 offset:0
    ds_read_b64_tr_b16 v[94:95], v16 offset:4608
    s_waitcnt lgkmcnt(6)
    v_mfma_f32_16x16x32_bf16 v[132:135], v[100:103], v[40:43], v[132:135]
    v_mfma_f32_16x16x32_bf16 v[168:171], v[100:103], v[44:47], v[168:171]
    ds_read_b64_tr_b16 v[96:97], v16 offset:32
    ds_read_b64_tr_b16 v[98:99], v16 offset:4640
    s_waitcnt lgkmcnt(6)
    v_mfma_f32_16x16x32_bf16 v[136:139], v[104:107], v[40:43], v[136:139]
    v_mfma_f32_16x16x32_bf16 v[172:175], v[104:107], v[44:47], v[172:175]
    ds_read_b64_tr_b16 v[100:101], v16 offset:64
    ds_read_b64_tr_b16 v[102:103], v16 offset:4672
    s_waitcnt lgkmcnt(6)
    v_mfma_f32_16x16x32_bf16 v[140:143], v[88:91], v[40:43], v[140:143]
    v_mfma_f32_16x16x32_bf16 v[176:179], v[88:91], v[44:47], v[176:179]
    ds_read_b64_tr_b16 v[104:105], v16 offset:96
    ds_read_b64_tr_b16 v[106:107], v16 offset:4704
    s_waitcnt vmcnt(5)
    s_waitcnt lgkmcnt(6)
    v_mfma_f32_16x16x32_bf16 v[108:111], v[92:95], v[48:51], v[108:111]
    v_mfma_f32_16x16x32_bf16 v[144:147], v[92:95], v[52:55], v[144:147]
    ds_read_b64_tr_b16 v[88:89], v16 offset:128
    ds_read_b64_tr_b16 v[90:91], v16 offset:4736
    s_waitcnt lgkmcnt(6)
    v_mfma_f32_16x16x32_bf16 v[112:115], v[96:99], v[48:51], v[112:115]
    v_mfma_f32_16x16x32_bf16 v[148:151], v[96:99], v[52:55], v[148:151]
    ds_read_b64_tr_b16 v[92:93], v16 offset:160
    ds_read_b64_tr_b16 v[94:95], v16 offset:4768
    s_waitcnt lgkmcnt(6)
    v_mfma_f32_16x16x32_bf16 v[116:119], v[100:103], v[48:51], v[116:119]
    v_mfma_f32_16x16x32_bf16 v[152:155], v[100:103], v[52:55], v[152:155]
    ds_read_b64_tr_b16 v[96:97], v16 offset:192
    ds_read_b64_tr_b16 v[98:99], v16 offset:4800
    s_waitcnt lgkmcnt(6)
    v_mfma_f32_16x16x32_bf16 v[120:123], v[104:107], v[48:51], v[120:123]
    v_mfma_f32_16x16x32_bf16 v[156:159], v[104:107], v[52:55], v[156:159]
    ds_read_b64_tr_b16 v[100:101], v16 offset:224
    ds_read_b64_tr_b16 v[102:103], v16 offset:4832
    s_waitcnt lgkmcnt(6)
    v_mfma_f32_16x16x32_bf16 v[124:127], v[88:91], v[48:51], v[124:127]
    v_mfma_f32_16x16x32_bf16 v[160:163], v[88:91], v[52:55], v[160:163]
    ds_read_b64_tr_b16 v[104:105], v16 offset:256
    ds_read_b64_tr_b16 v[106:107], v16 offset:4864
    s_waitcnt lgkmcnt(6)
    v_mfma_f32_16x16x32_bf16 v[128:131], v[92:95], v[48:51], v[128:131]
    v_mfma_f32_16x16x32_bf16 v[164:167], v[92:95], v[52:55], v[164:167]
    s_waitcnt vmcnt(2)
    s_barrier
    ds_read_b64_tr_b16 v[88:89], v16 offset:18432
    ds_read_b64_tr_b16 v[90:91], v16 offset:23040
    s_waitcnt lgkmcnt(6)
    v_mfma_f32_16x16x32_bf16 v[132:135], v[96:99], v[48:51], v[132:135]
    v_mfma_f32_16x16x32_bf16 v[168:171], v[96:99], v[52:55], v[168:171]
    ds_read_b64_tr_b16 v[92:93], v16 offset:18464
    ds_read_b64_tr_b16 v[94:95], v16 offset:23072
    s_waitcnt lgkmcnt(6)
    v_mfma_f32_16x16x32_bf16 v[136:139], v[100:103], v[48:51], v[136:139]
    v_mfma_f32_16x16x32_bf16 v[172:175], v[100:103], v[52:55], v[172:175]
    ds_read_b64_tr_b16 v[96:97], v16 offset:18496
    ds_read_b64_tr_b16 v[98:99], v16 offset:23104
    s_waitcnt lgkmcnt(6)
    v_mfma_f32_16x16x32_bf16 v[140:143], v[104:107], v[48:51], v[140:143]
    v_mfma_f32_16x16x32_bf16 v[176:179], v[104:107], v[52:55], v[176:179]
    ds_read_b64_tr_b16 v[100:101], v16 offset:18528
    ds_read_b64_tr_b16 v[102:103], v16 offset:23136
    s_waitcnt vmcnt(0)
    s_waitcnt lgkmcnt(6)
    v_mfma_f32_16x16x32_bf16 v[108:111], v[88:91], v[56:59], v[108:111]
    v_mfma_f32_16x16x32_bf16 v[144:147], v[88:91], v[60:63], v[144:147]
    ds_read_b64_tr_b16 v[104:105], v16 offset:18560
    ds_read_b64_tr_b16 v[106:107], v16 offset:23168
    s_waitcnt lgkmcnt(6)
    v_mfma_f32_16x16x32_bf16 v[112:115], v[92:95], v[56:59], v[112:115]
    v_mfma_f32_16x16x32_bf16 v[148:151], v[92:95], v[60:63], v[148:151]
    ds_read_b64_tr_b16 v[88:89], v16 offset:18592
    ds_read_b64_tr_b16 v[90:91], v16 offset:23200
    s_waitcnt lgkmcnt(6)
    v_mfma_f32_16x16x32_bf16 v[116:119], v[96:99], v[56:59], v[116:119]
    v_mfma_f32_16x16x32_bf16 v[152:155], v[96:99], v[60:63], v[152:155]
    ds_read_b64_tr_b16 v[92:93], v16 offset:18624
    ds_read_b64_tr_b16 v[94:95], v16 offset:23232
    s_waitcnt lgkmcnt(6)
    v_mfma_f32_16x16x32_bf16 v[120:123], v[100:103], v[56:59], v[120:123]
    v_mfma_f32_16x16x32_bf16 v[156:159], v[100:103], v[60:63], v[156:159]
    ds_read_b64_tr_b16 v[96:97], v16 offset:18656
    ds_read_b64_tr_b16 v[98:99], v16 offset:23264
    s_waitcnt lgkmcnt(6)
    v_mfma_f32_16x16x32_bf16 v[124:127], v[104:107], v[56:59], v[124:127]
    v_mfma_f32_16x16x32_bf16 v[160:163], v[104:107], v[60:63], v[160:163]
    ds_read_b64_tr_b16 v[100:101], v16 offset:18688
    ds_read_b64_tr_b16 v[102:103], v16 offset:23296
    s_waitcnt lgkmcnt(6)
    v_mfma_f32_16x16x32_bf16 v[128:131], v[88:91], v[56:59], v[128:131]
    v_mfma_f32_16x16x32_bf16 v[164:167], v[88:91], v[60:63], v[164:167]
    s_waitcnt lgkmcnt(4)
    v_mfma_f32_16x16x32_bf16 v[132:135], v[92:95], v[56:59], v[132:135]
    v_mfma_f32_16x16x32_bf16 v[168:171], v[92:95], v[60:63], v[168:171]
    s_waitcnt lgkmcnt(2)
    v_mfma_f32_16x16x32_bf16 v[136:139], v[96:99], v[56:59], v[136:139]
    v_mfma_f32_16x16x32_bf16 v[172:175], v[96:99], v[60:63], v[172:175]
    s_waitcnt lgkmcnt(0)
    v_mfma_f32_16x16x32_bf16 v[140:143], v[100:103], v[56:59], v[140:143]
    v_mfma_f32_16x16x32_bf16 v[176:179], v[100:103], v[60:63], v[176:179]
    s_waitcnt vmcnt(0) lgkmcnt(0)
    s_nop 7
    s_barrier
    s_lshl_b32 s23, s38, 1
    s_sub_u32 s24, 1, s39
    s_add_u32 s24, s24, s23
    s_mul_i32 s24, s24, 9216
    s_add_u32 s25, s23, s39
    s_mul_i32 s25, s25, 9216
    v_add_u32 v2, s24, v18
    v_add_u32 v3, s25, v18
    s_cmp_eq_u32 s39, 0
    s_cbranch_scc1 L_g2_x0
    ds_write_b128 v2, v[108:111] offset:0
    ds_write_b128 v2, v[112:115] offset:1024
    ds_write_b128 v2, v[116:119] offset:2048
    ds_write_b128 v2, v[120:123] offset:3072
    ds_write_b128 v2, v[124:127] offset:4096
    ds_write_b128 v2, v[128:131] offset:5120
    ds_write_b128 v2, v[132:135] offset:6144
    ds_write_b128 v2, v[136:139] offset:7168
    ds_write_b128 v2, v[140:143] offset:8192
    s_waitcnt lgkmcnt(0)
    v_mov_b32 v108, v144
    v_mov_b32 v109, v145
    v_mov_b32 v110, v146
    v_mov_b32 v111, v147
    v_mov_b32 v112, v148
    v_mov_b32 v113, v149
    v_mov_b32 v114, v150
    v_mov_b32 v115, v151
    v_mov_b32 v116, v152
    v_mov_b32 v117, v153
    v_mov_b32 v118, v154
    v_mov_b32 v119, v155
    v_mov_b32 v120, v156
    v_mov_b32 v121, v157
    v_mov_b32 v122, v158
    v_mov_b32 v123, v159
    v_mov_b32 v124, v160
    v_mov_b32 v125, v161
    v_mov_b32 v126, v162
    v_mov_b32 v127, v163
    v_mov_b32 v128, v164
    v_mov_b32 v129, v165
    v_mov_b32 v130, v166
    v_mov_b32 v131, v167
    v_mov_b32 v132, v168
    v_mov_b32 v133, v169
    v_mov_b32 v134, v170
    v_mov_b32 v135, v171
    v_mov_b32 v136, v172
    v_mov_b32 v137, v173
    v_mov_b32 v138, v174
    v_mov_b32 v139, v175
    v_mov_b32 v140, v176
    v_mov_b32 v141, v177
    v_mov_b32 v142, v178
    v_mov_b32 v143, v179
    s_branch L_g2_x1
L_g2_x0:
    ds_write_b128 v2, v[144:147] offset:0
    ds_write_b128 v2, v[148:151] offset:1024
    ds_write_b128 v2, v[152:155] offset:2048
    ds_write_b128 v2, v[156:159] offset:3072
    ds_write_b128 v2, v[160:163] offset:4096
    ds_write_b128 v2, v[164:167] offset:5120
    ds_write_b128 v2, v[168:171] offset:6144
    ds_write_b128 v2, v[172:175] offset:7168
    ds_write_b128 v2, v[176:179] offset:8192
L_g2_x1:
    s_waitcnt lgkmcnt(0)
    s_barrier
    ds_read_b128 v[144:147], v3 offset:0
    ds_read_b128 v[148:151], v3 offset:1024
    ds_read_b128 v[152:155], v3 offset:2048
    ds_read_b128 v[156:159], v3 offset:3072
    ds_read_b128 v[160:163], v3 offset:4096
    ds_read_b128 v[164:167], v3 offset:5120
    ds_read_b128 v[168:171], v3 offset:6144
    ds_read_b128 v[172:175], v3 offset:7168
    ds_read_b128 v[176:179], v3 offset:8192
    s_waitcnt lgkmcnt(0)
    v_add_f32 v108, v108, v144
    v_add_f32 v109, v109, v145
    v_add_f32 v110, v110, v146
    v_add_f32 v111, v111, v147
    v_add_f32 v112, v112, v148
    v_add_f32 v113, v113, v149
    v_add_f32 v114, v114, v150
    v_add_f32 v115, v115, v151
    v_add_f32 v116, v116, v152
    v_add_f32 v117, v117, v153
    v_add_f32 v118, v118, v154
    v_add_f32 v119, v119, v155
    v_add_f32 v120, v120, v156
    v_add_f32 v121, v121, v157
    v_add_f32 v122, v122, v158
    v_add_f32 v123, v123, v159
    v_add_f32 v124, v124, v160
    v_add_f32 v125, v125, v161
    v_add_f32 v126, v126, v162
    v_add_f32 v127, v127, v163
    v_add_f32 v128, v128, v164
    v_add_f32 v129, v129, v165
    v_add_f32 v130, v130, v166
    v_add_f32 v131, v131, v167
    v_add_f32 v132, v132, v168
    v_add_f32 v133, v133, v169
    v_add_f32 v134, v134, v170
    v_add_f32 v135, v135, v171
    v_add_f32 v136, v136, v172
    v_add_f32 v137, v137, v173
    v_add_f32 v138, v138, v174
    v_add_f32 v139, v139, v175
    v_add_f32 v140, v140, v176
    v_add_f32 v141, v141, v177
    v_add_f32 v142, v142, v178
    v_add_f32 v143, v143, v179
    s_add_u32 s28, s28, s39
    s_mul_i32 s24, s28, 36
    s_mul_i32 s25, s34, 9
    s_add_u32 s24, s24, s25
    s_lshl_b32 s24, s24, 9
    s_mul_i32 s23, s21, 2359296
    s_add_u32 s23, s23, s24
    v_lshlrev_b32 v2, 3, v1
    v_cvt_pk_bf16_f32 v144, v108, v109
    v_cvt_pk_bf16_f32 v145, v110, v111
    s_add_u32 s25, s23, 0
    buffer_store_dwordx2 v[144:145], v2, s[16:19], s25 offen offset:0
    v_cvt_pk_bf16_f32 v146, v112, v113
    v_cvt_pk_bf16_f32 v147, v114, v115
    buffer_store_dwordx2 v[146:147], v2, s[16:19], s25 offen offset:512
    v_cvt_pk_bf16_f32 v148, v116, v117
    v_cvt_pk_bf16_f32 v149, v118, v119
    buffer_store_dwordx2 v[148:149], v2, s[16:19], s25 offen offset:1024
    v_cvt_pk_bf16_f32 v150, v120, v121
    v_cvt_pk_bf16_f32 v151, v122, v123
    buffer_store_dwordx2 v[150:151], v2, s[16:19], s25 offen offset:1536
    v_cvt_pk_bf16_f32 v152, v124, v125
    v_cvt_pk_bf16_f32 v153, v126, v127
    buffer_store_dwordx2 v[152:153], v2, s[16:19], s25 offen offset:2048
    v_cvt_pk_bf16_f32 v154, v128, v129
    v_cvt_pk_bf16_f32 v155, v130, v131
    buffer_store_dwordx2 v[154:155], v2, s[16:19], s25 offen offset:2560
    v_cvt_pk_bf16_f32 v156, v132, v133
    v_cvt_pk_bf16_f32 v157, v134, v135
    buffer_store_dwordx2 v[156:157], v2, s[16:19], s25 offen offset:3072
    v_cvt_pk_bf16_f32 v158, v136, v137
    v_cvt_pk_bf16_f32 v159, v138, v139
    buffer_store_dwordx2 v[158:159], v2, s[16:19], s25 offen offset:3584
    v_cvt_pk_bf16_f32 v160, v140, v141
    v_cvt_pk_bf16_f32 v161, v142, v143
    s_add_u32 s25, s23, 4096
    buffer_store_dwordx2 v[160:161], v2, s[16:19], s25 offen offset:0
L_g2_end:
    s_endpgm
.section .rodata,"a"
.p2align 6
.amdhsa_kernel gemm2_kernel
  .amdhsa_next_free_vgpr 180
  .amdhsa_next_free_sgpr 64
  .amdhsa_accum_offset 180
  .amdhsa_group_segment_fixed_size 0
  .amdhsa_kernarg_size 80
  .amdhsa_user_sgpr_count 2
  .amdhsa_user_sgpr_kernarg_segment_ptr 1
  .amdhsa_system_sgpr_workgroup_id_x 1
.end_amdhsa_kernel
.text

.globl reduce_kernel
.p2align 8
.type reduce_kernel,@function
reduce_kernel:
    s_cmp_ge_u32 s2, 288
    s_cbranch_scc1 L_r_end
    s_load_dwordx2 s[4:5], s[0:1], 0
    s_load_dwordx2 s[6:7], s[0:1], 56
    s_load_dwordx2 s[26:27], s[0:1], 72
    v_and_b32 v1, 63, v0
    v_lshrrev_b32 v2, 6, v0
    s_nop 0
    v_readfirstlane_b32 s20, v2
    s_lshl_b32 s21, s2, 2
    s_add_u32 s21, s21, s20
    s_lshl_b32 s22, s21, 11
    s_mul_i32 s23, s21, 7282
    s_lshr_b32 s23, s23, 16
    s_mul_i32 s24, s23, 9
    s_sub_u32 s24, s21, s24
    v_and_b32 v2, 15, v1
    v_mul_u32_u24 v2, 1152, v2
    v_lshrrev_b32 v3, 4, v1
    v_lshl_add_u32 v2, v3, 3, v2
    s_mul_i32 s25, s23, 18432
    s_lshl_b32 s28, s24, 7
    s_add_u32 s25, s25, s28
    v_lshlrev_b32 v3, 3, v1
    s_waitcnt lgkmcnt(0)
    s_mov_b32 s8, s4
    s_and_b32 s9, s5, 0xffff
    s_mov_b32 s10, 2359296
    s_mov_b32 s11, 0x00020000
    s_mov_b32 s12, s6
    s_and_b32 s13, s7, 0xffff
    s_mov_b32 s14, 2359296
    s_mov_b32 s15, 0x00020000
    s_add_u32 s16, s26, 33554432
    s_addc_u32 s17, s27, 0
    s_and_b32 s17, s17, 0xffff
    s_mov_b32 s18, 18874368
    s_mov_b32 s19, 0x00020000
    s_add_u32 s28, s22, 0
    buffer_load_dwordx2 v[16:17], v3, s[16:19], s28 offen offset:0
    buffer_load_dwordx2 v[24:25], v3, s[16:19], s28 offen offset:512
    buffer_load_dwordx2 v[32:33], v3, s[16:19], s28 offen offset:1024
    buffer_load_dwordx2 v[40:41], v3, s[16:19], s28 offen offset:1536
    s_add_u32 s28, s22, 2359296
    buffer_load_dwordx2 v[18:19], v3, s[16:19], s28 offen offset:0
    buffer_load_dwordx2 v[26:27], v3, s[16:19], s28 offen offset:512
    buffer_load_dwordx2 v[34:35], v3, s[16:19], s28 offen offset:1024
    buffer_load_dwordx2 v[42:43], v3, s[16:19], s28 offen offset:1536
    s_add_u32 s28, s22, 4718592
    buffer_load_dwordx2 v[20:21], v3, s[16:19], s28 offen offset:0
    buffer_load_dwordx2 v[28:29], v3, s[16:19], s28 offen offset:512
    buffer_load_dwordx2 v[36:37], v3, s[16:19], s28 offen offset:1024
    buffer_load_dwordx2 v[44:45], v3, s[16:19], s28 offen offset:1536
    s_add_u32 s28, s22, 7077888
    buffer_load_dwordx2 v[22:23], v3, s[16:19], s28 offen offset:0
    buffer_load_dwordx2 v[30:31], v3, s[16:19], s28 offen offset:512
    buffer_load_dwordx2 v[38:39], v3, s[16:19], s28 offen offset:1024
    buffer_load_dwordx2 v[46:47], v3, s[16:19], s28 offen offset:1536
    buffer_load_dwordx2 v[48:49], v2, s[8:11], s25 offen offset:0
    buffer_load_dwordx2 v[50:51], v2, s[8:11], s25 offen offset:32
    buffer_load_dwordx2 v[52:53], v2, s[8:11], s25 offen offset:64
    buffer_load_dwordx2 v[54:55], v2, s[8:11], s25 offen offset:96
    s_waitcnt vmcnt(0)
    v_lshlrev_b32 v8, 16, v48
    v_and_b32 v9, 0xffff0000, v48
    v_lshlrev_b32 v10, 16, v49
    v_and_b32 v11, 0xffff0000, v49
    v_lshlrev_b32 v12, 16, v16
    v_and_b32 v13, 0xffff0000, v16
    v_lshlrev_b32 v14, 16, v17
    v_and_b32 v15, 0xffff0000, v17
    v_lshlrev_b32 v6, 16, v18
    v_and_b32 v7, 0xffff0000, v18
    v_add_f32 v12, v12, v6
    v_add_f32 v13, v13, v7
    v_lshlrev_b32 v6, 16, v19
    v_and_b32 v7, 0xffff0000, v19
    v_add_f32 v14, v14, v6
    v_add_f32 v15, v15, v7
    v_lshlrev_b32 v6, 16, v20
    v_and_b32 v7, 0xffff0000, v20
    v_add_f32 v12, v12, v6
    v_add_f32 v13, v13, v7
    v_lshlrev_b32 v6, 16, v21
    v_and_b32 v7, 0xffff0000, v21
    v_add_f32 v14, v14, v6
    v_add_f32 v15, v15, v7
    v_lshlrev_b32 v6, 16, v22
    v_and_b32 v7, 0xffff0000, v22
    v_add_f32 v12, v12, v6
    v_add_f32 v13, v13, v7
    v_lshlrev_b32 v6, 16, v23
    v_and_b32 v7, 0xffff0000, v23
    v_add_f32 v14, v14, v6
    v_add_f32 v15, v15, v7
    v_add_f32 v8, v8, v12
    v_add_f32 v9, v9, v13
    v_add_f32 v10, v10, v14
    v_add_f32 v11, v11, v15
    v_cvt_pk_bf16_f32 v48, v8, v9
    v_cvt_pk_bf16_f32 v49, v10, v11
    buffer_store_dwordx2 v[48:49], v2, s[12:15], s25 offen offset:0
    v_lshlrev_b32 v8, 16, v50
    v_and_b32 v9, 0xffff0000, v50
    v_lshlrev_b32 v10, 16, v51
    v_and_b32 v11, 0xffff0000, v51
    v_lshlrev_b32 v12, 16, v24
    v_and_b32 v13, 0xffff0000, v24
    v_lshlrev_b32 v14, 16, v25
    v_and_b32 v15, 0xffff0000, v25
    v_lshlrev_b32 v6, 16, v26
    v_and_b32 v7, 0xffff0000, v26
    v_add_f32 v12, v12, v6
    v_add_f32 v13, v13, v7
    v_lshlrev_b32 v6, 16, v27
    v_and_b32 v7, 0xffff0000, v27
    v_add_f32 v14, v14, v6
    v_add_f32 v15, v15, v7
    v_lshlrev_b32 v6, 16, v28
    v_and_b32 v7, 0xffff0000, v28
    v_add_f32 v12, v12, v6
    v_add_f32 v13, v13, v7
    v_lshlrev_b32 v6, 16, v29
    v_and_b32 v7, 0xffff0000, v29
    v_add_f32 v14, v14, v6
    v_add_f32 v15, v15, v7
    v_lshlrev_b32 v6, 16, v30
    v_and_b32 v7, 0xffff0000, v30
    v_add_f32 v12, v12, v6
    v_add_f32 v13, v13, v7
    v_lshlrev_b32 v6, 16, v31
    v_and_b32 v7, 0xffff0000, v31
    v_add_f32 v14, v14, v6
    v_add_f32 v15, v15, v7
    v_add_f32 v8, v8, v12
    v_add_f32 v9, v9, v13
    v_add_f32 v10, v10, v14
    v_add_f32 v11, v11, v15
    v_cvt_pk_bf16_f32 v50, v8, v9
    v_cvt_pk_bf16_f32 v51, v10, v11
    buffer_store_dwordx2 v[50:51], v2, s[12:15], s25 offen offset:32
    v_lshlrev_b32 v8, 16, v52
    v_and_b32 v9, 0xffff0000, v52
    v_lshlrev_b32 v10, 16, v53
    v_and_b32 v11, 0xffff0000, v53
    v_lshlrev_b32 v12, 16, v32
    v_and_b32 v13, 0xffff0000, v32
    v_lshlrev_b32 v14, 16, v33
    v_and_b32 v15, 0xffff0000, v33
    v_lshlrev_b32 v6, 16, v34
    v_and_b32 v7, 0xffff0000, v34
    v_add_f32 v12, v12, v6
    v_add_f32 v13, v13, v7
    v_lshlrev_b32 v6, 16, v35
    v_and_b32 v7, 0xffff0000, v35
    v_add_f32 v14, v14, v6
    v_add_f32 v15, v15, v7
    v_lshlrev_b32 v6, 16, v36
    v_and_b32 v7, 0xffff0000, v36
    v_add_f32 v12, v12, v6
    v_add_f32 v13, v13, v7
    v_lshlrev_b32 v6, 16, v37
    v_and_b32 v7, 0xffff0000, v37
    v_add_f32 v14, v14, v6
    v_add_f32 v15, v15, v7
    v_lshlrev_b32 v6, 16, v38
    v_and_b32 v7, 0xffff0000, v38
    v_add_f32 v12, v12, v6
    v_add_f32 v13, v13, v7
    v_lshlrev_b32 v6, 16, v39
    v_and_b32 v7, 0xffff0000, v39
    v_add_f32 v14, v14, v6
    v_add_f32 v15, v15, v7
    v_add_f32 v8, v8, v12
    v_add_f32 v9, v9, v13
    v_add_f32 v10, v10, v14
    v_add_f32 v11, v11, v15
    v_cvt_pk_bf16_f32 v52, v8, v9
    v_cvt_pk_bf16_f32 v53, v10, v11
    buffer_store_dwordx2 v[52:53], v2, s[12:15], s25 offen offset:64
    v_lshlrev_b32 v8, 16, v54
    v_and_b32 v9, 0xffff0000, v54
    v_lshlrev_b32 v10, 16, v55
    v_and_b32 v11, 0xffff0000, v55
    v_lshlrev_b32 v12, 16, v40
    v_and_b32 v13, 0xffff0000, v40
    v_lshlrev_b32 v14, 16, v41
    v_and_b32 v15, 0xffff0000, v41
    v_lshlrev_b32 v6, 16, v42
    v_and_b32 v7, 0xffff0000, v42
    v_add_f32 v12, v12, v6
    v_add_f32 v13, v13, v7
    v_lshlrev_b32 v6, 16, v43
    v_and_b32 v7, 0xffff0000, v43
    v_add_f32 v14, v14, v6
    v_add_f32 v15, v15, v7
    v_lshlrev_b32 v6, 16, v44
    v_and_b32 v7, 0xffff0000, v44
    v_add_f32 v12, v12, v6
    v_add_f32 v13, v13, v7
    v_lshlrev_b32 v6, 16, v45
    v_and_b32 v7, 0xffff0000, v45
    v_add_f32 v14, v14, v6
    v_add_f32 v15, v15, v7
    v_lshlrev_b32 v6, 16, v46
    v_and_b32 v7, 0xffff0000, v46
    v_add_f32 v12, v12, v6
    v_add_f32 v13, v13, v7
    v_lshlrev_b32 v6, 16, v47
    v_and_b32 v7, 0xffff0000, v47
    v_add_f32 v14, v14, v6
    v_add_f32 v15, v15, v7
    v_add_f32 v8, v8, v12
    v_add_f32 v9, v9, v13
    v_add_f32 v10, v10, v14
    v_add_f32 v11, v11, v15
    v_cvt_pk_bf16_f32 v54, v8, v9
    v_cvt_pk_bf16_f32 v55, v10, v11
    buffer_store_dwordx2 v[54:55], v2, s[12:15], s25 offen offset:96
L_r_end:
    s_endpgm
L_code_end:
.section .rodata,"a"
.p2align 6
.amdhsa_kernel reduce_kernel
  .amdhsa_next_free_vgpr 56
  .amdhsa_next_free_sgpr 32
  .amdhsa_accum_offset 56
  .amdhsa_group_segment_fixed_size 0
  .amdhsa_kernarg_size 80
  .amdhsa_user_sgpr_count 2
  .amdhsa_user_sgpr_kernarg_segment_ptr 1
  .amdhsa_system_sgpr_workgroup_id_x 1
.end_amdhsa_kernel
.text
```
